```python
import torch

def _softmax(x, axis=-1):
    return torch.softmax(x, dim=axis)
def _gelu(x):
    return torch.nn.functional.gelu(x, approximate="tanh")
def _silu(x):
    return torch.nn.functional.silu(x)
def _sigmoid(x):
    return torch.sigmoid(x)
def _layernorm(x, axis=-1, eps=1e-5):
    m = x.mean(dim=axis, keepdim=True)
    v = x.var(dim=axis, keepdim=True, unbiased=False)
    return (x - m) / torch.sqrt(v + eps)
def _scatter_add(tgt, idx, src, axis=0):
    return tgt.clone().index_add_(axis, idx, src)
def _segment_sum(src, seg, n):
    out = torch.zeros((n,) + src.shape[1:], dtype=src.dtype)
    return out.index_add_(0, seg, src)
def _pad(x, pw):
    flat = tuple(v for pair in reversed(pw) for v in pair)
    return torch.nn.functional.pad(x, flat)

kernel_name = 'gated_mix__linear_kernel_hedgehog__glu_gated_swiglu__prompt'

def setup_inputs():

    _w = (lambda a: (lambda t: t.to(torch.bfloat16) if t.is_floating_point() else t)(torch.as_tensor(a)))
    def _A_setup():
        B, S, D, H = 1, 2048, 576, 32
        Dh = D // H
        return {
            "x": _w((lambda *s: torch.randn(*s, dtype=torch.bfloat16) * 0.05)(B, S, D)),
            "wqkv": _w((lambda *s: torch.randn(*s, dtype=torch.bfloat16) * 0.8)(D, 3 * D)),
            "w_phi": _w((lambda *s: torch.randn(*s, dtype=torch.bfloat16) * 0.8)(H, Dh, Dh) * (Dh ** -0.5)),
            "wo": _w((lambda *s: torch.randn(*s, dtype=torch.bfloat16) * 0.05)(D, D)),
        }
    _A_in = _A_setup()

    def _B_setup():
        B, S, D, F = 1, 2048, 576, 4608
        return {
            "x": _w((lambda *s: torch.randn(*s, dtype=torch.bfloat16) * 0.05)(B, S, D)),
            "w1": _w((lambda *s: torch.randn(*s, dtype=torch.bfloat16) * 1.6)(D, F) * (2.0 / D) ** 0.5),
            "w3": _w((lambda *s: torch.randn(*s, dtype=torch.bfloat16) * 1.6)(D, F) * (2.0 / D) ** 0.5),
            "w2": _w((lambda *s: torch.randn(*s, dtype=torch.bfloat16) * 1.6)(F, D) * (2.0 / F) ** 0.5),
        }
    _B_in = _B_setup()

    return {
        "A_x": _A_in["x"],
        "A_wqkv": _A_in["wqkv"],
        "A_w_phi": _A_in["w_phi"],
        "A_wo": _A_in["wo"],
        "B_x": _B_in["x"],
        "B_w1": _B_in["w1"],
        "B_w3": _B_in["w3"],
        "B_w2": _B_in["w2"],
        "gate_w": _w((lambda *s: torch.randn(*s, dtype=torch.bfloat16) * 0.05)(576) * 16.0),
    }

def reference(A_x, A_wqkv, A_w_phi, A_wo, B_x, B_w1, B_w3, B_w2, gate_w):
    def _A_ref(x, wqkv, w_phi, wo):
        B, S, D = x.shape
        H = 32; Dh = D // H
        qkv = (lambda x, *d: x.permute(*d))((x @ wqkv).reshape(B, S, 3, H, Dh), 2, 0, 3, 1, 4)
        q, k, v = qkv[0], qkv[1], qkv[2]
        pq = torch.einsum("bhsd,hdf->bhsf", q, w_phi)
        pk = torch.einsum("bhsd,hdf->bhsf", k, w_phi)
        phi_q = torch.concatenate([_softmax(pq, axis=-1), _softmax(-pq, axis=-1)], axis=-1)
        phi_k = torch.concatenate([_softmax(pk, axis=-1), _softmax(-pk, axis=-1)], axis=-1)
        kv = torch.einsum("bhsf,bhsd->bhfd", phi_k, v)
        z  = torch.einsum("bhsf->bhf", phi_k)
        num = torch.einsum("bhqf,bhfd->bhqd", phi_q, kv)
        den = torch.einsum("bhqf,bhf->bhq", phi_q, z)[..., None] + 1e-6
        o = num / den
        return (lambda x, *d: x.permute(*d))(o, 0, 2, 1, 3).reshape(B, S, D) @ wo

    def _B_ref(x, w1, w3, w2):
        gate = torch.einsum("bsd,df->bsf", x, w1)
        up = torch.einsum("bsd,df->bsf", x, w3)
        h = _silu(gate) * up
        out = torch.einsum("bsf,fd->bsd", h, w2)
        return out

    x = A_x
    g = _sigmoid((x * gate_w).sum(-1, keepdims=True))
    a = _A_ref(x, A_wqkv, A_w_phi, A_wo)
    b = _B_ref(x, B_w1, B_w3, B_w2)
    return g * a + (1 - g) * b
```

```asm
; @launch grid=(256,1,1) block=(256,1,1) lds=163840
.amdgcn_target "amdgcn-amd-amdhsa--gfx950"
.text
.globl gated_mix__linear_kernel_hedgehog__glu_gated_swiglu__prompt_kernel
.p2align 8
.type gated_mix__linear_kernel_hedgehog__glu_gated_swiglu__prompt_kernel,@function
gated_mix__linear_kernel_hedgehog__glu_gated_swiglu__prompt_kernel:
s_cmp_ge_u32 s2, 256
s_cbranch_scc1 L_end
s_load_dwordx2 s[36:37], s[0:1], 80
s_getreg_b32 s78, hwreg(HW_REG_XCC_ID, 0, 3)
s_mov_b32 s38, 256
s_mov_b32 s39, 0x20000
s_load_dwordx2 s[4:5], s[0:1], 0
s_load_dwordx2 s[16:17], s[0:1], 8
s_load_dwordx2 s[96:97], s[0:1], 16
s_load_dwordx2 s[24:25], s[0:1], 24
s_load_dwordx2 s[8:9], s[0:1], 40
s_load_dwordx2 s[12:13], s[0:1], 48
s_load_dwordx2 s[20:21], s[0:1], 56
s_load_dwordx2 s[44:45], s[0:1], 64
s_load_dwordx2 s[32:33], s[0:1], 72
s_load_dwordx2 s[28:29], s[0:1], 88
s_getpc_b64 s[92:93]
L_pc:
s_mov_b32 s94, L_tabend-L_pc
s_mov_b32 s95, 0x20000
v_and_b32 v14, 63, v0
v_lshrrev_b32 v15, 6, v0
v_lshlrev_b32 v12, 4, v14
v_readfirstlane_b32 s48, v15
s_lshr_b32 s63, s2, 3
s_lshl_b32 s76, s63, 12
v_lshlrev_b32 v40, 4, v0
s_lshl_b32 s76, s63, 12
buffer_load_dwordx4 v[208:211], v40, s[92:95], s76 offen
s_and_b32 s76, s2, 1
s_lshl_b32 s76, s76, 2
s_and_b32 s50, s63, 3
s_add_u32 s50, s50, s76
s_bfe_u32 s49, s2, 0x20001
s_lshr_b32 s51, s63, 2
s_lshl_b32 s52, s49, 3
s_add_u32 s52, s52, s51
s_and_b32 s53, s51, 3
s_lshr_b32 s54, s51, 2
s_lshr_b32 s55, s51, 1
s_and_b32 s76, s51, 1
s_lshl_b32 s56, s50, 1
s_add_u32 s56, s56, s76
s_mov_b32 s58, 0x3fb8aa3b
s_mov_b32 s59, 0xbfb8aa3b
s_mul_i32 s79, s54, 18
v_lshrrev_b32 v40, 3, v14
v_and_b32 v41, 7, v14
v_lshrrev_b32 v42, 1, v40
v_xor_b32 v43, v41, v42
v_mul_u32_u24 v44, 1152, v40
v_lshl_add_u32 v1, v43, 4, v44
v_xor_b32 v2, 64, v1
v_and_b32 v42, 1, v42
v_lshlrev_b32 v42, 1, v42
v_xor_b32 v43, v41, v42
v_mul_u32_u24 v44, 9216, v40
v_lshl_add_u32 v5, v43, 4, v44
v_xor_b32 v6, 64, v5
s_lshl_b32 s76, s50, 8
s_lshl_b32 s77, s48, 6
s_add_u32 s76, s76, s77
s_mul_i32 s76, s76, 1152
s_add_u32 s64, s76, 4096
s_add_u32 s65, s76, 12288
s_add_u32 s66, s76, 20480
s_add_u32 s67, s76, 28672
s_add_u32 s68, s76, 40960
s_add_u32 s69, s76, 49152
s_add_u32 s70, s76, 57344
s_add_u32 s71, s76, 65536
s_lshl_b32 s76, s49, 1
s_add_u32 s76, s76, s54
s_mul_i32 s78, s76, 1152
s_lshl_b32 s77, s53, 8
s_add_u32 s60, s78, s77
s_mul_i32 s76, s48, 147456
s_add_u32 s76, s76, s60
s_add_u32 s72, s76, 4096
s_add_u32 s73, s76, 76800
s_add_u32 s74, s76, 2048
s_add_u32 s75, s76, 74752
s_lshl_b32 s62, s48, 12
s_lshl_b32 s61, s48, 13
s_add_u32 s61, s61, 16384
s_and_b32 s76, s50, 3
s_lshl_b32 s76, s76, 1
s_add_u32 s76, s76, s51
s_sub_u32 s77, s76, 9
s_min_u32 s76, s76, s77
s_waitcnt lgkmcnt(0)
s_mul_i32 s0, s76, 1
s_lshl_b32 s1, s0, 7
s_mul_i32 s76, s0, 589824
v_add_u32 v1, s1, v1
v_add_u32 v2, s1, v2
v_add_u32 v5, s76, v5
v_add_u32 v6, s76, v6
s_sub_u32 s4, s4, 4096
s_subb_u32 s5, s5, 0
s_mov_b32 s6, 2363392
s_mov_b32 s7, 0x20000
s_sub_u32 s8, s8, 4096
s_subb_u32 s9, s9, 0
s_mov_b32 s10, 5312512
s_mov_b32 s11, 0x20000
s_sub_u32 s12, s12, 4096
s_subb_u32 s13, s13, 0
s_mov_b32 s14, 5312512
s_mov_b32 s15, 0x20000
s_add_u32 m0, s62, 0
s_nop 0
buffer_load_dwordx4 v5, s[8:11], s72 offen offset:0 lds
buffer_load_dwordx4 v6, s[8:11], s73 offen offset:1024 lds
buffer_load_dwordx4 v5, s[12:15], s74 offen offset:2048 lds
buffer_load_dwordx4 v6, s[12:15], s75 offen offset:3072 lds
s_add_u32 s78, s1, 128
s_sub_u32 s63, s1, 1024
s_min_u32 s78, s78, s63
s_sub_u32 s63, s78, s1
s_mov_b32 s1, s78
s_mul_i32 s78, s63, 4608
v_add_u32 v5, s78, v5
v_add_u32 v6, s78, v6
s_add_u32 m0, s61, 0
s_nop 0
buffer_load_dwordx4 v1, s[4:7], s64 offen offset:0 lds
buffer_load_dwordx4 v2, s[4:7], s65 offen offset:1024 lds
buffer_load_dwordx4 v1, s[4:7], s66 offen offset:2048 lds
buffer_load_dwordx4 v2, s[4:7], s67 offen offset:3072 lds
s_add_u32 m0, s61, 4096
s_nop 0
buffer_load_dwordx4 v1, s[4:7], s68 offen offset:0 lds
buffer_load_dwordx4 v2, s[4:7], s69 offen offset:1024 lds
buffer_load_dwordx4 v1, s[4:7], s70 offen offset:2048 lds
buffer_load_dwordx4 v2, s[4:7], s71 offen offset:3072 lds
v_add_u32 v1, s63, v1
v_add_u32 v2, s63, v2
s_mov_b32 s30, 268435456
s_mov_b32 s31, 0x20000
s_mov_b32 s18, 1990656
s_mov_b32 s19, 0x20000
s_sub_u32 s20, s20, 4096
s_subb_u32 s21, s21, 0
s_mov_b32 s22, 5312512
s_mov_b32 s23, 0x20000
s_sub_u32 s24, s24, 4096
s_subb_u32 s25, s25, 0
s_mov_b32 s26, 667648
s_mov_b32 s27, 0x20000
s_mov_b32 s34, 2359296
s_mov_b32 s35, 0x20000
s_mov_b32 s98, 20736
s_mov_b32 s99, 0x20000
s_mov_b32 s46, 1152
s_mov_b32 s47, 0x20000
s_mov_b32 s42, 5312512
s_mov_b32 s43, 0x20000
s_mov_b32 s76, 35127296
buffer_load_dword v176, off, s[28:31], s76 sc1
s_add_u32 m0, s62, 49152
s_nop 0
buffer_load_dwordx4 v5, s[8:11], s72 offen offset:0 lds
buffer_load_dwordx4 v6, s[8:11], s73 offen offset:1024 lds
buffer_load_dwordx4 v5, s[12:15], s74 offen offset:2048 lds
buffer_load_dwordx4 v6, s[12:15], s75 offen offset:3072 lds
s_add_u32 s78, s1, 128
s_sub_u32 s63, s1, 1024
s_min_u32 s78, s78, s63
s_sub_u32 s63, s78, s1
s_mov_b32 s1, s78
s_mul_i32 s78, s63, 4608
v_add_u32 v5, s78, v5
v_add_u32 v6, s78, v6
s_add_u32 m0, s61, 49152
s_nop 0
buffer_load_dwordx4 v1, s[4:7], s64 offen offset:0 lds
buffer_load_dwordx4 v2, s[4:7], s65 offen offset:1024 lds
buffer_load_dwordx4 v1, s[4:7], s66 offen offset:2048 lds
buffer_load_dwordx4 v2, s[4:7], s67 offen offset:3072 lds
s_add_u32 m0, s61, 53248
s_nop 0
buffer_load_dwordx4 v1, s[4:7], s68 offen offset:0 lds
buffer_load_dwordx4 v2, s[4:7], s69 offen offset:1024 lds
buffer_load_dwordx4 v1, s[4:7], s70 offen offset:2048 lds
buffer_load_dwordx4 v2, s[4:7], s71 offen offset:3072 lds
v_add_u32 v1, s63, v1
v_add_u32 v2, s63, v2
s_mul_i32 s76, s52, 648
v_add_u32 v177, 256, v0
v_min_u32 v177, 323, v177
v_lshlrev_b32 v42, 1, v0
v_lshlrev_b32 v43, 1, v177
buffer_load_ushort v178, v42, s[96:99], s76 offen
buffer_load_ushort v179, v43, s[96:99], s76 offen
s_add_u32 s96, s92, L_tab-L_pc
s_addc_u32 s97, s93, 0
s_mov_b32 s98, L_tabend-L_tab
v_and_b32 v44, 15, v14
v_lshrrev_b32 v45, 4, v14
v_lshrrev_b32 v15, 1, v44
v_xor_b32 v15, v45, v15
v_lshlrev_b32 v15, 4, v15
v_lshl_add_u32 v3, v44, 7, v15
v_add_u32 v3, s61, v3
v_xor_b32 v4, 64, v3
v_bfe_u32 v15, v14, 3, 1
v_and_b32 v44, 1, v45
v_lshl_or_b32 v15, v44, 1, v15
v_lshlrev_b32 v15, 5, v15
v_and_b32 v11, 3, v14
v_lshl_add_u32 v15, v11, 3, v15
v_bfe_u32 v11, v14, 2, 2
v_lshl_add_u32 v15, v11, 7, v15
v_lshl_add_u32 v13, v45, 10, v15
v_lshl_add_u32 v15, v44, 10, v15
v_lshrrev_b32 v45, 1, v45
v_lshl_add_u32 v7, v45, 12, v15
v_xor_b32 v8, 32, v7
v_xor_b32 v9, 64, v7
v_xor_b32 v10, 96, v7
v_mov_b32 v180, v0
v_mov_b32 v181, 0
v_cmp_eq_u32 vcc, 0, v0
v_bfrev_b32 v0, 1
s_nop 0
v_cndmask_b32 v0, v0, v181, vcc
s_lshl_b32 s76, s53, 2
s_add_u32 s79, s79, s76
s_mul_i32 s79, s79, 16
s_lshl3_add_u32 s85, s49, s50
s_mul_i32 s85, s85, 672
s_lshl_b32 s76, s48, 2
s_add_u32 s85, s85, s76
s_add_u32 s79, s79, s85
s_lshl_b32 s79, s79, 10
s_waitcnt vmcnt(15)
s_barrier
ds_read_b64_tr_b16 v[16:17], v7 offset:0
ds_read_b64_tr_b16 v[18:19], v7 offset:512
ds_read_b128 a[0:3], v3 offset:0
ds_read_b128 a[4:7], v3 offset:2048
ds_read_b128 a[8:11], v3 offset:4096
ds_read_b128 a[12:15], v3 offset:6144
ds_read_b64_tr_b16 v[20:21], v8 offset:0
ds_read_b64_tr_b16 v[22:23], v8 offset:512
ds_read_b64_tr_b16 v[24:25], v9 offset:0
ds_read_b64_tr_b16 v[26:27], v9 offset:512
ds_read_b64_tr_b16 v[28:29], v10 offset:0
ds_read_b64_tr_b16 v[30:31], v10 offset:512
s_waitcnt lgkmcnt(9)
v_mfma_f32_16x16x32_bf16 v[48:51], v[16:19], a[0:3], 0
s_add_u32 m0, s62, 98304
ds_read_b64_tr_b16 v[32:33], v7 offset:2048
buffer_load_dwordx4 v5, s[8:11], s72 offen offset:0 lds
s_waitcnt lgkmcnt(9)
v_mfma_f32_16x16x32_bf16 v[52:55], v[16:19], a[4:7], 0
ds_read_b64_tr_b16 v[34:35], v7 offset:2560
s_waitcnt lgkmcnt(9)
v_mfma_f32_16x16x32_bf16 v[56:59], v[16:19], a[8:11], 0
ds_read_b128 a[16:19], v4 offset:0
s_waitcnt lgkmcnt(9)
v_mfma_f32_16x16x32_bf16 v[60:63], v[16:19], a[12:15], 0
ds_read_b128 a[20:23], v4 offset:2048
buffer_load_dwordx4 v6, s[8:11], s73 offen offset:1024 lds
s_waitcnt lgkmcnt(8)
v_mfma_f32_16x16x32_bf16 v[76:79], v[20:23], a[12:15], 0
ds_read_b64_tr_b16 v[36:37], v8 offset:2048
v_mfma_f32_16x16x32_bf16 v[72:75], v[20:23], a[8:11], 0
ds_read_b64_tr_b16 v[38:39], v8 offset:2560
v_mfma_f32_16x16x32_bf16 v[68:71], v[20:23], a[4:7], 0
ds_read_b128 a[24:27], v4 offset:4096
v_mfma_f32_16x16x32_bf16 v[64:67], v[20:23], a[0:3], 0
s_waitcnt lgkmcnt(7)
ds_read_b128 a[28:31], v4 offset:6144
buffer_load_dwordx4 v5, s[12:15], s74 offen offset:2048 lds
v_mfma_f32_16x16x32_bf16 v[80:83], v[24:27], a[0:3], 0
ds_read_b64_tr_b16 v[16:17], v9 offset:2048
v_mfma_f32_16x16x32_bf16 v[84:87], v[24:27], a[4:7], 0
ds_read_b64_tr_b16 v[18:19], v9 offset:2560
v_mfma_f32_16x16x32_bf16 v[88:91], v[24:27], a[8:11], 0
v_mfma_f32_16x16x32_bf16 v[92:95], v[24:27], a[12:15], 0
v_mfma_f32_16x16x32_bf16 v[108:111], v[28:31], a[12:15], 0
ds_read_b64_tr_b16 v[20:21], v10 offset:2048
buffer_load_dwordx4 v6, s[12:15], s75 offen offset:3072 lds
v_mfma_f32_16x16x32_bf16 v[104:107], v[28:31], a[8:11], 0
s_add_u32 s78, s1, 128
ds_read_b64_tr_b16 v[22:23], v10 offset:2560
s_sub_u32 s63, s1, 1024
v_mfma_f32_16x16x32_bf16 v[100:103], v[28:31], a[4:7], 0
s_min_u32 s78, s78, s63
s_sub_u32 s63, s78, s1
s_mov_b32 s1, s78
v_mfma_f32_16x16x32_bf16 v[96:99], v[28:31], a[0:3], 0
s_waitcnt lgkmcnt(6)
s_mul_i32 s78, s63, 4608
v_add_u32 v5, s78, v5
v_mfma_f32_16x16x32_bf16 v[112:115], v[32:35], a[0:3], 0
ds_read_b64_tr_b16 v[24:25], v7 offset:8192
v_add_u32 v6, s78, v6
v_mfma_f32_16x16x32_bf16 v[116:119], v[32:35], a[4:7], 0
s_add_u32 m0, s61, 98304
ds_read_b64_tr_b16 v[26:27], v7 offset:8704
buffer_load_dwordx4 v1, s[4:7], s64 offen offset:0 lds
v_mfma_f32_16x16x32_bf16 v[120:123], v[32:35], a[8:11], 0
v_mfma_f32_16x16x32_bf16 v[124:127], v[32:35], a[12:15], 0
v_mfma_f32_16x16x32_bf16 v[140:143], v[36:39], a[12:15], 0
ds_read_b64_tr_b16 v[28:29], v8 offset:8192
buffer_load_dwordx4 v2, s[4:7], s65 offen offset:1024 lds
v_mfma_f32_16x16x32_bf16 v[136:139], v[36:39], a[8:11], 0
ds_read_b64_tr_b16 v[30:31], v8 offset:8704
v_mfma_f32_16x16x32_bf16 v[132:135], v[36:39], a[4:7], 0
v_mfma_f32_16x16x32_bf16 v[128:131], v[36:39], a[0:3], 0
s_waitcnt lgkmcnt(4)
v_mfma_f32_16x16x32_bf16 v[144:147], v[16:19], a[0:3], 0
ds_read_b64_tr_b16 v[32:33], v9 offset:8192
v_mfma_f32_16x16x32_bf16 v[148:151], v[16:19], a[4:7], 0
ds_read_b64_tr_b16 v[34:35], v9 offset:8704
buffer_load_dwordx4 v1, s[4:7], s66 offen offset:2048 lds
v_mfma_f32_16x16x32_bf16 v[152:155], v[16:19], a[8:11], 0
v_mfma_f32_16x16x32_bf16 v[156:159], v[16:19], a[12:15], 0
v_mfma_f32_16x16x32_bf16 v[172:175], v[20:23], a[12:15], 0
ds_read_b64_tr_b16 v[36:37], v10 offset:8192
v_mfma_f32_16x16x32_bf16 v[168:171], v[20:23], a[8:11], 0
ds_read_b64_tr_b16 v[38:39], v10 offset:8704
buffer_load_dwordx4 v2, s[4:7], s67 offen offset:3072 lds
v_mfma_f32_16x16x32_bf16 v[164:167], v[20:23], a[4:7], 0
s_add_u32 m0, s61, 102400
v_mfma_f32_16x16x32_bf16 v[160:163], v[20:23], a[0:3], 0
s_waitcnt lgkmcnt(4)
v_mfma_f32_16x16x32_bf16 v[48:51], v[24:27], a[16:19], v[48:51]
ds_read_b64_tr_b16 v[16:17], v7 offset:10240
v_mfma_f32_16x16x32_bf16 v[52:55], v[24:27], a[20:23], v[52:55]
ds_read_b64_tr_b16 v[18:19], v7 offset:10752
buffer_load_dwordx4 v1, s[4:7], s68 offen offset:0 lds
v_mfma_f32_16x16x32_bf16 v[56:59], v[24:27], a[24:27], v[56:59]
v_mfma_f32_16x16x32_bf16 v[60:63], v[24:27], a[28:31], v[60:63]
v_mfma_f32_16x16x32_bf16 v[76:79], v[28:31], a[28:31], v[76:79]
ds_read_b64_tr_b16 v[20:21], v8 offset:10240
v_mfma_f32_16x16x32_bf16 v[72:75], v[28:31], a[24:27], v[72:75]
ds_read_b64_tr_b16 v[22:23], v8 offset:10752
v_mfma_f32_16x16x32_bf16 v[68:71], v[28:31], a[20:23], v[68:71]
buffer_load_dwordx4 v2, s[4:7], s69 offen offset:1024 lds
v_mfma_f32_16x16x32_bf16 v[64:67], v[28:31], a[16:19], v[64:67]
s_waitcnt lgkmcnt(4)
v_mfma_f32_16x16x32_bf16 v[80:83], v[32:35], a[16:19], v[80:83]
ds_read_b64_tr_b16 v[24:25], v9 offset:10240
v_mfma_f32_16x16x32_bf16 v[84:87], v[32:35], a[20:23], v[84:87]
ds_read_b64_tr_b16 v[26:27], v9 offset:10752
v_mfma_f32_16x16x32_bf16 v[88:91], v[32:35], a[24:27], v[88:91]
buffer_load_dwordx4 v1, s[4:7], s70 offen offset:2048 lds
v_mfma_f32_16x16x32_bf16 v[92:95], v[32:35], a[28:31], v[92:95]
v_mfma_f32_16x16x32_bf16 v[108:111], v[36:39], a[28:31], v[108:111]
ds_read_b64_tr_b16 v[28:29], v10 offset:10240
v_mfma_f32_16x16x32_bf16 v[104:107], v[36:39], a[24:27], v[104:107]
ds_read_b64_tr_b16 v[30:31], v10 offset:10752
v_mfma_f32_16x16x32_bf16 v[100:103], v[36:39], a[20:23], v[100:103]
buffer_load_dwordx4 v2, s[4:7], s71 offen offset:3072 lds
v_add_u32 v1, s63, v1
v_mfma_f32_16x16x32_bf16 v[96:99], v[36:39], a[16:19], v[96:99]
s_waitcnt lgkmcnt(4)
v_add_u32 v2, s63, v2
v_mfma_f32_16x16x32_bf16 v[112:115], v[16:19], a[16:19], v[112:115]
v_mfma_f32_16x16x32_bf16 v[116:119], v[16:19], a[20:23], v[116:119]
v_mfma_f32_16x16x32_bf16 v[120:123], v[16:19], a[24:27], v[120:123]
v_mfma_f32_16x16x32_bf16 v[124:127], v[16:19], a[28:31], v[124:127]
v_mfma_f32_16x16x32_bf16 v[140:143], v[20:23], a[28:31], v[140:143]
s_waitcnt vmcnt(14) lgkmcnt(0)
s_barrier
v_add_u32 v7, 49152, v7
v_mfma_f32_16x16x32_bf16 v[136:139], v[20:23], a[24:27], v[136:139]
s_add_u32 m0, s62, 0
v_add_u32 v3, 49152, v3
v_readfirstlane_b32 s77, v176
v_mfma_f32_16x16x32_bf16 v[132:135], v[20:23], a[20:23], v[132:135]
ds_read_b64_tr_b16 v[32:33], v7 offset:0
ds_read_b64_tr_b16 v[34:35], v7 offset:512
v_mfma_f32_16x16x32_bf16 v[128:131], v[20:23], a[16:19], v[128:131]
ds_read_b128 a[32:35], v3 offset:0
ds_read_b128 a[36:39], v3 offset:2048
v_mfma_f32_16x16x32_bf16 v[144:147], v[24:27], a[16:19], v[144:147]
ds_read_b128 a[40:43], v3 offset:4096
buffer_load_dwordx4 v5, s[8:11], s72 offen offset:0 lds
v_mfma_f32_16x16x32_bf16 v[148:151], v[24:27], a[20:23], v[148:151]
ds_read_b128 a[44:47], v3 offset:6144
v_add_u32 v8, 49152, v8
v_mfma_f32_16x16x32_bf16 v[152:155], v[24:27], a[24:27], v[152:155]
s_cmp_eq_u32 s2, 0
s_cselect_b32 s88, 0, 0x80000000
v_mfma_f32_16x16x32_bf16 v[156:159], v[24:27], a[28:31], v[156:159]
v_add_u32 v4, 49152, v4
v_or_b32 v182, s88, v0
v_mfma_f32_16x16x32_bf16 v[172:175], v[28:31], a[28:31], v[172:175]
s_mul_i32 s88, s77, 0x9e3779b1
ds_read_b64_tr_b16 v[36:37], v8 offset:0
buffer_load_dwordx4 v6, s[8:11], s73 offen offset:1024 lds
v_mfma_f32_16x16x32_bf16 v[168:171], v[28:31], a[24:27], v[168:171]
s_add_u32 s88, s88, 0x7f4a7c15
ds_read_b64_tr_b16 v[38:39], v8 offset:512
v_add_u32 v9, 49152, v9
v_mfma_f32_16x16x32_bf16 v[164:167], v[28:31], a[20:23], v[164:167]
s_or_b32 s88, s88, 1
ds_read_b64_tr_b16 v[16:17], v9 offset:0
s_add_u32 s87, s88, 2
v_mfma_f32_16x16x32_bf16 v[160:163], v[28:31], a[16:19], v[160:163]
s_waitcnt lgkmcnt(1)
ds_read_b64_tr_b16 v[18:19], v9 offset:512
v_add_u32 v10, 49152, v10
v_mfma_f32_16x16x32_bf16 v[48:51], v[32:35], a[32:35], v[48:51]
ds_read_b64_tr_b16 v[20:21], v10 offset:0
v_mfma_f32_16x16x32_bf16 v[52:55], v[32:35], a[36:39], v[52:55]
ds_read_b64_tr_b16 v[22:23], v10 offset:512
buffer_load_dwordx4 v5, s[12:15], s74 offen offset:2048 lds
v_mfma_f32_16x16x32_bf16 v[56:59], v[32:35], a[40:43], v[56:59]
ds_read_b64_tr_b16 v[24:25], v7 offset:2048
v_mfma_f32_16x16x32_bf16 v[60:63], v[32:35], a[44:47], v[60:63]
ds_read_b64_tr_b16 v[26:27], v7 offset:2560
v_mfma_f32_16x16x32_bf16 v[76:79], v[36:39], a[44:47], v[76:79]
ds_read_b128 a[48:51], v4 offset:0
v_mfma_f32_16x16x32_bf16 v[72:75], v[36:39], a[40:43], v[72:75]
ds_read_b128 a[52:55], v4 offset:2048
v_mfma_f32_16x16x32_bf16 v[68:71], v[36:39], a[36:39], v[68:71]
ds_read_b64_tr_b16 v[28:29], v8 offset:2048
buffer_load_dwordx4 v6, s[12:15], s75 offen offset:3072 lds
v_mfma_f32_16x16x32_bf16 v[64:67], v[36:39], a[32:35], v[64:67]
s_waitcnt lgkmcnt(5)
ds_read_b64_tr_b16 v[30:31], v8 offset:2560
s_add_u32 s78, s1, 128
v_mfma_f32_16x16x32_bf16 v[80:83], v[16:19], a[32:35], v[80:83]
s_sub_u32 s63, s1, 1024
ds_read_b128 a[56:59], v4 offset:4096
s_min_u32 s78, s78, s63
v_mfma_f32_16x16x32_bf16 v[84:87], v[16:19], a[36:39], v[84:87]
s_sub_u32 s63, s78, s1
ds_read_b128 a[60:63], v4 offset:6144
s_mov_b32 s1, s78
v_mfma_f32_16x16x32_bf16 v[88:91], v[16:19], a[40:43], v[88:91]
s_mul_i32 s78, s63, 4608
ds_read_b64_tr_b16 v[32:33], v9 offset:2048
v_add_u32 v5, s78, v5
v_mfma_f32_16x16x32_bf16 v[92:95], v[16:19], a[44:47], v[92:95]
ds_read_b64_tr_b16 v[34:35], v9 offset:2560
v_add_u32 v6, s78, v6
v_mfma_f32_16x16x32_bf16 v[108:111], v[20:23], a[44:47], v[108:111]
s_add_u32 m0, s61, 0
ds_read_b64_tr_b16 v[36:37], v10 offset:2048
buffer_load_dwordx4 v1, s[4:7], s64 offen offset:0 lds
v_mfma_f32_16x16x32_bf16 v[104:107], v[20:23], a[40:43], v[104:107]
ds_read_b64_tr_b16 v[38:39], v10 offset:2560
v_mfma_f32_16x16x32_bf16 v[100:103], v[20:23], a[36:39], v[100:103]
s_cmp_eq_u32 s88, s77
s_cselect_b32 s88, s87, s88
v_mfma_f32_16x16x32_bf16 v[96:99], v[20:23], a[32:35], v[96:99]
s_waitcnt lgkmcnt(6)
v_mov_b32 v176, s88
s_mov_b32 s76, 35127296
v_mfma_f32_16x16x32_bf16 v[112:115], v[24:27], a[32:35], v[112:115]
ds_read_b64_tr_b16 v[16:17], v7 offset:8192
buffer_load_dwordx4 v2, s[4:7], s65 offen offset:1024 lds
v_mfma_f32_16x16x32_bf16 v[116:119], v[24:27], a[36:39], v[116:119]
ds_read_b64_tr_b16 v[18:19], v7 offset:8704
v_mfma_f32_16x16x32_bf16 v[120:123], v[24:27], a[40:43], v[120:123]
s_cmp_lg_u32 s2, 0
s_cbranch_scc1 L_nonce_done
buffer_store_dword v176, v0, s[36:39], 16 offen sc1
buffer_store_dword v176, v0, s[28:31], s76 offen sc1
L_nonce_done:
v_mfma_f32_16x16x32_bf16 v[124:127], v[24:27], a[44:47], v[124:127]
v_mfma_f32_16x16x32_bf16 v[140:143], v[28:31], a[44:47], v[140:143]
ds_read_b64_tr_b16 v[20:21], v8 offset:8192
v_mfma_f32_16x16x32_bf16 v[136:139], v[28:31], a[40:43], v[136:139]
ds_read_b64_tr_b16 v[22:23], v8 offset:8704
buffer_load_dwordx4 v1, s[4:7], s66 offen offset:2048 lds
v_mfma_f32_16x16x32_bf16 v[132:135], v[28:31], a[36:39], v[132:135]
v_mfma_f32_16x16x32_bf16 v[128:131], v[28:31], a[32:35], v[128:131]
s_waitcnt lgkmcnt(4)
v_mfma_f32_16x16x32_bf16 v[144:147], v[32:35], a[32:35], v[144:147]
ds_read_b64_tr_b16 v[24:25], v9 offset:8192
v_mfma_f32_16x16x32_bf16 v[148:151], v[32:35], a[36:39], v[148:151]
ds_read_b64_tr_b16 v[26:27], v9 offset:8704
buffer_load_dwordx4 v2, s[4:7], s67 offen offset:3072 lds
v_mfma_f32_16x16x32_bf16 v[152:155], v[32:35], a[40:43], v[152:155]
s_add_u32 m0, s61, 4096
v_mfma_f32_16x16x32_bf16 v[156:159], v[32:35], a[44:47], v[156:159]
v_mfma_f32_16x16x32_bf16 v[172:175], v[36:39], a[44:47], v[172:175]
ds_read_b64_tr_b16 v[28:29], v10 offset:8192
v_mfma_f32_16x16x32_bf16 v[168:171], v[36:39], a[40:43], v[168:171]
ds_read_b64_tr_b16 v[30:31], v10 offset:8704
v_mfma_f32_16x16x32_bf16 v[164:167], v[36:39], a[36:39], v[164:167]
buffer_load_dwordx4 v1, s[4:7], s68 offen offset:0 lds
v_mfma_f32_16x16x32_bf16 v[160:163], v[36:39], a[32:35], v[160:163]
s_waitcnt lgkmcnt(4)
v_mfma_f32_16x16x32_bf16 v[48:51], v[16:19], a[48:51], v[48:51]
ds_read_b64_tr_b16 v[32:33], v7 offset:10240
v_mfma_f32_16x16x32_bf16 v[52:55], v[16:19], a[52:55], v[52:55]
ds_read_b64_tr_b16 v[34:35], v7 offset:10752
v_mfma_f32_16x16x32_bf16 v[56:59], v[16:19], a[56:59], v[56:59]
v_mfma_f32_16x16x32_bf16 v[60:63], v[16:19], a[60:63], v[60:63]
buffer_load_dwordx4 v2, s[4:7], s69 offen offset:1024 lds
v_mfma_f32_16x16x32_bf16 v[76:79], v[20:23], a[60:63], v[76:79]
ds_read_b64_tr_b16 v[36:37], v8 offset:10240
v_mfma_f32_16x16x32_bf16 v[72:75], v[20:23], a[56:59], v[72:75]
ds_read_b64_tr_b16 v[38:39], v8 offset:10752
v_mfma_f32_16x16x32_bf16 v[68:71], v[20:23], a[52:55], v[68:71]
v_mfma_f32_16x16x32_bf16 v[64:67], v[20:23], a[48:51], v[64:67]
s_waitcnt lgkmcnt(4)
v_mfma_f32_16x16x32_bf16 v[80:83], v[24:27], a[48:51], v[80:83]
ds_read_b64_tr_b16 v[16:17], v9 offset:10240
buffer_load_dwordx4 v1, s[4:7], s70 offen offset:2048 lds
v_mfma_f32_16x16x32_bf16 v[84:87], v[24:27], a[52:55], v[84:87]
ds_read_b64_tr_b16 v[18:19], v9 offset:10752
v_mfma_f32_16x16x32_bf16 v[88:91], v[24:27], a[56:59], v[88:91]
v_mfma_f32_16x16x32_bf16 v[92:95], v[24:27], a[60:63], v[92:95]
v_mfma_f32_16x16x32_bf16 v[108:111], v[28:31], a[60:63], v[108:111]
ds_read_b64_tr_b16 v[20:21], v10 offset:10240
v_mfma_f32_16x16x32_bf16 v[104:107], v[28:31], a[56:59], v[104:107]
ds_read_b64_tr_b16 v[22:23], v10 offset:10752
buffer_load_dwordx4 v2, s[4:7], s71 offen offset:3072 lds
v_mfma_f32_16x16x32_bf16 v[100:103], v[28:31], a[52:55], v[100:103]
v_add_u32 v1, s63, v1
v_add_u32 v2, s63, v2
v_mfma_f32_16x16x32_bf16 v[96:99], v[28:31], a[48:51], v[96:99]
s_waitcnt lgkmcnt(4)
v_mfma_f32_16x16x32_bf16 v[112:115], v[32:35], a[48:51], v[112:115]
v_mfma_f32_16x16x32_bf16 v[116:119], v[32:35], a[52:55], v[116:119]
v_mfma_f32_16x16x32_bf16 v[120:123], v[32:35], a[56:59], v[120:123]
v_mfma_f32_16x16x32_bf16 v[124:127], v[32:35], a[60:63], v[124:127]
v_mfma_f32_16x16x32_bf16 v[140:143], v[36:39], a[60:63], v[140:143]
s_waitcnt vmcnt(12) lgkmcnt(0)
s_barrier
v_add_u32 v7, 49152, v7
v_mfma_f32_16x16x32_bf16 v[136:139], v[36:39], a[56:59], v[136:139]
s_add_u32 m0, s62, 49152
v_add_u32 v3, 49152, v3
s_lshr_b32 s87, s48, 1
v_mfma_f32_16x16x32_bf16 v[132:135], v[36:39], a[52:55], v[132:135]
s_add_u32 s87, s87, s0
ds_read_b64_tr_b16 v[24:25], v7 offset:0
ds_read_b64_tr_b16 v[26:27], v7 offset:512
v_mfma_f32_16x16x32_bf16 v[128:131], v[36:39], a[48:51], v[128:131]
s_add_u32 s87, s87, 0
ds_read_b128 a[64:67], v3 offset:0
ds_read_b128 a[68:71], v3 offset:2048
v_mfma_f32_16x16x32_bf16 v[144:147], v[16:19], a[48:51], v[144:147]
s_sub_u32 s88, s87, 9
ds_read_b128 a[72:75], v3 offset:4096
buffer_load_dwordx4 v5, s[8:11], s72 offen offset:0 lds
v_mfma_f32_16x16x32_bf16 v[148:151], v[16:19], a[52:55], v[148:151]
s_min_u32 s87, s87, s88
ds_read_b128 a[76:79], v3 offset:6144
v_add_u32 v8, 49152, v8
v_mfma_f32_16x16x32_bf16 v[152:155], v[16:19], a[56:59], v[152:155]
s_mul_i32 s87, s87, 589824
v_add_u32 v4, 49152, v4
s_and_b32 s88, s48, 1
v_mfma_f32_16x16x32_bf16 v[156:159], v[16:19], a[60:63], v[156:159]
s_mul_i32 s88, s88, 294912
ds_read_b64_tr_b16 v[28:29], v8 offset:0
ds_read_b64_tr_b16 v[30:31], v8 offset:512
v_mfma_f32_16x16x32_bf16 v[172:175], v[20:23], a[60:63], v[172:175]
s_add_u32 s87, s87, s88
buffer_load_dwordx4 v6, s[8:11], s73 offen offset:1024 lds
v_add_u32 v9, 49152, v9
v_mfma_f32_16x16x32_bf16 v[168:171], v[20:23], a[56:59], v[168:171]
s_add_u32 s87, s87, s60
ds_read_b64_tr_b16 v[32:33], v9 offset:0
s_add_u32 s3, s87, 4224
v_mfma_f32_16x16x32_bf16 v[164:167], v[20:23], a[52:55], v[164:167]
s_lshr_b32 s87, s48, 1
ds_read_b64_tr_b16 v[34:35], v9 offset:512
v_add_u32 v10, 49152, v10
v_mfma_f32_16x16x32_bf16 v[160:163], v[20:23], a[48:51], v[160:163]
s_waitcnt lgkmcnt(2)
ds_read_b64_tr_b16 v[36:37], v10 offset:0
s_add_u32 s87, s87, s0
v_mfma_f32_16x16x32_bf16 v[48:51], v[24:27], a[64:67], v[48:51]
s_add_u32 s87, s87, 2
ds_read_b64_tr_b16 v[38:39], v10 offset:512
s_sub_u32 s88, s87, 9
v_mfma_f32_16x16x32_bf16 v[52:55], v[24:27], a[68:71], v[52:55]
s_min_u32 s87, s87, s88
ds_read_b64_tr_b16 v[16:17], v7 offset:2048
buffer_load_dwordx4 v5, s[12:15], s74 offen offset:2048 lds
v_mfma_f32_16x16x32_bf16 v[56:59], v[24:27], a[72:75], v[56:59]
s_mul_i32 s87, s87, 589824
ds_read_b64_tr_b16 v[18:19], v7 offset:2560
s_and_b32 s88, s48, 1
v_mfma_f32_16x16x32_bf16 v[60:63], v[24:27], a[76:79], v[60:63]
s_mul_i32 s88, s88, 294912
ds_read_b128 a[80:83], v4 offset:0
s_add_u32 s87, s87, s88
v_mfma_f32_16x16x32_bf16 v[76:79], v[28:31], a[76:79], v[76:79]
s_add_u32 s87, s87, s60
ds_read_b128 a[84:87], v4 offset:2048
s_add_u32 s94, s87, 4224
v_mfma_f32_16x16x32_bf16 v[72:75], v[28:31], a[72:75], v[72:75]
s_lshr_b32 s87, s48, 1
ds_read_b64_tr_b16 v[20:21], v8 offset:2048
s_add_u32 s87, s87, s0
v_mfma_f32_16x16x32_bf16 v[68:71], v[28:31], a[68:71], v[68:71]
s_add_u32 s87, s87, 4
ds_read_b64_tr_b16 v[22:23], v8 offset:2560
buffer_load_dwordx4 v6, s[12:15], s75 offen offset:3072 lds
v_mfma_f32_16x16x32_bf16 v[64:67], v[28:31], a[64:67], v[64:67]
s_waitcnt lgkmcnt(6)
ds_read_b128 a[88:91], v4 offset:4096
s_add_u32 s78, s1, 128
v_mfma_f32_16x16x32_bf16 v[80:83], v[32:35], a[64:67], v[80:83]
s_sub_u32 s63, s1, 1024
ds_read_b128 a[92:95], v4 offset:6144
s_min_u32 s78, s78, s63
v_mfma_f32_16x16x32_bf16 v[84:87], v[32:35], a[68:71], v[84:87]
s_sub_u32 s63, s78, s1
ds_read_b64_tr_b16 v[24:25], v9 offset:2048
s_mov_b32 s1, s78
v_mfma_f32_16x16x32_bf16 v[88:91], v[32:35], a[72:75], v[88:91]
s_mul_i32 s78, s63, 4608
ds_read_b64_tr_b16 v[26:27], v9 offset:2560
v_add_u32 v5, s78, v5
v_mfma_f32_16x16x32_bf16 v[92:95], v[32:35], a[76:79], v[92:95]
s_sub_u32 s88, s87, 9
v_add_u32 v6, s78, v6
s_add_u32 m0, s61, 49152
v_mfma_f32_16x16x32_bf16 v[108:111], v[36:39], a[76:79], v[108:111]
s_min_u32 s87, s87, s88
ds_read_b64_tr_b16 v[28:29], v10 offset:2048
buffer_load_dwordx4 v1, s[4:7], s64 offen offset:0 lds
v_mfma_f32_16x16x32_bf16 v[104:107], v[36:39], a[72:75], v[104:107]
s_mul_i32 s87, s87, 589824
ds_read_b64_tr_b16 v[30:31], v10 offset:2560
s_and_b32 s88, s48, 1
v_mfma_f32_16x16x32_bf16 v[100:103], v[36:39], a[68:71], v[100:103]
s_mul_i32 s88, s88, 294912
s_add_u32 s87, s87, s88
s_add_u32 s87, s87, s60
v_mfma_f32_16x16x32_bf16 v[96:99], v[36:39], a[64:67], v[96:99]
s_waitcnt lgkmcnt(6)
s_add_u32 s95, s87, 4224
s_lshr_b32 s87, s48, 1
v_mfma_f32_16x16x32_bf16 v[112:115], v[16:19], a[64:67], v[112:115]
s_add_u32 s87, s87, s0
ds_read_b64_tr_b16 v[32:33], v7 offset:8192
buffer_load_dwordx4 v2, s[4:7], s65 offen offset:1024 lds
v_mfma_f32_16x16x32_bf16 v[116:119], v[16:19], a[68:71], v[116:119]
s_add_u32 s87, s87, 6
ds_read_b64_tr_b16 v[34:35], v7 offset:8704
s_sub_u32 s88, s87, 9
v_mfma_f32_16x16x32_bf16 v[120:123], v[16:19], a[72:75], v[120:123]
s_min_u32 s87, s87, s88
s_mul_i32 s87, s87, 589824
s_and_b32 s88, s48, 1
v_mfma_f32_16x16x32_bf16 v[124:127], v[16:19], a[76:79], v[124:127]
s_mul_i32 s88, s88, 294912
s_add_u32 s87, s87, s88
s_add_u32 s87, s87, s60
v_mfma_f32_16x16x32_bf16 v[140:143], v[20:23], a[76:79], v[140:143]
s_add_u32 s89, s87, 4224
ds_read_b64_tr_b16 v[36:37], v8 offset:8192
s_add_u32 s87, s0, 8
v_mfma_f32_16x16x32_bf16 v[136:139], v[20:23], a[72:75], v[136:139]
s_sub_u32 s88, s87, 9
ds_read_b64_tr_b16 v[38:39], v8 offset:8704
buffer_load_dwordx4 v1, s[4:7], s66 offen offset:2048 lds
v_mfma_f32_16x16x32_bf16 v[132:135], v[20:23], a[68:71], v[132:135]
s_min_u32 s87, s87, s88
s_mul_i32 s87, s87, 589824
s_mul_i32 s88, s48, 147456
v_mfma_f32_16x16x32_bf16 v[128:131], v[20:23], a[64:67], v[128:131]
s_waitcnt lgkmcnt(4)
s_add_u32 s87, s87, s88
s_add_u32 s87, s87, s60
v_mfma_f32_16x16x32_bf16 v[144:147], v[24:27], a[64:67], v[144:147]
s_add_u32 s54, s87, 4224
ds_read_b64_tr_b16 v[16:17], v9 offset:8192
v_mfma_f32_16x16x32_bf16 v[148:151], v[24:27], a[68:71], v[148:151]
ds_read_b64_tr_b16 v[18:19], v9 offset:8704
buffer_load_dwordx4 v2, s[4:7], s67 offen offset:3072 lds
v_mfma_f32_16x16x32_bf16 v[152:155], v[24:27], a[72:75], v[152:155]
s_add_u32 m0, s61, 53248
v_mfma_f32_16x16x32_bf16 v[156:159], v[24:27], a[76:79], v[156:159]
v_mfma_f32_16x16x32_bf16 v[172:175], v[28:31], a[76:79], v[172:175]
ds_read_b64_tr_b16 v[20:21], v10 offset:8192
v_mfma_f32_16x16x32_bf16 v[168:171], v[28:31], a[72:75], v[168:171]
ds_read_b64_tr_b16 v[22:23], v10 offset:8704
v_mfma_f32_16x16x32_bf16 v[164:167], v[28:31], a[68:71], v[164:167]
buffer_load_dwordx4 v1, s[4:7], s68 offen offset:0 lds
v_mfma_f32_16x16x32_bf16 v[160:163], v[28:31], a[64:67], v[160:163]
s_waitcnt lgkmcnt(4)
v_mfma_f32_16x16x32_bf16 v[48:51], v[32:35], a[80:83], v[48:51]
ds_read_b64_tr_b16 v[24:25], v7 offset:10240
v_mfma_f32_16x16x32_bf16 v[52:55], v[32:35], a[84:87], v[52:55]
ds_read_b64_tr_b16 v[26:27], v7 offset:10752
v_mfma_f32_16x16x32_bf16 v[56:59], v[32:35], a[88:91], v[56:59]
v_mfma_f32_16x16x32_bf16 v[60:63], v[32:35], a[92:95], v[60:63]
buffer_load_dwordx4 v2, s[4:7], s69 offen offset:1024 lds
v_mfma_f32_16x16x32_bf16 v[76:79], v[36:39], a[92:95], v[76:79]
ds_read_b64_tr_b16 v[28:29], v8 offset:10240
v_mfma_f32_16x16x32_bf16 v[72:75], v[36:39], a[88:91], v[72:75]
ds_read_b64_tr_b16 v[30:31], v8 offset:10752
v_mfma_f32_16x16x32_bf16 v[68:71], v[36:39], a[84:87], v[68:71]
v_mfma_f32_16x16x32_bf16 v[64:67], v[36:39], a[80:83], v[64:67]
s_waitcnt lgkmcnt(4)
v_mfma_f32_16x16x32_bf16 v[80:83], v[16:19], a[80:83], v[80:83]
ds_read_b64_tr_b16 v[32:33], v9 offset:10240
buffer_load_dwordx4 v1, s[4:7], s70 offen offset:2048 lds
v_mfma_f32_16x16x32_bf16 v[84:87], v[16:19], a[84:87], v[84:87]
ds_read_b64_tr_b16 v[34:35], v9 offset:10752
v_mfma_f32_16x16x32_bf16 v[88:91], v[16:19], a[88:91], v[88:91]
v_mfma_f32_16x16x32_bf16 v[92:95], v[16:19], a[92:95], v[92:95]
v_mfma_f32_16x16x32_bf16 v[108:111], v[20:23], a[92:95], v[108:111]
ds_read_b64_tr_b16 v[36:37], v10 offset:10240
v_mfma_f32_16x16x32_bf16 v[104:107], v[20:23], a[88:91], v[104:107]
ds_read_b64_tr_b16 v[38:39], v10 offset:10752
buffer_load_dwordx4 v2, s[4:7], s71 offen offset:3072 lds
v_mfma_f32_16x16x32_bf16 v[100:103], v[20:23], a[84:87], v[100:103]
v_add_u32 v1, s63, v1
v_add_u32 v2, s63, v2
v_mfma_f32_16x16x32_bf16 v[96:99], v[20:23], a[80:83], v[96:99]
s_waitcnt lgkmcnt(4)
v_mfma_f32_16x16x32_bf16 v[112:115], v[24:27], a[80:83], v[112:115]
v_mfma_f32_16x16x32_bf16 v[116:119], v[24:27], a[84:87], v[116:119]
v_mfma_f32_16x16x32_bf16 v[120:123], v[24:27], a[88:91], v[120:123]
v_mfma_f32_16x16x32_bf16 v[124:127], v[24:27], a[92:95], v[124:127]
v_mfma_f32_16x16x32_bf16 v[140:143], v[28:31], a[92:95], v[140:143]
s_waitcnt vmcnt(12) lgkmcnt(0)
s_barrier
v_add_u32 v7, 4294868992, v7
v_mfma_f32_16x16x32_bf16 v[136:139], v[28:31], a[88:91], v[136:139]
s_add_u32 m0, s62, 98304
v_add_u32 v3, 4294868992, v3
v_mfma_f32_16x16x32_bf16 v[132:135], v[28:31], a[84:87], v[132:135]
ds_read_b64_tr_b16 v[16:17], v7 offset:0
ds_read_b64_tr_b16 v[18:19], v7 offset:512
v_mfma_f32_16x16x32_bf16 v[128:131], v[28:31], a[80:83], v[128:131]
ds_read_b128 a[96:99], v3 offset:0
ds_read_b128 a[100:103], v3 offset:2048
v_mfma_f32_16x16x32_bf16 v[144:147], v[32:35], a[80:83], v[144:147]
ds_read_b128 a[104:107], v3 offset:4096
buffer_load_dwordx4 v5, s[8:11], s72 offen offset:0 lds
v_mfma_f32_16x16x32_bf16 v[148:151], v[32:35], a[84:87], v[148:151]
ds_read_b128 a[108:111], v3 offset:6144
v_add_u32 v8, 4294868992, v8
v_mfma_f32_16x16x32_bf16 v[152:155], v[32:35], a[88:91], v[152:155]
v_add_u32 v4, 4294868992, v4
v_mfma_f32_16x16x32_bf16 v[156:159], v[32:35], a[92:95], v[156:159]
ds_read_b64_tr_b16 v[20:21], v8 offset:0
ds_read_b64_tr_b16 v[22:23], v8 offset:512
v_mfma_f32_16x16x32_bf16 v[172:175], v[36:39], a[92:95], v[172:175]
buffer_load_dwordx4 v6, s[8:11], s73 offen offset:1024 lds
v_add_u32 v9, 4294868992, v9
v_mfma_f32_16x16x32_bf16 v[168:171], v[36:39], a[88:91], v[168:171]
ds_read_b64_tr_b16 v[24:25], v9 offset:0
v_mfma_f32_16x16x32_bf16 v[164:167], v[36:39], a[84:87], v[164:167]
ds_read_b64_tr_b16 v[26:27], v9 offset:512
v_add_u32 v10, 4294868992, v10
v_mfma_f32_16x16x32_bf16 v[160:163], v[36:39], a[80:83], v[160:163]
s_waitcnt lgkmcnt(2)
ds_read_b64_tr_b16 v[28:29], v10 offset:0
v_mfma_f32_16x16x32_bf16 v[48:51], v[16:19], a[96:99], v[48:51]
ds_read_b64_tr_b16 v[30:31], v10 offset:512
v_mfma_f32_16x16x32_bf16 v[52:55], v[16:19], a[100:103], v[52:55]
ds_read_b64_tr_b16 v[32:33], v7 offset:2048
buffer_load_dwordx4 v5, s[12:15], s74 offen offset:2048 lds
v_mfma_f32_16x16x32_bf16 v[56:59], v[16:19], a[104:107], v[56:59]
ds_read_b64_tr_b16 v[34:35], v7 offset:2560
v_mfma_f32_16x16x32_bf16 v[60:63], v[16:19], a[108:111], v[60:63]
ds_read_b128 a[112:115], v4 offset:0
v_mfma_f32_16x16x32_bf16 v[76:79], v[20:23], a[108:111], v[76:79]
ds_read_b128 a[116:119], v4 offset:2048
v_mfma_f32_16x16x32_bf16 v[72:75], v[20:23], a[104:107], v[72:75]
ds_read_b64_tr_b16 v[36:37], v8 offset:2048
v_mfma_f32_16x16x32_bf16 v[68:71], v[20:23], a[100:103], v[68:71]
ds_read_b64_tr_b16 v[38:39], v8 offset:2560
buffer_load_dwordx4 v6, s[12:15], s75 offen offset:3072 lds
v_mfma_f32_16x16x32_bf16 v[64:67], v[20:23], a[96:99], v[64:67]
s_waitcnt lgkmcnt(6)
ds_read_b128 a[120:123], v4 offset:4096
s_add_u32 s78, s1, 128
v_mfma_f32_16x16x32_bf16 v[80:83], v[24:27], a[96:99], v[80:83]
s_sub_u32 s63, s1, 1024
ds_read_b128 a[124:127], v4 offset:6144
s_min_u32 s78, s78, s63
v_mfma_f32_16x16x32_bf16 v[84:87], v[24:27], a[100:103], v[84:87]
s_sub_u32 s63, s78, s1
ds_read_b64_tr_b16 v[16:17], v9 offset:2048
s_mov_b32 s1, s78
v_mfma_f32_16x16x32_bf16 v[88:91], v[24:27], a[104:107], v[88:91]
s_mul_i32 s78, s63, 4608
ds_read_b64_tr_b16 v[18:19], v9 offset:2560
v_add_u32 v5, s78, v5
v_mfma_f32_16x16x32_bf16 v[92:95], v[24:27], a[108:111], v[92:95]
v_add_u32 v6, s78, v6
s_add_u32 m0, s61, 98304
v_mfma_f32_16x16x32_bf16 v[108:111], v[28:31], a[108:111], v[108:111]
ds_read_b64_tr_b16 v[20:21], v10 offset:2048
buffer_load_dwordx4 v1, s[4:7], s64 offen offset:0 lds
v_mfma_f32_16x16x32_bf16 v[104:107], v[28:31], a[104:107], v[104:107]
ds_read_b64_tr_b16 v[22:23], v10 offset:2560
v_mfma_f32_16x16x32_bf16 v[100:103], v[28:31], a[100:103], v[100:103]
v_mfma_f32_16x16x32_bf16 v[96:99], v[28:31], a[96:99], v[96:99]
s_waitcnt lgkmcnt(6)
v_mfma_f32_16x16x32_bf16 v[112:115], v[32:35], a[96:99], v[112:115]
ds_read_b64_tr_b16 v[24:25], v7 offset:8192
buffer_load_dwordx4 v2, s[4:7], s65 offen offset:1024 lds
v_mfma_f32_16x16x32_bf16 v[116:119], v[32:35], a[100:103], v[116:119]
ds_read_b64_tr_b16 v[26:27], v7 offset:8704
v_mfma_f32_16x16x32_bf16 v[120:123], v[32:35], a[104:107], v[120:123]
v_mfma_f32_16x16x32_bf16 v[124:127], v[32:35], a[108:111], v[124:127]
v_mfma_f32_16x16x32_bf16 v[140:143], v[36:39], a[108:111], v[140:143]
ds_read_b64_tr_b16 v[28:29], v8 offset:8192
v_mfma_f32_16x16x32_bf16 v[136:139], v[36:39], a[104:107], v[136:139]
ds_read_b64_tr_b16 v[30:31], v8 offset:8704
buffer_load_dwordx4 v1, s[4:7], s66 offen offset:2048 lds
v_mfma_f32_16x16x32_bf16 v[132:135], v[36:39], a[100:103], v[132:135]
v_mfma_f32_16x16x32_bf16 v[128:131], v[36:39], a[96:99], v[128:131]
s_waitcnt lgkmcnt(4)
v_mfma_f32_16x16x32_bf16 v[144:147], v[16:19], a[96:99], v[144:147]
ds_read_b64_tr_b16 v[32:33], v9 offset:8192
v_mfma_f32_16x16x32_bf16 v[148:151], v[16:19], a[100:103], v[148:151]
ds_read_b64_tr_b16 v[34:35], v9 offset:8704
buffer_load_dwordx4 v2, s[4:7], s67 offen offset:3072 lds
v_mfma_f32_16x16x32_bf16 v[152:155], v[16:19], a[104:107], v[152:155]
s_add_u32 m0, s61, 102400
v_mfma_f32_16x16x32_bf16 v[156:159], v[16:19], a[108:111], v[156:159]
v_mfma_f32_16x16x32_bf16 v[172:175], v[20:23], a[108:111], v[172:175]
ds_read_b64_tr_b16 v[36:37], v10 offset:8192
v_mfma_f32_16x16x32_bf16 v[168:171], v[20:23], a[104:107], v[168:171]
ds_read_b64_tr_b16 v[38:39], v10 offset:8704
v_mfma_f32_16x16x32_bf16 v[164:167], v[20:23], a[100:103], v[164:167]
buffer_load_dwordx4 v1, s[4:7], s68 offen offset:0 lds
v_mfma_f32_16x16x32_bf16 v[160:163], v[20:23], a[96:99], v[160:163]
s_waitcnt lgkmcnt(4)
v_mfma_f32_16x16x32_bf16 v[48:51], v[24:27], a[112:115], v[48:51]
ds_read_b64_tr_b16 v[16:17], v7 offset:10240
v_mfma_f32_16x16x32_bf16 v[52:55], v[24:27], a[116:119], v[52:55]
ds_read_b64_tr_b16 v[18:19], v7 offset:10752
v_mfma_f32_16x16x32_bf16 v[56:59], v[24:27], a[120:123], v[56:59]
v_mfma_f32_16x16x32_bf16 v[60:63], v[24:27], a[124:127], v[60:63]
buffer_load_dwordx4 v2, s[4:7], s69 offen offset:1024 lds
v_mfma_f32_16x16x32_bf16 v[76:79], v[28:31], a[124:127], v[76:79]
ds_read_b64_tr_b16 v[20:21], v8 offset:10240
v_mfma_f32_16x16x32_bf16 v[72:75], v[28:31], a[120:123], v[72:75]
ds_read_b64_tr_b16 v[22:23], v8 offset:10752
v_mfma_f32_16x16x32_bf16 v[68:71], v[28:31], a[116:119], v[68:71]
v_mfma_f32_16x16x32_bf16 v[64:67], v[28:31], a[112:115], v[64:67]
s_waitcnt lgkmcnt(4)
v_mfma_f32_16x16x32_bf16 v[80:83], v[32:35], a[112:115], v[80:83]
ds_read_b64_tr_b16 v[24:25], v9 offset:10240
buffer_load_dwordx4 v1, s[4:7], s70 offen offset:2048 lds
v_mfma_f32_16x16x32_bf16 v[84:87], v[32:35], a[116:119], v[84:87]
ds_read_b64_tr_b16 v[26:27], v9 offset:10752
v_mfma_f32_16x16x32_bf16 v[88:91], v[32:35], a[120:123], v[88:91]
v_mfma_f32_16x16x32_bf16 v[92:95], v[32:35], a[124:127], v[92:95]
v_mfma_f32_16x16x32_bf16 v[108:111], v[36:39], a[124:127], v[108:111]
ds_read_b64_tr_b16 v[28:29], v10 offset:10240
v_mfma_f32_16x16x32_bf16 v[104:107], v[36:39], a[120:123], v[104:107]
ds_read_b64_tr_b16 v[30:31], v10 offset:10752
buffer_load_dwordx4 v2, s[4:7], s71 offen offset:3072 lds
v_mfma_f32_16x16x32_bf16 v[100:103], v[36:39], a[116:119], v[100:103]
v_add_u32 v1, s63, v1
v_add_u32 v2, s63, v2
v_mfma_f32_16x16x32_bf16 v[96:99], v[36:39], a[112:115], v[96:99]
s_waitcnt lgkmcnt(4)
v_mfma_f32_16x16x32_bf16 v[112:115], v[16:19], a[112:115], v[112:115]
v_mfma_f32_16x16x32_bf16 v[116:119], v[16:19], a[116:119], v[116:119]
v_mfma_f32_16x16x32_bf16 v[120:123], v[16:19], a[120:123], v[120:123]
v_mfma_f32_16x16x32_bf16 v[124:127], v[16:19], a[124:127], v[124:127]
v_mfma_f32_16x16x32_bf16 v[140:143], v[20:23], a[124:127], v[140:143]
s_waitcnt vmcnt(12) lgkmcnt(0)
s_barrier
v_add_u32 v7, 49152, v7
v_mfma_f32_16x16x32_bf16 v[136:139], v[20:23], a[120:123], v[136:139]
s_add_u32 m0, s62, 0
v_add_u32 v3, 49152, v3
v_mul_u32_u24 v44, 3641, v180
v_mfma_f32_16x16x32_bf16 v[132:135], v[20:23], a[116:119], v[132:135]
ds_read_b64_tr_b16 v[32:33], v7 offset:0
ds_read_b64_tr_b16 v[34:35], v7 offset:512
v_mfma_f32_16x16x32_bf16 v[128:131], v[20:23], a[112:115], v[128:131]
ds_read_b128 a[128:131], v3 offset:0
ds_read_b128 a[132:135], v3 offset:2048
v_mfma_f32_16x16x32_bf16 v[144:147], v[24:27], a[112:115], v[144:147]
ds_read_b128 a[136:139], v3 offset:4096
buffer_load_dwordx4 v5, s[8:11], s72 offen offset:0 lds
v_mfma_f32_16x16x32_bf16 v[148:151], v[24:27], a[116:119], v[148:151]
ds_read_b128 a[140:143], v3 offset:6144
v_add_u32 v8, 49152, v8
v_mfma_f32_16x16x32_bf16 v[152:155], v[24:27], a[120:123], v[152:155]
v_add_u32 v4, 49152, v4
v_lshrrev_b32 v44, 16, v44
v_mfma_f32_16x16x32_bf16 v[156:159], v[24:27], a[124:127], v[156:159]
ds_read_b64_tr_b16 v[36:37], v8 offset:0
ds_read_b64_tr_b16 v[38:39], v8 offset:512
v_mfma_f32_16x16x32_bf16 v[172:175], v[28:31], a[124:127], v[172:175]
buffer_load_dwordx4 v6, s[8:11], s73 offen offset:1024 lds
v_add_u32 v9, 49152, v9
v_mfma_f32_16x16x32_bf16 v[168:171], v[28:31], a[120:123], v[168:171]
ds_read_b64_tr_b16 v[16:17], v9 offset:0
v_lshlrev_b32 v44, 2, v44
v_mfma_f32_16x16x32_bf16 v[164:167], v[28:31], a[116:119], v[164:167]
ds_read_b64_tr_b16 v[18:19], v9 offset:512
v_add_u32 v10, 49152, v10
v_mfma_f32_16x16x32_bf16 v[160:163], v[28:31], a[112:115], v[160:163]
s_waitcnt lgkmcnt(2)
ds_read_b64_tr_b16 v[20:21], v10 offset:0
v_lshl_add_u32 v44, v180, 1, v44
v_mfma_f32_16x16x32_bf16 v[48:51], v[32:35], a[128:131], v[48:51]
ds_read_b64_tr_b16 v[22:23], v10 offset:512
v_add_u32 v44, 162016, v44
v_mfma_f32_16x16x32_bf16 v[52:55], v[32:35], a[132:135], v[52:55]
ds_read_b64_tr_b16 v[24:25], v7 offset:2048
buffer_load_dwordx4 v5, s[12:15], s74 offen offset:2048 lds
v_mfma_f32_16x16x32_bf16 v[56:59], v[32:35], a[136:139], v[56:59]
ds_read_b64_tr_b16 v[26:27], v7 offset:2560
v_xor_b32 v45, 0x8000, v178
v_mfma_f32_16x16x32_bf16 v[60:63], v[32:35], a[140:143], v[60:63]
ds_read_b128 a[144:147], v4 offset:0
v_mfma_f32_16x16x32_bf16 v[76:79], v[36:39], a[140:143], v[76:79]
ds_read_b128 a[148:151], v4 offset:2048
v_mfma_f32_16x16x32_bf16 v[72:75], v[36:39], a[136:139], v[72:75]
ds_read_b64_tr_b16 v[28:29], v8 offset:2048
v_mfma_f32_16x16x32_bf16 v[68:71], v[36:39], a[132:135], v[68:71]
ds_read_b64_tr_b16 v[30:31], v8 offset:2560
buffer_load_dwordx4 v6, s[12:15], s75 offen offset:3072 lds
v_mfma_f32_16x16x32_bf16 v[64:67], v[36:39], a[128:131], v[64:67]
s_waitcnt lgkmcnt(6)
ds_read_b128 a[152:155], v4 offset:4096
s_add_u32 s78, s1, 128
v_mfma_f32_16x16x32_bf16 v[80:83], v[16:19], a[128:131], v[80:83]
s_sub_u32 s63, s1, 1024
ds_read_b128 a[156:159], v4 offset:6144
s_min_u32 s78, s78, s63
v_mfma_f32_16x16x32_bf16 v[84:87], v[16:19], a[132:135], v[84:87]
s_sub_u32 s63, s78, s1
ds_read_b64_tr_b16 v[32:33], v9 offset:2048
s_mov_b32 s1, s78
v_mfma_f32_16x16x32_bf16 v[88:91], v[16:19], a[136:139], v[88:91]
s_mul_i32 s78, s63, 4608
ds_read_b64_tr_b16 v[34:35], v9 offset:2560
v_add_u32 v5, s78, v5
v_mfma_f32_16x16x32_bf16 v[92:95], v[16:19], a[140:143], v[92:95]
ds_write_b16 v44, v178
v_add_u32 v6, s78, v6
v_mfma_f32_16x16x32_bf16 v[108:111], v[20:23], a[140:143], v[108:111]
s_add_u32 m0, s61, 0
ds_read_b64_tr_b16 v[36:37], v10 offset:2048
buffer_load_dwordx4 v1, s[4:7], s64 offen offset:0 lds
v_mfma_f32_16x16x32_bf16 v[104:107], v[20:23], a[136:139], v[104:107]
ds_read_b64_tr_b16 v[38:39], v10 offset:2560
v_mfma_f32_16x16x32_bf16 v[100:103], v[20:23], a[132:135], v[100:103]
ds_write_b16 v44, v45 offset:720
v_mul_u32_u24 v44, 3641, v177
v_mfma_f32_16x16x32_bf16 v[96:99], v[20:23], a[128:131], v[96:99]
s_waitcnt lgkmcnt(8)
v_lshrrev_b32 v44, 16, v44
v_lshlrev_b32 v44, 2, v44
v_mfma_f32_16x16x32_bf16 v[112:115], v[24:27], a[128:131], v[112:115]
ds_read_b64_tr_b16 v[16:17], v7 offset:8192
buffer_load_dwordx4 v2, s[4:7], s65 offen offset:1024 lds
v_mfma_f32_16x16x32_bf16 v[116:119], v[24:27], a[132:135], v[116:119]
ds_read_b64_tr_b16 v[18:19], v7 offset:8704
v_lshl_add_u32 v44, v177, 1, v44
v_mfma_f32_16x16x32_bf16 v[120:123], v[24:27], a[136:139], v[120:123]
v_add_u32 v44, 162016, v44
v_xor_b32 v45, 0x8000, v179
v_mfma_f32_16x16x32_bf16 v[124:127], v[24:27], a[140:143], v[124:127]
ds_write_b16 v44, v179
v_mfma_f32_16x16x32_bf16 v[140:143], v[28:31], a[140:143], v[140:143]
ds_read_b64_tr_b16 v[20:21], v8 offset:8192
v_mfma_f32_16x16x32_bf16 v[136:139], v[28:31], a[136:139], v[136:139]
ds_read_b64_tr_b16 v[22:23], v8 offset:8704
buffer_load_dwordx4 v1, s[4:7], s66 offen offset:2048 lds
v_mfma_f32_16x16x32_bf16 v[132:135], v[28:31], a[132:135], v[132:135]
ds_write_b16 v44, v45 offset:720
v_min_u32 v44, 35, v180
v_mfma_f32_16x16x32_bf16 v[128:131], v[28:31], a[128:131], v[128:131]
s_waitcnt lgkmcnt(7)
v_mul_u32_u24 v44, 40, v44
v_add_u32 v44, 162052, v44
v_mfma_f32_16x16x32_bf16 v[144:147], v[32:35], a[128:131], v[144:147]
ds_read_b64_tr_b16 v[24:25], v9 offset:8192
v_min_u32 v45, 9, v180
v_mfma_f32_16x16x32_bf16 v[148:151], v[32:35], a[132:135], v[148:151]
ds_read_b64_tr_b16 v[26:27], v9 offset:8704
buffer_load_dwordx4 v2, s[4:7], s67 offen offset:3072 lds
v_mfma_f32_16x16x32_bf16 v[152:155], v[32:35], a[136:139], v[152:155]
s_add_u32 m0, s61, 4096
v_lshlrev_b32 v45, 2, v45
v_add_u32 v45, 163456, v45
v_mfma_f32_16x16x32_bf16 v[156:159], v[32:35], a[140:143], v[156:159]
ds_write_b32 v44, v181
v_mfma_f32_16x16x32_bf16 v[172:175], v[36:39], a[140:143], v[172:175]
ds_read_b64_tr_b16 v[28:29], v10 offset:8192
v_mfma_f32_16x16x32_bf16 v[168:171], v[36:39], a[136:139], v[168:171]
ds_read_b64_tr_b16 v[30:31], v10 offset:8704
v_mfma_f32_16x16x32_bf16 v[164:167], v[36:39], a[132:135], v[164:167]
buffer_load_dwordx4 v1, s[4:7], s68 offen offset:0 lds
ds_write_b32 v45, v181
v_mfma_f32_16x16x32_bf16 v[160:163], v[36:39], a[128:131], v[160:163]
s_waitcnt lgkmcnt(7)
v_mfma_f32_16x16x32_bf16 v[48:51], v[16:19], a[144:147], v[48:51]
ds_read_b64_tr_b16 v[32:33], v7 offset:10240
v_mfma_f32_16x16x32_bf16 v[52:55], v[16:19], a[148:151], v[52:55]
ds_read_b64_tr_b16 v[34:35], v7 offset:10752
v_mfma_f32_16x16x32_bf16 v[56:59], v[16:19], a[152:155], v[56:59]
v_mfma_f32_16x16x32_bf16 v[60:63], v[16:19], a[156:159], v[60:63]
buffer_load_dwordx4 v2, s[4:7], s69 offen offset:1024 lds
v_mfma_f32_16x16x32_bf16 v[76:79], v[20:23], a[156:159], v[76:79]
ds_read_b64_tr_b16 v[36:37], v8 offset:10240
v_mfma_f32_16x16x32_bf16 v[72:75], v[20:23], a[152:155], v[72:75]
ds_read_b64_tr_b16 v[38:39], v8 offset:10752
v_mfma_f32_16x16x32_bf16 v[68:71], v[20:23], a[148:151], v[68:71]
v_mfma_f32_16x16x32_bf16 v[64:67], v[20:23], a[144:147], v[64:67]
s_waitcnt lgkmcnt(5)
v_mfma_f32_16x16x32_bf16 v[80:83], v[24:27], a[144:147], v[80:83]
ds_read_b64_tr_b16 v[16:17], v9 offset:10240
buffer_load_dwordx4 v1, s[4:7], s70 offen offset:2048 lds
v_mfma_f32_16x16x32_bf16 v[84:87], v[24:27], a[148:151], v[84:87]
ds_read_b64_tr_b16 v[18:19], v9 offset:10752
v_mfma_f32_16x16x32_bf16 v[88:91], v[24:27], a[152:155], v[88:91]
v_mfma_f32_16x16x32_bf16 v[92:95], v[24:27], a[156:159], v[92:95]
v_mfma_f32_16x16x32_bf16 v[108:111], v[28:31], a[156:159], v[108:111]
ds_read_b64_tr_b16 v[20:21], v10 offset:10240
v_mfma_f32_16x16x32_bf16 v[104:107], v[28:31], a[152:155], v[104:107]
ds_read_b64_tr_b16 v[22:23], v10 offset:10752
buffer_load_dwordx4 v2, s[4:7], s71 offen offset:3072 lds
v_mfma_f32_16x16x32_bf16 v[100:103], v[28:31], a[148:151], v[100:103]
v_add_u32 v1, s63, v1
v_add_u32 v2, s63, v2
v_mfma_f32_16x16x32_bf16 v[96:99], v[28:31], a[144:147], v[96:99]
s_waitcnt lgkmcnt(4)
v_mfma_f32_16x16x32_bf16 v[112:115], v[32:35], a[144:147], v[112:115]
v_mfma_f32_16x16x32_bf16 v[116:119], v[32:35], a[148:151], v[116:119]
v_mfma_f32_16x16x32_bf16 v[120:123], v[32:35], a[152:155], v[120:123]
v_mfma_f32_16x16x32_bf16 v[124:127], v[32:35], a[156:159], v[124:127]
v_mfma_f32_16x16x32_bf16 v[140:143], v[36:39], a[156:159], v[140:143]
s_waitcnt vmcnt(12) lgkmcnt(0)
s_barrier
buffer_load_dword v176, v181, s[36:39], 16 offen sc1
v_mfma_f32_16x16x32_bf16 v[136:139], v[36:39], a[152:155], v[136:139]
s_add_u32 m0, s62, 49152
v_add_u32 v7, 49152, v7
v_add_u32 v3, 49152, v3
v_mfma_f32_16x16x32_bf16 v[132:135], v[36:39], a[148:151], v[132:135]
ds_read_b64_tr_b16 v[24:25], v7 offset:0
ds_read_b64_tr_b16 v[26:27], v7 offset:512
v_mfma_f32_16x16x32_bf16 v[128:131], v[36:39], a[144:147], v[128:131]
ds_read_b128 a[160:163], v3 offset:0
ds_read_b128 a[164:167], v3 offset:2048
v_mfma_f32_16x16x32_bf16 v[144:147], v[16:19], a[144:147], v[144:147]
ds_read_b128 a[168:171], v3 offset:4096
buffer_load_dwordx4 v5, s[8:11], s72 offen offset:0 lds
v_mfma_f32_16x16x32_bf16 v[148:151], v[16:19], a[148:151], v[148:151]
ds_read_b128 a[172:175], v3 offset:6144
v_add_u32 v8, 49152, v8
v_mfma_f32_16x16x32_bf16 v[152:155], v[16:19], a[152:155], v[152:155]
v_add_u32 v4, 49152, v4
v_mfma_f32_16x16x32_bf16 v[156:159], v[16:19], a[156:159], v[156:159]
ds_read_b64_tr_b16 v[28:29], v8 offset:0
ds_read_b64_tr_b16 v[30:31], v8 offset:512
v_mfma_f32_16x16x32_bf16 v[172:175], v[20:23], a[156:159], v[172:175]
buffer_load_dwordx4 v6, s[8:11], s73 offen offset:1024 lds
v_add_u32 v9, 49152, v9
v_mfma_f32_16x16x32_bf16 v[168:171], v[20:23], a[152:155], v[168:171]
ds_read_b64_tr_b16 v[32:33], v9 offset:0
v_mfma_f32_16x16x32_bf16 v[164:167], v[20:23], a[148:151], v[164:167]
ds_read_b64_tr_b16 v[34:35], v9 offset:512
v_add_u32 v10, 49152, v10
v_mfma_f32_16x16x32_bf16 v[160:163], v[20:23], a[144:147], v[160:163]
s_waitcnt lgkmcnt(2)
ds_read_b64_tr_b16 v[36:37], v10 offset:0
v_mfma_f32_16x16x32_bf16 v[48:51], v[24:27], a[160:163], v[48:51]
ds_read_b64_tr_b16 v[38:39], v10 offset:512
v_mfma_f32_16x16x32_bf16 v[52:55], v[24:27], a[164:167], v[52:55]
ds_read_b64_tr_b16 v[16:17], v7 offset:2048
buffer_load_dwordx4 v5, s[12:15], s74 offen offset:2048 lds
v_mfma_f32_16x16x32_bf16 v[56:59], v[24:27], a[168:171], v[56:59]
ds_read_b64_tr_b16 v[18:19], v7 offset:2560
v_mfma_f32_16x16x32_bf16 v[60:63], v[24:27], a[172:175], v[60:63]
ds_read_b128 a[176:179], v4 offset:0
v_mfma_f32_16x16x32_bf16 v[76:79], v[28:31], a[172:175], v[76:79]
ds_read_b128 a[180:183], v4 offset:2048
v_mfma_f32_16x16x32_bf16 v[72:75], v[28:31], a[168:171], v[72:75]
ds_read_b64_tr_b16 v[20:21], v8 offset:2048
v_mfma_f32_16x16x32_bf16 v[68:71], v[28:31], a[164:167], v[68:71]
ds_read_b64_tr_b16 v[22:23], v8 offset:2560
buffer_load_dwordx4 v6, s[12:15], s75 offen offset:3072 lds
v_mfma_f32_16x16x32_bf16 v[64:67], v[28:31], a[160:163], v[64:67]
s_waitcnt lgkmcnt(6)
ds_read_b128 a[184:187], v4 offset:4096
s_add_u32 s78, s1, 128
v_mfma_f32_16x16x32_bf16 v[80:83], v[32:35], a[160:163], v[80:83]
s_sub_u32 s63, s1, 1024
ds_read_b128 a[188:191], v4 offset:6144
s_min_u32 s78, s78, s63
v_mfma_f32_16x16x32_bf16 v[84:87], v[32:35], a[164:167], v[84:87]
s_sub_u32 s63, s78, s1
ds_read_b64_tr_b16 v[24:25], v9 offset:2048
s_mov_b32 s1, s78
v_mfma_f32_16x16x32_bf16 v[88:91], v[32:35], a[168:171], v[88:91]
s_mul_i32 s78, s63, 4608
ds_read_b64_tr_b16 v[26:27], v9 offset:2560
v_add_u32 v5, s78, v5
v_mfma_f32_16x16x32_bf16 v[92:95], v[32:35], a[172:175], v[92:95]
v_add_u32 v6, s78, v6
s_add_u32 m0, s61, 49152
v_mfma_f32_16x16x32_bf16 v[108:111], v[36:39], a[172:175], v[108:111]
ds_read_b64_tr_b16 v[28:29], v10 offset:2048
buffer_load_dwordx4 v1, s[4:7], s64 offen offset:0 lds
v_mfma_f32_16x16x32_bf16 v[104:107], v[36:39], a[168:171], v[104:107]
ds_read_b64_tr_b16 v[30:31], v10 offset:2560
v_mfma_f32_16x16x32_bf16 v[100:103], v[36:39], a[164:167], v[100:103]
v_mfma_f32_16x16x32_bf16 v[96:99], v[36:39], a[160:163], v[96:99]
s_waitcnt lgkmcnt(6)
v_mfma_f32_16x16x32_bf16 v[112:115], v[16:19], a[160:163], v[112:115]
ds_read_b64_tr_b16 v[32:33], v7 offset:8192
buffer_load_dwordx4 v2, s[4:7], s65 offen offset:1024 lds
v_mfma_f32_16x16x32_bf16 v[116:119], v[16:19], a[164:167], v[116:119]
ds_read_b64_tr_b16 v[34:35], v7 offset:8704
v_mfma_f32_16x16x32_bf16 v[120:123], v[16:19], a[168:171], v[120:123]
v_mfma_f32_16x16x32_bf16 v[124:127], v[16:19], a[172:175], v[124:127]
v_mfma_f32_16x16x32_bf16 v[140:143], v[20:23], a[172:175], v[140:143]
ds_read_b64_tr_b16 v[36:37], v8 offset:8192
v_mfma_f32_16x16x32_bf16 v[136:139], v[20:23], a[168:171], v[136:139]
ds_read_b64_tr_b16 v[38:39], v8 offset:8704
buffer_load_dwordx4 v1, s[4:7], s66 offen offset:2048 lds
v_mfma_f32_16x16x32_bf16 v[132:135], v[20:23], a[164:167], v[132:135]
v_mfma_f32_16x16x32_bf16 v[128:131], v[20:23], a[160:163], v[128:131]
s_waitcnt lgkmcnt(4)
v_mfma_f32_16x16x32_bf16 v[144:147], v[24:27], a[160:163], v[144:147]
ds_read_b64_tr_b16 v[16:17], v9 offset:8192
v_mfma_f32_16x16x32_bf16 v[148:151], v[24:27], a[164:167], v[148:151]
ds_read_b64_tr_b16 v[18:19], v9 offset:8704
buffer_load_dwordx4 v2, s[4:7], s67 offen offset:3072 lds
v_mfma_f32_16x16x32_bf16 v[152:155], v[24:27], a[168:171], v[152:155]
s_add_u32 m0, s61, 53248
v_mfma_f32_16x16x32_bf16 v[156:159], v[24:27], a[172:175], v[156:159]
v_mfma_f32_16x16x32_bf16 v[172:175], v[28:31], a[172:175], v[172:175]
ds_read_b64_tr_b16 v[20:21], v10 offset:8192
v_mfma_f32_16x16x32_bf16 v[168:171], v[28:31], a[168:171], v[168:171]
ds_read_b64_tr_b16 v[22:23], v10 offset:8704
v_mfma_f32_16x16x32_bf16 v[164:167], v[28:31], a[164:167], v[164:167]
buffer_load_dwordx4 v1, s[4:7], s68 offen offset:0 lds
v_mfma_f32_16x16x32_bf16 v[160:163], v[28:31], a[160:163], v[160:163]
s_waitcnt lgkmcnt(4)
v_mfma_f32_16x16x32_bf16 v[48:51], v[32:35], a[176:179], v[48:51]
ds_read_b64_tr_b16 v[24:25], v7 offset:10240
v_mfma_f32_16x16x32_bf16 v[52:55], v[32:35], a[180:183], v[52:55]
ds_read_b64_tr_b16 v[26:27], v7 offset:10752
v_mfma_f32_16x16x32_bf16 v[56:59], v[32:35], a[184:187], v[56:59]
v_mfma_f32_16x16x32_bf16 v[60:63], v[32:35], a[188:191], v[60:63]
buffer_load_dwordx4 v2, s[4:7], s69 offen offset:1024 lds
v_mfma_f32_16x16x32_bf16 v[76:79], v[36:39], a[188:191], v[76:79]
ds_read_b64_tr_b16 v[28:29], v8 offset:10240
v_mfma_f32_16x16x32_bf16 v[72:75], v[36:39], a[184:187], v[72:75]
ds_read_b64_tr_b16 v[30:31], v8 offset:10752
v_mfma_f32_16x16x32_bf16 v[68:71], v[36:39], a[180:183], v[68:71]
v_mfma_f32_16x16x32_bf16 v[64:67], v[36:39], a[176:179], v[64:67]
s_waitcnt lgkmcnt(4)
v_mfma_f32_16x16x32_bf16 v[80:83], v[16:19], a[176:179], v[80:83]
ds_read_b64_tr_b16 v[32:33], v9 offset:10240
buffer_load_dwordx4 v1, s[4:7], s70 offen offset:2048 lds
v_mfma_f32_16x16x32_bf16 v[84:87], v[16:19], a[180:183], v[84:87]
ds_read_b64_tr_b16 v[34:35], v9 offset:10752
v_mfma_f32_16x16x32_bf16 v[88:91], v[16:19], a[184:187], v[88:91]
v_mfma_f32_16x16x32_bf16 v[92:95], v[16:19], a[188:191], v[92:95]
v_mfma_f32_16x16x32_bf16 v[108:111], v[20:23], a[188:191], v[108:111]
ds_read_b64_tr_b16 v[36:37], v10 offset:10240
v_mfma_f32_16x16x32_bf16 v[104:107], v[20:23], a[184:187], v[104:107]
ds_read_b64_tr_b16 v[38:39], v10 offset:10752
buffer_load_dwordx4 v2, s[4:7], s71 offen offset:3072 lds
v_mfma_f32_16x16x32_bf16 v[100:103], v[20:23], a[180:183], v[100:103]
v_add_u32 v1, s63, v1
v_add_u32 v2, s63, v2
v_mfma_f32_16x16x32_bf16 v[96:99], v[20:23], a[176:179], v[96:99]
s_waitcnt lgkmcnt(4)
v_mfma_f32_16x16x32_bf16 v[112:115], v[24:27], a[176:179], v[112:115]
v_mfma_f32_16x16x32_bf16 v[116:119], v[24:27], a[180:183], v[116:119]
v_mfma_f32_16x16x32_bf16 v[120:123], v[24:27], a[184:187], v[120:123]
v_mfma_f32_16x16x32_bf16 v[124:127], v[24:27], a[188:191], v[124:127]
v_mfma_f32_16x16x32_bf16 v[140:143], v[28:31], a[188:191], v[140:143]
s_waitcnt vmcnt(13) lgkmcnt(0)
s_barrier
v_add_u32 v7, 4294868992, v7
v_mfma_f32_16x16x32_bf16 v[136:139], v[28:31], a[184:187], v[136:139]
s_add_u32 m0, s62, 98304
v_add_u32 v3, 4294868992, v3
v_and_b32 v11, 7, v14
v_mfma_f32_16x16x32_bf16 v[132:135], v[28:31], a[180:183], v[132:135]
s_mul_i32 s82, s52, 110592
ds_read_b64_tr_b16 v[16:17], v7 offset:0
ds_read_b64_tr_b16 v[18:19], v7 offset:512
v_mfma_f32_16x16x32_bf16 v[128:131], v[28:31], a[176:179], v[128:131]
s_add_u32 s82, s82, 36700160
ds_read_b128 a[192:195], v3 offset:0
ds_read_b128 a[196:199], v3 offset:2048
v_mfma_f32_16x16x32_bf16 v[144:147], v[32:35], a[176:179], v[144:147]
s_lshl_b32 s83, s52, 7
ds_read_b128 a[200:203], v3 offset:4096
buffer_load_dwordx4 v5, s[8:11], s72 offen offset:0 lds
v_mfma_f32_16x16x32_bf16 v[148:151], v[32:35], a[180:183], v[148:151]
s_lshl_b32 s87, s50, 2
ds_read_b128 a[204:207], v3 offset:6144
v_add_u32 v8, 4294868992, v8
v_mfma_f32_16x16x32_bf16 v[152:155], v[32:35], a[184:187], v[152:155]
s_add_u32 s86, s83, s87
v_add_u32 v4, 4294868992, v4
v_lshlrev_b32 v11, 2, v11
v_mfma_f32_16x16x32_bf16 v[156:159], v[32:35], a[188:191], v[156:159]
ds_read_b64_tr_b16 v[20:21], v8 offset:0
ds_read_b64_tr_b16 v[22:23], v8 offset:512
v_mfma_f32_16x16x32_bf16 v[172:175], v[36:39], a[188:191], v[172:175]
buffer_load_dwordx4 v6, s[8:11], s73 offen offset:1024 lds
v_add_u32 v9, 4294868992, v9
v_mfma_f32_16x16x32_bf16 v[168:171], v[36:39], a[184:187], v[168:171]
ds_read_b64_tr_b16 v[24:25], v9 offset:0
v_mfma_f32_16x16x32_bf16 v[164:167], v[36:39], a[180:183], v[164:167]
ds_read_b64_tr_b16 v[26:27], v9 offset:512
v_add_u32 v10, 4294868992, v10
v_mfma_f32_16x16x32_bf16 v[160:163], v[36:39], a[176:179], v[160:163]
s_waitcnt lgkmcnt(2)
ds_read_b64_tr_b16 v[28:29], v10 offset:0
v_mfma_f32_16x16x32_bf16 v[48:51], v[16:19], a[192:195], v[48:51]
ds_read_b64_tr_b16 v[30:31], v10 offset:512
v_mfma_f32_16x16x32_bf16 v[52:55], v[16:19], a[196:199], v[52:55]
ds_read_b64_tr_b16 v[32:33], v7 offset:2048
buffer_load_dwordx4 v5, s[12:15], s74 offen offset:2048 lds
v_mfma_f32_16x16x32_bf16 v[56:59], v[16:19], a[200:203], v[56:59]
ds_read_b64_tr_b16 v[34:35], v7 offset:2560
v_mfma_f32_16x16x32_bf16 v[60:63], v[16:19], a[204:207], v[60:63]
ds_read_b128 a[208:211], v4 offset:0
v_mfma_f32_16x16x32_bf16 v[76:79], v[20:23], a[204:207], v[76:79]
ds_read_b128 a[212:215], v4 offset:2048
v_mfma_f32_16x16x32_bf16 v[72:75], v[20:23], a[200:203], v[72:75]
ds_read_b64_tr_b16 v[36:37], v8 offset:2048
v_mfma_f32_16x16x32_bf16 v[68:71], v[20:23], a[196:199], v[68:71]
ds_read_b64_tr_b16 v[38:39], v8 offset:2560
buffer_load_dwordx4 v6, s[12:15], s75 offen offset:3072 lds
v_mfma_f32_16x16x32_bf16 v[64:67], v[20:23], a[192:195], v[64:67]
s_waitcnt lgkmcnt(6)
ds_read_b128 a[216:219], v4 offset:4096
s_add_u32 s78, s1, 128
v_mfma_f32_16x16x32_bf16 v[80:83], v[24:27], a[192:195], v[80:83]
s_sub_u32 s63, s1, 1024
ds_read_b128 a[220:223], v4 offset:6144
s_min_u32 s78, s78, s63
v_mfma_f32_16x16x32_bf16 v[84:87], v[24:27], a[196:199], v[84:87]
s_sub_u32 s63, s78, s1
ds_read_b64_tr_b16 v[16:17], v9 offset:2048
s_mov_b32 s1, s78
v_mfma_f32_16x16x32_bf16 v[88:91], v[24:27], a[200:203], v[88:91]
s_mul_i32 s78, s63, 4608
ds_read_b64_tr_b16 v[18:19], v9 offset:2560
v_add_u32 v5, s78, v5
v_mfma_f32_16x16x32_bf16 v[92:95], v[24:27], a[204:207], v[92:95]
v_add_u32 v6, s78, v6
s_add_u32 m0, s61, 98304
v_mfma_f32_16x16x32_bf16 v[108:111], v[28:31], a[204:207], v[108:111]
ds_read_b64_tr_b16 v[20:21], v10 offset:2048
buffer_load_dwordx4 v1, s[4:7], s64 offen offset:0 lds
v_mfma_f32_16x16x32_bf16 v[104:107], v[28:31], a[200:203], v[104:107]
ds_read_b64_tr_b16 v[22:23], v10 offset:2560
v_mfma_f32_16x16x32_bf16 v[100:103], v[28:31], a[196:199], v[100:103]
v_mfma_f32_16x16x32_bf16 v[96:99], v[28:31], a[192:195], v[96:99]
s_waitcnt lgkmcnt(6)
v_mfma_f32_16x16x32_bf16 v[112:115], v[32:35], a[192:195], v[112:115]
ds_read_b64_tr_b16 v[24:25], v7 offset:8192
buffer_load_dwordx4 v2, s[4:7], s65 offen offset:1024 lds
v_mfma_f32_16x16x32_bf16 v[116:119], v[32:35], a[196:199], v[116:119]
ds_read_b64_tr_b16 v[26:27], v7 offset:8704
v_mfma_f32_16x16x32_bf16 v[120:123], v[32:35], a[200:203], v[120:123]
v_mfma_f32_16x16x32_bf16 v[124:127], v[32:35], a[204:207], v[124:127]
v_mfma_f32_16x16x32_bf16 v[140:143], v[36:39], a[204:207], v[140:143]
ds_read_b64_tr_b16 v[28:29], v8 offset:8192
v_mfma_f32_16x16x32_bf16 v[136:139], v[36:39], a[200:203], v[136:139]
ds_read_b64_tr_b16 v[30:31], v8 offset:8704
buffer_load_dwordx4 v1, s[4:7], s66 offen offset:2048 lds
v_mfma_f32_16x16x32_bf16 v[132:135], v[36:39], a[196:199], v[132:135]
v_mfma_f32_16x16x32_bf16 v[128:131], v[36:39], a[192:195], v[128:131]
s_waitcnt lgkmcnt(4)
v_mfma_f32_16x16x32_bf16 v[144:147], v[16:19], a[192:195], v[144:147]
ds_read_b64_tr_b16 v[32:33], v9 offset:8192
v_mfma_f32_16x16x32_bf16 v[148:151], v[16:19], a[196:199], v[148:151]
ds_read_b64_tr_b16 v[34:35], v9 offset:8704
buffer_load_dwordx4 v2, s[4:7], s67 offen offset:3072 lds
v_mfma_f32_16x16x32_bf16 v[152:155], v[16:19], a[200:203], v[152:155]
s_add_u32 m0, s61, 102400
v_mfma_f32_16x16x32_bf16 v[156:159], v[16:19], a[204:207], v[156:159]
v_mfma_f32_16x16x32_bf16 v[172:175], v[20:23], a[204:207], v[172:175]
ds_read_b64_tr_b16 v[36:37], v10 offset:8192
v_mfma_f32_16x16x32_bf16 v[168:171], v[20:23], a[200:203], v[168:171]
ds_read_b64_tr_b16 v[38:39], v10 offset:8704
v_mfma_f32_16x16x32_bf16 v[164:167], v[20:23], a[196:199], v[164:167]
buffer_load_dwordx4 v1, s[4:7], s68 offen offset:0 lds
v_mfma_f32_16x16x32_bf16 v[160:163], v[20:23], a[192:195], v[160:163]
s_waitcnt lgkmcnt(4)
v_mfma_f32_16x16x32_bf16 v[48:51], v[24:27], a[208:211], v[48:51]
ds_read_b64_tr_b16 v[16:17], v7 offset:10240
v_mfma_f32_16x16x32_bf16 v[52:55], v[24:27], a[212:215], v[52:55]
ds_read_b64_tr_b16 v[18:19], v7 offset:10752
v_mfma_f32_16x16x32_bf16 v[56:59], v[24:27], a[216:219], v[56:59]
v_mfma_f32_16x16x32_bf16 v[60:63], v[24:27], a[220:223], v[60:63]
buffer_load_dwordx4 v2, s[4:7], s69 offen offset:1024 lds
v_mfma_f32_16x16x32_bf16 v[76:79], v[28:31], a[220:223], v[76:79]
ds_read_b64_tr_b16 v[20:21], v8 offset:10240
v_mfma_f32_16x16x32_bf16 v[72:75], v[28:31], a[216:219], v[72:75]
ds_read_b64_tr_b16 v[22:23], v8 offset:10752
v_mfma_f32_16x16x32_bf16 v[68:71], v[28:31], a[212:215], v[68:71]
v_mfma_f32_16x16x32_bf16 v[64:67], v[28:31], a[208:211], v[64:67]
s_waitcnt lgkmcnt(4)
v_mfma_f32_16x16x32_bf16 v[80:83], v[32:35], a[208:211], v[80:83]
ds_read_b64_tr_b16 v[24:25], v9 offset:10240
buffer_load_dwordx4 v1, s[4:7], s70 offen offset:2048 lds
v_mfma_f32_16x16x32_bf16 v[84:87], v[32:35], a[212:215], v[84:87]
ds_read_b64_tr_b16 v[26:27], v9 offset:10752
v_mfma_f32_16x16x32_bf16 v[88:91], v[32:35], a[216:219], v[88:91]
v_mfma_f32_16x16x32_bf16 v[92:95], v[32:35], a[220:223], v[92:95]
v_mfma_f32_16x16x32_bf16 v[108:111], v[36:39], a[220:223], v[108:111]
ds_read_b64_tr_b16 v[28:29], v10 offset:10240
v_mfma_f32_16x16x32_bf16 v[104:107], v[36:39], a[216:219], v[104:107]
ds_read_b64_tr_b16 v[30:31], v10 offset:10752
buffer_load_dwordx4 v2, s[4:7], s71 offen offset:3072 lds
v_mfma_f32_16x16x32_bf16 v[100:103], v[36:39], a[212:215], v[100:103]
v_add_u32 v1, s63, v1
v_add_u32 v2, s63, v2
v_mfma_f32_16x16x32_bf16 v[96:99], v[36:39], a[208:211], v[96:99]
s_waitcnt lgkmcnt(4)
v_mfma_f32_16x16x32_bf16 v[112:115], v[16:19], a[208:211], v[112:115]
v_mfma_f32_16x16x32_bf16 v[116:119], v[16:19], a[212:215], v[116:119]
v_mfma_f32_16x16x32_bf16 v[120:123], v[16:19], a[216:219], v[120:123]
v_mfma_f32_16x16x32_bf16 v[124:127], v[16:19], a[220:223], v[124:127]
v_mfma_f32_16x16x32_bf16 v[140:143], v[20:23], a[220:223], v[140:143]
s_waitcnt vmcnt(12) lgkmcnt(0)
s_barrier
v_add_u32 v7, 49152, v7
v_mfma_f32_16x16x32_bf16 v[136:139], v[20:23], a[216:219], v[136:139]
s_mov_b32 s61, s89
v_add_u32 v3, 49152, v3
v_cmp_eq_u32 vcc, 0, v176
s_nop 1
s_cbranch_vccnz L_slow0
L_back0:
v_mfma_f32_16x16x32_bf16 v[132:135], v[20:23], a[212:215], v[132:135]
s_mul_i32 s78, s0, 589824
ds_read_b64_tr_b16 v[32:33], v7 offset:0
ds_read_b64_tr_b16 v[34:35], v7 offset:512
v_mfma_f32_16x16x32_bf16 v[128:131], v[20:23], a[208:211], v[128:131]
ds_read_b128 a[224:227], v3 offset:0
ds_read_b128 a[228:231], v3 offset:2048
v_mfma_f32_16x16x32_bf16 v[144:147], v[24:27], a[208:211], v[144:147]
ds_read_b128 a[232:235], v3 offset:4096
v_subrev_u32 v5, s78, v5
v_mfma_f32_16x16x32_bf16 v[148:151], v[24:27], a[212:215], v[148:151]
ds_read_b128 a[236:239], v3 offset:6144
v_add_u32 v8, 49152, v8
v_mfma_f32_16x16x32_bf16 v[152:155], v[24:27], a[216:219], v[152:155]
v_add_u32 v4, 49152, v4
v_subrev_u32 v6, s78, v6
v_mfma_f32_16x16x32_bf16 v[156:159], v[24:27], a[220:223], v[156:159]
s_add_u32 m0, s62, 0
ds_read_b64_tr_b16 v[36:37], v8 offset:0
ds_read_b64_tr_b16 v[38:39], v8 offset:512
v_mfma_f32_16x16x32_bf16 v[172:175], v[28:31], a[220:223], v[172:175]
s_add_u32 s72, s3, 0
buffer_load_dwordx4 v5, s[8:11], s72 offen offset:0 lds
v_add_u32 v9, 49152, v9
v_mfma_f32_16x16x32_bf16 v[168:171], v[28:31], a[216:219], v[168:171]
s_add_u32 s73, s3, 72704
ds_read_b64_tr_b16 v[16:17], v9 offset:0
buffer_load_dwordx4 v6, s[8:11], s73 offen offset:1024 lds
v_mfma_f32_16x16x32_bf16 v[164:167], v[28:31], a[212:215], v[164:167]
s_add_u32 s74, s3, 145408
ds_read_b64_tr_b16 v[18:19], v9 offset:512
buffer_load_dwordx4 v5, s[8:11], s74 offen offset:2048 lds
v_mfma_f32_16x16x32_bf16 v[160:163], v[28:31], a[208:211], v[160:163]
s_waitcnt lgkmcnt(2)
v_add_u32 v10, 49152, v10
v_readfirstlane_b32 s57, v176
v_mfma_f32_16x16x32_bf16 v[48:51], v[32:35], a[224:227], v[48:51]
s_add_u32 s75, s3, 218112
ds_read_b64_tr_b16 v[20:21], v10 offset:0
v_mfma_f32_16x16x32_bf16 v[52:55], v[32:35], a[228:231], v[52:55]
ds_read_b64_tr_b16 v[22:23], v10 offset:512
v_mfma_f32_16x16x32_bf16 v[56:59], v[32:35], a[232:235], v[56:59]
ds_read_b64_tr_b16 v[24:25], v7 offset:2048
buffer_load_dwordx4 v6, s[8:11], s75 offen offset:3072 lds
v_mfma_f32_16x16x32_bf16 v[60:63], v[32:35], a[236:239], v[60:63]
s_add_u32 m0, s62, 16384
ds_read_b64_tr_b16 v[26:27], v7 offset:2560
s_add_u32 s72, s94, 0
v_mfma_f32_16x16x32_bf16 v[76:79], v[36:39], a[236:239], v[76:79]
ds_read_b128 a[240:243], v4 offset:0
v_mfma_f32_16x16x32_bf16 v[72:75], v[36:39], a[232:235], v[72:75]
ds_read_b128 a[244:247], v4 offset:2048
buffer_load_dwordx4 v5, s[8:11], s72 offen offset:0 lds
v_mfma_f32_16x16x32_bf16 v[68:71], v[36:39], a[228:231], v[68:71]
s_add_u32 s73, s94, 72704
ds_read_b64_tr_b16 v[28:29], v8 offset:2048
v_mfma_f32_16x16x32_bf16 v[64:67], v[36:39], a[224:227], v[64:67]
s_waitcnt lgkmcnt(5)
ds_read_b64_tr_b16 v[30:31], v8 offset:2560
v_mfma_f32_16x16x32_bf16 v[80:83], v[16:19], a[224:227], v[80:83]
ds_read_b128 a[248:251], v4 offset:4096
buffer_load_dwordx4 v6, s[8:11], s73 offen offset:1024 lds
v_mfma_f32_16x16x32_bf16 v[84:87], v[16:19], a[228:231], v[84:87]
s_add_u32 s74, s94, 145408
ds_read_b128 a[252:255], v4 offset:6144
v_mfma_f32_16x16x32_bf16 v[88:91], v[16:19], a[232:235], v[88:91]
ds_read_b64_tr_b16 v[32:33], v9 offset:2048
v_mfma_f32_16x16x32_bf16 v[92:95], v[16:19], a[236:239], v[92:95]
ds_read_b64_tr_b16 v[34:35], v9 offset:2560
v_mfma_f32_16x16x32_bf16 v[108:111], v[20:23], a[236:239], v[108:111]
ds_read_b64_tr_b16 v[36:37], v10 offset:2048
buffer_load_dwordx4 v5, s[8:11], s74 offen offset:2048 lds
v_mfma_f32_16x16x32_bf16 v[104:107], v[20:23], a[232:235], v[104:107]
s_add_u32 s75, s94, 218112
ds_read_b64_tr_b16 v[38:39], v10 offset:2560
v_mfma_f32_16x16x32_bf16 v[100:103], v[20:23], a[228:231], v[100:103]
v_mfma_f32_16x16x32_bf16 v[96:99], v[20:23], a[224:227], v[96:99]
s_waitcnt lgkmcnt(6)
buffer_load_dwordx4 v6, s[8:11], s75 offen offset:3072 lds
s_add_u32 m0, s62, 32768
v_mfma_f32_16x16x32_bf16 v[112:115], v[24:27], a[224:227], v[112:115]
s_add_u32 s72, s95, 0
ds_read_b64_tr_b16 v[16:17], v7 offset:8192
v_mfma_f32_16x16x32_bf16 v[116:119], v[24:27], a[228:231], v[116:119]
ds_read_b64_tr_b16 v[18:19], v7 offset:8704
v_mfma_f32_16x16x32_bf16 v[120:123], v[24:27], a[232:235], v[120:123]
buffer_load_dwordx4 v5, s[8:11], s72 offen offset:0 lds
s_add_u32 s73, s95, 72704
v_mfma_f32_16x16x32_bf16 v[124:127], v[24:27], a[236:239], v[124:127]
v_mfma_f32_16x16x32_bf16 v[140:143], v[28:31], a[236:239], v[140:143]
ds_read_b64_tr_b16 v[20:21], v8 offset:8192
v_mfma_f32_16x16x32_bf16 v[136:139], v[28:31], a[232:235], v[136:139]
ds_read_b64_tr_b16 v[22:23], v8 offset:8704
v_mfma_f32_16x16x32_bf16 v[132:135], v[28:31], a[228:231], v[132:135]
buffer_load_dwordx4 v6, s[8:11], s73 offen offset:1024 lds
s_add_u32 s74, s95, 145408
v_mfma_f32_16x16x32_bf16 v[128:131], v[28:31], a[224:227], v[128:131]
s_waitcnt lgkmcnt(4)
v_mfma_f32_16x16x32_bf16 v[144:147], v[32:35], a[224:227], v[144:147]
ds_read_b64_tr_b16 v[24:25], v9 offset:8192
v_mfma_f32_16x16x32_bf16 v[148:151], v[32:35], a[228:231], v[148:151]
ds_read_b64_tr_b16 v[26:27], v9 offset:8704
buffer_load_dwordx4 v5, s[8:11], s74 offen offset:2048 lds
v_mfma_f32_16x16x32_bf16 v[152:155], v[32:35], a[232:235], v[152:155]
s_add_u32 s75, s95, 218112
v_mfma_f32_16x16x32_bf16 v[156:159], v[32:35], a[236:239], v[156:159]
v_mfma_f32_16x16x32_bf16 v[172:175], v[36:39], a[236:239], v[172:175]
ds_read_b64_tr_b16 v[28:29], v10 offset:8192
buffer_load_dwordx4 v6, s[8:11], s75 offen offset:3072 lds
v_mfma_f32_16x16x32_bf16 v[168:171], v[36:39], a[232:235], v[168:171]
ds_read_b64_tr_b16 v[30:31], v10 offset:8704
v_mfma_f32_16x16x32_bf16 v[164:167], v[36:39], a[228:231], v[164:167]
v_mfma_f32_16x16x32_bf16 v[160:163], v[36:39], a[224:227], v[160:163]
s_waitcnt lgkmcnt(4)
v_mfma_f32_16x16x32_bf16 v[48:51], v[16:19], a[240:243], v[48:51]
ds_read_b64_tr_b16 v[32:33], v7 offset:10240
v_mfma_f32_16x16x32_bf16 v[52:55], v[16:19], a[244:247], v[52:55]
ds_read_b64_tr_b16 v[34:35], v7 offset:10752
v_mfma_f32_16x16x32_bf16 v[56:59], v[16:19], a[248:251], v[56:59]
v_mfma_f32_16x16x32_bf16 v[60:63], v[16:19], a[252:255], v[60:63]
v_mfma_f32_16x16x32_bf16 v[76:79], v[20:23], a[252:255], v[76:79]
ds_read_b64_tr_b16 v[36:37], v8 offset:10240
v_mfma_f32_16x16x32_bf16 v[72:75], v[20:23], a[248:251], v[72:75]
ds_read_b64_tr_b16 v[38:39], v8 offset:10752
v_mfma_f32_16x16x32_bf16 v[68:71], v[20:23], a[244:247], v[68:71]
v_mfma_f32_16x16x32_bf16 v[64:67], v[20:23], a[240:243], v[64:67]
s_waitcnt lgkmcnt(4)
v_mfma_f32_16x16x32_bf16 v[80:83], v[24:27], a[240:243], v[80:83]
ds_read_b64_tr_b16 v[16:17], v9 offset:10240
v_mfma_f32_16x16x32_bf16 v[84:87], v[24:27], a[244:247], v[84:87]
ds_read_b64_tr_b16 v[18:19], v9 offset:10752
v_mfma_f32_16x16x32_bf16 v[88:91], v[24:27], a[248:251], v[88:91]
v_mfma_f32_16x16x32_bf16 v[92:95], v[24:27], a[252:255], v[92:95]
v_mfma_f32_16x16x32_bf16 v[108:111], v[28:31], a[252:255], v[108:111]
ds_read_b64_tr_b16 v[20:21], v10 offset:10240
v_mfma_f32_16x16x32_bf16 v[104:107], v[28:31], a[248:251], v[104:107]
ds_read_b64_tr_b16 v[22:23], v10 offset:10752
v_mfma_f32_16x16x32_bf16 v[100:103], v[28:31], a[244:247], v[100:103]
v_mfma_f32_16x16x32_bf16 v[96:99], v[28:31], a[240:243], v[96:99]
s_waitcnt lgkmcnt(4)
v_mfma_f32_16x16x32_bf16 v[112:115], v[32:35], a[240:243], v[112:115]
v_mfma_f32_16x16x32_bf16 v[116:119], v[32:35], a[244:247], v[116:119]
v_mfma_f32_16x16x32_bf16 v[120:123], v[32:35], a[248:251], v[120:123]
v_mfma_f32_16x16x32_bf16 v[124:127], v[32:35], a[252:255], v[124:127]
v_mfma_f32_16x16x32_bf16 v[140:143], v[36:39], a[252:255], v[140:143]
s_waitcnt vmcnt(12) lgkmcnt(0)
s_barrier
v_add_u32 v7, 49152, v7
v_mfma_f32_16x16x32_bf16 v[136:139], v[36:39], a[248:251], v[136:139]
s_add_u32 m0, s62, 49152
v_add_u32 v3, 49152, v3
s_add_u32 s72, s61, 0
v_mfma_f32_16x16x32_bf16 v[132:135], v[36:39], a[244:247], v[132:135]
ds_read_b64_tr_b16 v[24:25], v7 offset:0
ds_read_b64_tr_b16 v[26:27], v7 offset:512
v_mfma_f32_16x16x32_bf16 v[128:131], v[36:39], a[240:243], v[128:131]
ds_read_b128 v[224:227], v3 offset:0
ds_read_b128 v[228:231], v3 offset:2048
v_mfma_f32_16x16x32_bf16 v[144:147], v[16:19], a[240:243], v[144:147]
ds_read_b128 v[232:235], v3 offset:4096
buffer_load_dwordx4 v5, s[8:11], s72 offen offset:0 lds
v_mfma_f32_16x16x32_bf16 v[148:151], v[16:19], a[244:247], v[148:151]
s_add_u32 s73, s61, 72704
ds_read_b128 v[236:239], v3 offset:6144
v_add_u32 v8, 49152, v8
v_mfma_f32_16x16x32_bf16 v[152:155], v[16:19], a[248:251], v[152:155]
buffer_load_dwordx4 v6, s[8:11], s73 offen offset:1024 lds
v_add_u32 v4, 49152, v4
v_mfma_f32_16x16x32_bf16 v[156:159], v[16:19], a[252:255], v[156:159]
s_add_u32 s74, s61, 145408
ds_read_b64_tr_b16 v[28:29], v8 offset:0
ds_read_b64_tr_b16 v[30:31], v8 offset:512
v_mfma_f32_16x16x32_bf16 v[172:175], v[20:23], a[252:255], v[172:175]
v_add_u32 v9, 49152, v9
v_mfma_f32_16x16x32_bf16 v[168:171], v[20:23], a[248:251], v[168:171]
ds_read_b64_tr_b16 v[32:33], v9 offset:0
buffer_load_dwordx4 v5, s[8:11], s74 offen offset:2048 lds
v_mfma_f32_16x16x32_bf16 v[164:167], v[20:23], a[244:247], v[164:167]
s_add_u32 s75, s61, 218112
ds_read_b64_tr_b16 v[34:35], v9 offset:512
v_add_u32 v10, 49152, v10
v_mfma_f32_16x16x32_bf16 v[160:163], v[20:23], a[240:243], v[160:163]
s_waitcnt lgkmcnt(2)
ds_read_b64_tr_b16 v[36:37], v10 offset:0
v_mfma_f32_16x16x32_bf16 v[48:51], v[24:27], v[224:227], v[48:51]
ds_read_b64_tr_b16 v[38:39], v10 offset:512
buffer_load_dwordx4 v6, s[8:11], s75 offen offset:3072 lds
v_mfma_f32_16x16x32_bf16 v[52:55], v[24:27], v[228:231], v[52:55]
s_lshl_b32 s78, s48, 11
ds_read_b64_tr_b16 v[16:17], v7 offset:2048
s_add_u32 m0, s78, 65536
v_mfma_f32_16x16x32_bf16 v[56:59], v[24:27], v[232:235], v[56:59]
s_add_u32 s72, s54, 0
ds_read_b64_tr_b16 v[18:19], v7 offset:2560
buffer_load_dwordx4 v5, s[8:11], s72 offen offset:0 lds
v_mfma_f32_16x16x32_bf16 v[60:63], v[24:27], v[236:239], v[60:63]
s_add_u32 s73, s54, 72704
ds_read_b128 v[240:243], v4 offset:0
v_mfma_f32_16x16x32_bf16 v[76:79], v[28:31], v[236:239], v[76:79]
ds_read_b128 v[244:247], v4 offset:2048
v_mfma_f32_16x16x32_bf16 v[72:75], v[28:31], v[232:235], v[72:75]
ds_read_b64_tr_b16 v[20:21], v8 offset:2048
buffer_load_dwordx4 v6, s[8:11], s73 offen offset:1024 lds
v_mfma_f32_16x16x32_bf16 v[68:71], v[28:31], v[228:231], v[68:71]
ds_read_b64_tr_b16 v[22:23], v8 offset:2560
v_mfma_f32_16x16x32_bf16 v[64:67], v[28:31], v[224:227], v[64:67]
s_waitcnt lgkmcnt(6)
ds_read_b128 v[248:251], v4 offset:4096
v_mfma_f32_16x16x32_bf16 v[80:83], v[32:35], v[224:227], v[80:83]
ds_read_b128 v[252:255], v4 offset:6144
v_mfma_f32_16x16x32_bf16 v[84:87], v[32:35], v[228:231], v[84:87]
ds_read_b64_tr_b16 v[24:25], v9 offset:2048
v_mfma_f32_16x16x32_bf16 v[88:91], v[32:35], v[232:235], v[88:91]
ds_read_b64_tr_b16 v[26:27], v9 offset:2560
v_mfma_f32_16x16x32_bf16 v[92:95], v[32:35], v[236:239], v[92:95]
v_mfma_f32_16x16x32_bf16 v[108:111], v[36:39], v[236:239], v[108:111]
ds_read_b64_tr_b16 v[28:29], v10 offset:2048
v_mfma_f32_16x16x32_bf16 v[104:107], v[36:39], v[232:235], v[104:107]
ds_read_b64_tr_b16 v[30:31], v10 offset:2560
v_mfma_f32_16x16x32_bf16 v[100:103], v[36:39], v[228:231], v[100:103]
v_mfma_f32_16x16x32_bf16 v[96:99], v[36:39], v[224:227], v[96:99]
s_waitcnt lgkmcnt(6)
v_mfma_f32_16x16x32_bf16 v[112:115], v[16:19], v[224:227], v[112:115]
ds_read_b64_tr_b16 v[32:33], v7 offset:8192
v_mfma_f32_16x16x32_bf16 v[116:119], v[16:19], v[228:231], v[116:119]
ds_read_b64_tr_b16 v[34:35], v7 offset:8704
v_mfma_f32_16x16x32_bf16 v[120:123], v[16:19], v[232:235], v[120:123]
v_mfma_f32_16x16x32_bf16 v[124:127], v[16:19], v[236:239], v[124:127]
v_mfma_f32_16x16x32_bf16 v[140:143], v[20:23], v[236:239], v[140:143]
ds_read_b64_tr_b16 v[36:37], v8 offset:8192
v_mfma_f32_16x16x32_bf16 v[136:139], v[20:23], v[232:235], v[136:139]
ds_read_b64_tr_b16 v[38:39], v8 offset:8704
v_mfma_f32_16x16x32_bf16 v[132:135], v[20:23], v[228:231], v[132:135]
s_mov_b32 s84, 0
buffer_load_dwordx3 v[2:4], v12, s[96:99], s84 offen
v_mfma_f32_16x16x32_bf16 v[128:131], v[20:23], v[224:227], v[128:131]
s_waitcnt lgkmcnt(4)
v_mfma_f32_16x16x32_bf16 v[144:147], v[24:27], v[224:227], v[144:147]
ds_read_b64_tr_b16 v[16:17], v9 offset:8192
v_mfma_f32_16x16x32_bf16 v[148:151], v[24:27], v[228:231], v[148:151]
ds_read_b64_tr_b16 v[18:19], v9 offset:8704
v_mfma_f32_16x16x32_bf16 v[152:155], v[24:27], v[232:235], v[152:155]
v_mfma_f32_16x16x32_bf16 v[156:159], v[24:27], v[236:239], v[156:159]
v_mfma_f32_16x16x32_bf16 v[172:175], v[28:31], v[236:239], v[172:175]
ds_read_b64_tr_b16 v[20:21], v10 offset:8192
v_mfma_f32_16x16x32_bf16 v[168:171], v[28:31], v[232:235], v[168:171]
ds_read_b64_tr_b16 v[22:23], v10 offset:8704
v_mfma_f32_16x16x32_bf16 v[164:167], v[28:31], v[228:231], v[164:167]
v_mfma_f32_16x16x32_bf16 v[160:163], v[28:31], v[224:227], v[160:163]
s_waitcnt lgkmcnt(4)
v_mfma_f32_16x16x32_bf16 v[48:51], v[32:35], v[240:243], v[48:51]
ds_read_b64_tr_b16 v[24:25], v7 offset:10240
v_mfma_f32_16x16x32_bf16 v[52:55], v[32:35], v[244:247], v[52:55]
ds_read_b64_tr_b16 v[26:27], v7 offset:10752
v_mfma_f32_16x16x32_bf16 v[56:59], v[32:35], v[248:251], v[56:59]
v_mfma_f32_16x16x32_bf16 v[60:63], v[32:35], v[252:255], v[60:63]
v_mfma_f32_16x16x32_bf16 v[76:79], v[36:39], v[252:255], v[76:79]
ds_read_b64_tr_b16 v[28:29], v8 offset:10240
v_mfma_f32_16x16x32_bf16 v[72:75], v[36:39], v[248:251], v[72:75]
ds_read_b64_tr_b16 v[30:31], v8 offset:10752
v_mfma_f32_16x16x32_bf16 v[68:71], v[36:39], v[244:247], v[68:71]
v_mfma_f32_16x16x32_bf16 v[64:67], v[36:39], v[240:243], v[64:67]
s_waitcnt lgkmcnt(4)
v_mfma_f32_16x16x32_bf16 v[80:83], v[16:19], v[240:243], v[80:83]
ds_read_b64_tr_b16 v[32:33], v9 offset:10240
v_mfma_f32_16x16x32_bf16 v[84:87], v[16:19], v[244:247], v[84:87]
ds_read_b64_tr_b16 v[34:35], v9 offset:10752
v_mfma_f32_16x16x32_bf16 v[88:91], v[16:19], v[248:251], v[88:91]
v_mfma_f32_16x16x32_bf16 v[92:95], v[16:19], v[252:255], v[92:95]
v_mfma_f32_16x16x32_bf16 v[108:111], v[20:23], v[252:255], v[108:111]
ds_read_b64_tr_b16 v[36:37], v10 offset:10240
v_mfma_f32_16x16x32_bf16 v[104:107], v[20:23], v[248:251], v[104:107]
ds_read_b64_tr_b16 v[38:39], v10 offset:10752
v_mfma_f32_16x16x32_bf16 v[100:103], v[20:23], v[244:247], v[100:103]
v_mfma_f32_16x16x32_bf16 v[96:99], v[20:23], v[240:243], v[96:99]
s_waitcnt lgkmcnt(4)
v_mfma_f32_16x16x32_bf16 v[112:115], v[24:27], v[240:243], v[112:115]
v_mfma_f32_16x16x32_bf16 v[116:119], v[24:27], v[244:247], v[116:119]
v_mfma_f32_16x16x32_bf16 v[120:123], v[24:27], v[248:251], v[120:123]
v_mfma_f32_16x16x32_bf16 v[124:127], v[24:27], v[252:255], v[124:127]
v_mfma_f32_16x16x32_bf16 v[140:143], v[28:31], v[252:255], v[140:143]
s_waitcnt vmcnt(1) lgkmcnt(0)
s_barrier
v_xor_b32 v7, 0, v13
v_mfma_f32_16x16x32_bf16 v[136:139], v[28:31], v[248:251], v[136:139]
s_mul_i32 s87, s50, 9
v_add_u32 v8, 36864, v7
s_add_u32 s87, s87, 0
v_mfma_f32_16x16x32_bf16 v[132:135], v[28:31], v[244:247], v[132:135]
s_add_u32 s87, s87, s48
ds_read_b64_tr_b16 v[16:17], v7 offset:0
s_lshl_b32 s80, s87, 4
v_mfma_f32_16x16x32_bf16 v[128:131], v[28:31], v[240:243], v[128:131]
s_mul_i32 s87, s87, 27648
ds_read_b64_tr_b16 v[18:19], v7 offset:512
s_mul_i32 s88, s52, 36
v_mfma_f32_16x16x32_bf16 v[144:147], v[32:35], v[240:243], v[144:147]
s_add_u32 s87, s87, s88
ds_read_b64_tr_b16 v[20:21], v7 offset:4096
s_waitcnt vmcnt(0)
buffer_load_dwordx2 v[208:209], v2, s[16:19], s87 offen
v_mfma_f32_16x16x32_bf16 v[148:151], v[32:35], v[244:247], v[148:151]
ds_read_b64_tr_b16 v[22:23], v7 offset:4608
buffer_load_dwordx2 v[210:211], v3, s[16:19], s87 offen
v_mfma_f32_16x16x32_bf16 v[152:155], v[32:35], v[248:251], v[152:155]
ds_read_b64_tr_b16 v[24:25], v7 offset:8192
v_mfma_f32_16x16x32_bf16 v[156:159], v[32:35], v[252:255], v[156:159]
ds_read_b64_tr_b16 v[26:27], v7 offset:8704
v_mfma_f32_16x16x32_bf16 v[172:175], v[36:39], v[252:255], v[172:175]
ds_read_b64_tr_b16 v[28:29], v7 offset:12288
buffer_load_ushort v220, v4, s[44:47], s80 offen
v_mfma_f32_16x16x32_bf16 v[168:171], v[36:39], v[248:251], v[168:171]
s_mul_i32 s87, s50, 9
ds_read_b64_tr_b16 v[30:31], v7 offset:12800
s_add_u32 s87, s87, 4
v_mfma_f32_16x16x32_bf16 v[164:167], v[36:39], v[244:247], v[164:167]
s_add_u32 s87, s87, s48
s_lshl_b32 s80, s87, 4
s_mul_i32 s87, s87, 27648
v_mfma_f32_16x16x32_bf16 v[160:163], v[36:39], v[240:243], v[160:163]
s_waitcnt lgkmcnt(4)
s_mul_i32 s88, s52, 36
s_add_u32 s87, s87, s88
v_mfma_f32_16x16x32_bf16 v[176:179], v[16:19], a[0:3], 0
ds_read_b64_tr_b16 v[32:33], v7 offset:16384
buffer_load_dwordx2 v[212:213], v2, s[16:19], s87 offen
v_mfma_f32_16x16x32_bf16 v[180:183], v[16:19], a[4:7], 0
ds_read_b64_tr_b16 v[34:35], v7 offset:16896
v_mfma_f32_16x16x32_bf16 v[184:187], v[16:19], a[8:11], 0
v_mul_f32 v40, s59, v48
v_mul_f32 v41, s59, v49
v_mfma_f32_16x16x32_bf16 v[188:191], v[16:19], a[12:15], 0
buffer_load_dwordx2 v[214:215], v3, s[16:19], s87 offen
v_mul_f32 v42, s59, v50
v_mfma_f32_16x16x32_bf16 v[176:179], v[20:23], a[16:19], v[176:179]
ds_read_b64_tr_b16 v[36:37], v7 offset:20480
v_mul_f32 v43, s59, v51
v_mfma_f32_16x16x32_bf16 v[180:183], v[20:23], a[20:23], v[180:183]
ds_read_b64_tr_b16 v[38:39], v7 offset:20992
v_mfma_f32_16x16x32_bf16 v[184:187], v[20:23], a[24:27], v[184:187]
buffer_load_ushort v221, v4, s[44:47], s80 offen
s_mul_i32 s87, s50, 9
v_mfma_f32_16x16x32_bf16 v[188:191], v[20:23], a[28:31], v[188:191]
s_waitcnt lgkmcnt(4)
v_exp_f32 v40, v40
v_mfma_f32_16x16x32_bf16 v[176:179], v[24:27], a[32:35], v[176:179]
s_add_u32 s87, s87, 8
ds_read_b64_tr_b16 v[16:17], v7 offset:24576
v_add_f32 v40, 1.0, v40
v_mfma_f32_16x16x32_bf16 v[180:183], v[24:27], a[36:39], v[180:183]
s_lshl_b32 s80, s87, 4
ds_read_b64_tr_b16 v[18:19], v7 offset:25088
v_mul_f32 v44, s59, v52
v_mfma_f32_16x16x32_bf16 v[184:187], v[24:27], a[40:43], v[184:187]
s_mul_i32 s87, s87, 27648
v_exp_f32 v41, v41
v_mfma_f32_16x16x32_bf16 v[188:191], v[24:27], a[44:47], v[188:191]
s_mul_i32 s88, s52, 36
v_rcp_f32 v40, v40
v_mfma_f32_16x16x32_bf16 v[176:179], v[28:31], a[48:51], v[176:179]
s_add_u32 s87, s87, s88
ds_read_b64_tr_b16 v[20:21], v7 offset:28672
v_add_f32 v41, 1.0, v41
v_mfma_f32_16x16x32_bf16 v[180:183], v[28:31], a[52:55], v[180:183]
s_min_u32 s88, s48, 1
ds_read_b64_tr_b16 v[22:23], v7 offset:29184
v_mul_f32 v48, v48, v40
v_mfma_f32_16x16x32_bf16 v[184:187], v[28:31], a[56:59], v[184:187]
s_lshl_b32 s88, s88, 31
v_exp_f32 v42, v42
v_mfma_f32_16x16x32_bf16 v[188:191], v[28:31], a[60:63], v[188:191]
s_waitcnt lgkmcnt(4)
v_rcp_f32 v41, v41
v_mfma_f32_16x16x32_bf16 v[176:179], v[32:35], a[64:67], v[176:179]
ds_read_b64_tr_b16 v[24:25], v7 offset:32768
v_or_b32 v2, s88, v2
v_mfma_f32_16x16x32_bf16 v[180:183], v[32:35], a[68:71], v[180:183]
ds_read_b64_tr_b16 v[26:27], v7 offset:33280
v_or_b32 v3, s88, v3
v_mfma_f32_16x16x32_bf16 v[184:187], v[32:35], a[72:75], v[184:187]
v_exp_f32 v43, v43
v_mfma_f32_16x16x32_bf16 v[188:191], v[32:35], a[76:79], v[188:191]
v_exp_f32 v44, v44
v_mfma_f32_16x16x32_bf16 v[176:179], v[36:39], a[80:83], v[176:179]
ds_read_b64_tr_b16 v[28:29], v8 offset:0
v_or_b32 v4, s88, v4
v_mfma_f32_16x16x32_bf16 v[180:183], v[36:39], a[84:87], v[180:183]
ds_read_b64_tr_b16 v[30:31], v8 offset:512
v_or_b32 v1, s88, v12
v_mfma_f32_16x16x32_bf16 v[184:187], v[36:39], a[88:91], v[184:187]
buffer_load_dwordx2 v[216:217], v2, s[16:19], s87 offen
buffer_load_dwordx2 v[218:219], v3, s[16:19], s87 offen
v_mfma_f32_16x16x32_bf16 v[188:191], v[36:39], a[92:95], v[188:191]
s_waitcnt lgkmcnt(4)
buffer_load_ushort v222, v4, s[44:47], s80 offen
v_add_f32 v42, 1.0, v42
v_mfma_f32_16x16x32_bf16 v[176:179], v[16:19], a[96:99], v[176:179]
s_add_u32 m0, s62, 83712
ds_read_b64_tr_b16 v[32:33], v8 offset:4096
v_mul_f32 v49, v49, v41
v_mfma_f32_16x16x32_bf16 v[180:183], v[16:19], a[100:103], v[180:183]
s_add_u32 s72, s3, 0
ds_read_b64_tr_b16 v[34:35], v8 offset:4608
buffer_load_dwordx4 v5, s[12:15], s72 offen offset:0 lds
v_mfma_f32_16x16x32_bf16 v[184:187], v[16:19], a[104:107], v[184:187]
s_add_u32 s73, s3, 72704
v_rcp_f32 v42, v42
v_mfma_f32_16x16x32_bf16 v[188:191], v[16:19], a[108:111], v[188:191]
buffer_load_dwordx4 v6, s[12:15], s73 offen offset:1024 lds
v_add_f32 v43, 1.0, v43
v_mfma_f32_16x16x32_bf16 v[176:179], v[20:23], a[112:115], v[176:179]
s_add_u32 s74, s3, 145408
ds_read_b64_tr_b16 v[36:37], v8 offset:8192
v_mul_f32 v45, s59, v53
v_mfma_f32_16x16x32_bf16 v[180:183], v[20:23], a[116:119], v[180:183]
ds_read_b64_tr_b16 v[38:39], v8 offset:8704
v_mul_f32 v50, v50, v42
v_mfma_f32_16x16x32_bf16 v[184:187], v[20:23], a[120:123], v[184:187]
v_rcp_f32 v43, v43
v_mfma_f32_16x16x32_bf16 v[188:191], v[20:23], a[124:127], v[188:191]
s_waitcnt lgkmcnt(4)
v_exp_f32 v45, v45
v_mfma_f32_16x16x32_bf16 v[176:179], v[24:27], a[128:131], v[176:179]
ds_read_b64_tr_b16 v[16:17], v8 offset:12288
buffer_load_dwordx4 v5, s[12:15], s74 offen offset:2048 lds
v_mfma_f32_16x16x32_bf16 v[180:183], v[24:27], a[132:135], v[180:183]
s_add_u32 s75, s3, 218112
ds_read_b64_tr_b16 v[18:19], v8 offset:12800
v_add_f32 v44, 1.0, v44
v_mfma_f32_16x16x32_bf16 v[184:187], v[24:27], a[136:139], v[184:187]
v_rcp_f32 v44, v44
v_mfma_f32_16x16x32_bf16 v[188:191], v[24:27], a[140:143], v[188:191]
v_mul_f32 v40, s59, v54
v_mul_f32 v51, v51, v43
v_mfma_f32_16x16x32_bf16 v[176:179], v[28:31], a[144:147], v[176:179]
ds_read_b64_tr_b16 v[20:21], v8 offset:16384
v_add_f32 v45, 1.0, v45
v_mfma_f32_16x16x32_bf16 v[180:183], v[28:31], a[148:151], v[180:183]
ds_read_b64_tr_b16 v[22:23], v8 offset:16896
buffer_load_dwordx4 v6, s[12:15], s75 offen offset:3072 lds
v_mfma_f32_16x16x32_bf16 v[184:187], v[28:31], a[152:155], v[184:187]
s_add_u32 m0, s62, 100096
v_exp_f32 v40, v40
v_mfma_f32_16x16x32_bf16 v[188:191], v[28:31], a[156:159], v[188:191]
s_waitcnt lgkmcnt(4)
v_rcp_f32 v45, v45
v_mfma_f32_16x16x32_bf16 v[176:179], v[32:35], a[160:163], v[176:179]
s_add_u32 s72, s94, 0
ds_read_b64_tr_b16 v[24:25], v8 offset:20480
v_mul_f32 v41, s59, v55
v_mfma_f32_16x16x32_bf16 v[180:183], v[32:35], a[164:167], v[180:183]
ds_read_b64_tr_b16 v[26:27], v8 offset:20992
v_mul_f32 v52, v52, v44
v_mfma_f32_16x16x32_bf16 v[184:187], v[32:35], a[168:171], v[184:187]
buffer_load_dwordx4 v5, s[12:15], s72 offen offset:0 lds
v_add_f32 v40, 1.0, v40
v_mfma_f32_16x16x32_bf16 v[188:191], v[32:35], a[172:175], v[188:191]
s_add_u32 s73, s94, 72704
v_exp_f32 v41, v41
v_mfma_f32_16x16x32_bf16 v[176:179], v[36:39], a[176:179], v[176:179]
ds_read_b64_tr_b16 v[28:29], v8 offset:24576
v_mul_f32 v42, s59, v56
v_mfma_f32_16x16x32_bf16 v[180:183], v[36:39], a[180:183], v[180:183]
ds_read_b64_tr_b16 v[30:31], v8 offset:25088
v_mul_f32 v53, v53, v45
v_mfma_f32_16x16x32_bf16 v[184:187], v[36:39], a[184:187], v[184:187]
v_rcp_f32 v40, v40
v_mfma_f32_16x16x32_bf16 v[188:191], v[36:39], a[188:191], v[188:191]
s_waitcnt lgkmcnt(4)
buffer_load_dwordx4 v6, s[12:15], s73 offen offset:1024 lds
v_add_f32 v41, 1.0, v41
v_mfma_f32_16x16x32_bf16 v[176:179], v[16:19], a[192:195], v[176:179]
s_add_u32 s74, s94, 145408
ds_read_b64_tr_b16 v[32:33], v8 offset:28672
v_mul_f32 v43, s59, v57
v_mfma_f32_16x16x32_bf16 v[180:183], v[16:19], a[196:199], v[180:183]
ds_read_b64_tr_b16 v[34:35], v8 offset:29184
v_mul_f32 v54, v54, v40
v_mfma_f32_16x16x32_bf16 v[184:187], v[16:19], a[200:203], v[184:187]
v_exp_f32 v42, v42
v_mfma_f32_16x16x32_bf16 v[188:191], v[16:19], a[204:207], v[188:191]
v_rcp_f32 v41, v41
v_mfma_f32_16x16x32_bf16 v[176:179], v[20:23], a[208:211], v[176:179]
ds_read_b64_tr_b16 v[36:37], v8 offset:32768
buffer_load_dwordx4 v5, s[12:15], s74 offen offset:2048 lds
v_mfma_f32_16x16x32_bf16 v[180:183], v[20:23], a[212:215], v[180:183]
s_add_u32 s75, s94, 218112
ds_read_b64_tr_b16 v[38:39], v8 offset:33280
v_add_f32 v42, 1.0, v42
v_mfma_f32_16x16x32_bf16 v[184:187], v[20:23], a[216:219], v[184:187]
v_exp_f32 v43, v43
v_mfma_f32_16x16x32_bf16 v[188:191], v[20:23], a[220:223], v[188:191]
s_waitcnt lgkmcnt(4)
v_rcp_f32 v42, v42
v_mfma_f32_16x16x32_bf16 v[176:179], v[24:27], a[224:227], v[176:179]
v_xor_b32 v9, 32, v13
v_add_u32 v10, 36864, v9
v_mfma_f32_16x16x32_bf16 v[180:183], v[24:27], a[228:231], v[180:183]
ds_read_b64_tr_b16 v[16:17], v9 offset:0
buffer_load_dwordx4 v6, s[12:15], s75 offen offset:3072 lds
v_mfma_f32_16x16x32_bf16 v[184:187], v[24:27], a[232:235], v[184:187]
s_add_u32 m0, s62, 116480
ds_read_b64_tr_b16 v[18:19], v9 offset:512
v_mul_f32 v44, s59, v58
v_mfma_f32_16x16x32_bf16 v[188:191], v[24:27], a[236:239], v[188:191]
s_add_u32 s72, s95, 0
v_exp_f32 v44, v44
v_mfma_f32_16x16x32_bf16 v[176:179], v[28:31], a[240:243], v[176:179]
ds_read_b64_tr_b16 v[20:21], v9 offset:4096
v_mul_f32 v55, v55, v41
v_mfma_f32_16x16x32_bf16 v[180:183], v[28:31], a[244:247], v[180:183]
ds_read_b64_tr_b16 v[22:23], v9 offset:4608
v_add_f32 v43, 1.0, v43
v_mfma_f32_16x16x32_bf16 v[184:187], v[28:31], a[248:251], v[184:187]
buffer_load_dwordx4 v5, s[12:15], s72 offen offset:0 lds
v_mul_f32 v45, s59, v59
v_mfma_f32_16x16x32_bf16 v[188:191], v[28:31], a[252:255], v[188:191]
s_waitcnt lgkmcnt(4)
v_rcp_f32 v43, v43
v_mfma_f32_16x16x32_bf16 v[176:179], v[32:35], v[224:227], v[176:179]
s_add_u32 s73, s95, 72704
ds_read_b64_tr_b16 v[24:25], v9 offset:8192
v_mul_f32 v56, v56, v42
v_mfma_f32_16x16x32_bf16 v[180:183], v[32:35], v[228:231], v[180:183]
ds_read_b64_tr_b16 v[26:27], v9 offset:8704
v_add_f32 v44, 1.0, v44
v_mfma_f32_16x16x32_bf16 v[184:187], v[32:35], v[232:235], v[184:187]
v_exp_f32 v45, v45
v_mfma_f32_16x16x32_bf16 v[188:191], v[32:35], v[236:239], v[188:191]
buffer_load_dwordx4 v6, s[12:15], s73 offen offset:1024 lds
v_mul_f32 v40, s59, v60
v_mfma_f32_16x16x32_bf16 v[176:179], v[36:39], v[240:243], v[176:179]
s_add_u32 s74, s95, 145408
ds_read_b64_tr_b16 v[28:29], v9 offset:12288
v_mul_f32 v57, v57, v43
v_mfma_f32_16x16x32_bf16 v[180:183], v[36:39], v[244:247], v[180:183]
ds_read_b64_tr_b16 v[30:31], v9 offset:12800
v_add_f32 v45, 1.0, v45
v_mfma_f32_16x16x32_bf16 v[184:187], v[36:39], v[248:251], v[184:187]
v_rcp_f32 v44, v44
v_mfma_f32_16x16x32_bf16 v[188:191], v[36:39], v[252:255], v[188:191]
s_waitcnt lgkmcnt(4)
v_exp_f32 v40, v40
v_mfma_f32_16x16x32_bf16 v[192:195], v[16:19], a[0:3], 0
ds_read_b64_tr_b16 v[32:33], v9 offset:16384
buffer_load_dwordx4 v5, s[12:15], s74 offen offset:2048 lds
v_mfma_f32_16x16x32_bf16 v[196:199], v[16:19], a[4:7], 0
s_add_u32 s75, s95, 218112
ds_read_b64_tr_b16 v[34:35], v9 offset:16896
v_mul_f32 v41, s59, v61
v_mfma_f32_16x16x32_bf16 v[200:203], v[16:19], a[8:11], 0
v_rcp_f32 v45, v45
v_mfma_f32_16x16x32_bf16 v[204:207], v[16:19], a[12:15], 0
v_exp_f32 v41, v41
v_mfma_f32_16x16x32_bf16 v[192:195], v[20:23], a[16:19], v[192:195]
ds_read_b64_tr_b16 v[36:37], v9 offset:20480
v_mul_f32 v58, v58, v44
v_mfma_f32_16x16x32_bf16 v[196:199], v[20:23], a[20:23], v[196:199]
ds_read_b64_tr_b16 v[38:39], v9 offset:20992
buffer_load_dwordx4 v6, s[12:15], s75 offen offset:3072 lds
v_mfma_f32_16x16x32_bf16 v[200:203], v[20:23], a[24:27], v[200:203]
s_add_u32 m0, s62, 132864
v_add_f32 v40, 1.0, v40
v_mul_f32 v42, s59, v62
v_mfma_f32_16x16x32_bf16 v[204:207], v[20:23], a[28:31], v[204:207]
s_waitcnt lgkmcnt(4)
v_rcp_f32 v40, v40
v_mfma_f32_16x16x32_bf16 v[192:195], v[24:27], a[32:35], v[192:195]
s_add_u32 s72, s61, 0
ds_read_b64_tr_b16 v[16:17], v9 offset:24576
v_mul_f32 v59, v59, v45
v_mfma_f32_16x16x32_bf16 v[196:199], v[24:27], a[36:39], v[196:199]
ds_read_b64_tr_b16 v[18:19], v9 offset:25088
v_add_f32 v41, 1.0, v41
v_mfma_f32_16x16x32_bf16 v[200:203], v[24:27], a[40:43], v[200:203]
buffer_load_dwordx4 v5, s[12:15], s72 offen offset:0 lds
v_mul_f32 v43, s59, v63
v_mfma_f32_16x16x32_bf16 v[204:207], v[24:27], a[44:47], v[204:207]
s_add_u32 s73, s61, 72704
v_exp_f32 v42, v42
v_mfma_f32_16x16x32_bf16 v[192:195], v[28:31], a[48:51], v[192:195]
ds_read_b64_tr_b16 v[20:21], v9 offset:28672
v_mul_f32 v60, v60, v40
v_mfma_f32_16x16x32_bf16 v[196:199], v[28:31], a[52:55], v[196:199]
ds_read_b64_tr_b16 v[22:23], v9 offset:29184
v_add_f32 v42, 1.0, v42
v_mfma_f32_16x16x32_bf16 v[200:203], v[28:31], a[56:59], v[200:203]
v_rcp_f32 v41, v41
v_mfma_f32_16x16x32_bf16 v[204:207], v[28:31], a[60:63], v[204:207]
s_waitcnt lgkmcnt(4)
buffer_load_dwordx4 v6, s[12:15], s73 offen offset:1024 lds
v_mul_f32 v61, v61, v41
v_mfma_f32_16x16x32_bf16 v[192:195], v[32:35], a[64:67], v[192:195]
s_add_u32 s74, s61, 145408
ds_read_b64_tr_b16 v[24:25], v9 offset:32768
v_mfma_f32_16x16x32_bf16 v[196:199], v[32:35], a[68:71], v[196:199]
ds_read_b64_tr_b16 v[26:27], v9 offset:33280
v_mfma_f32_16x16x32_bf16 v[200:203], v[32:35], a[72:75], v[200:203]
v_exp_f32 v43, v43
v_mfma_f32_16x16x32_bf16 v[204:207], v[32:35], a[76:79], v[204:207]
v_rcp_f32 v42, v42
v_mfma_f32_16x16x32_bf16 v[192:195], v[36:39], a[80:83], v[192:195]
ds_read_b64_tr_b16 v[28:29], v10 offset:0
buffer_load_dwordx4 v5, s[12:15], s74 offen offset:2048 lds
v_mfma_f32_16x16x32_bf16 v[196:199], v[36:39], a[84:87], v[196:199]
s_add_u32 s75, s61, 218112
ds_read_b64_tr_b16 v[30:31], v10 offset:512
v_add_f32 v43, 1.0, v43
v_mfma_f32_16x16x32_bf16 v[200:203], v[36:39], a[88:91], v[200:203]
v_rcp_f32 v43, v43
v_mfma_f32_16x16x32_bf16 v[204:207], v[36:39], a[92:95], v[204:207]
s_waitcnt lgkmcnt(4)
v_mul_f32 v62, v62, v42
v_mul_f32 v63, v63, v43
v_mfma_f32_16x16x32_bf16 v[192:195], v[16:19], a[96:99], v[192:195]
ds_read_b64_tr_b16 v[32:33], v10 offset:4096
v_mul_f32 v112, v48, v112
v_mfma_f32_16x16x32_bf16 v[196:199], v[16:19], a[100:103], v[196:199]
ds_read_b64_tr_b16 v[34:35], v10 offset:4608
buffer_load_dwordx4 v6, s[12:15], s75 offen offset:3072 lds
v_mfma_f32_16x16x32_bf16 v[200:203], v[16:19], a[104:107], v[200:203]
s_lshl_b32 s78, s48, 11
v_mul_f32 v113, v49, v113
v_mul_f32 v114, v50, v114
v_mfma_f32_16x16x32_bf16 v[204:207], v[16:19], a[108:111], v[204:207]
s_add_u32 m0, s78, 149248
v_mul_f32 v115, v51, v115
v_cvt_pk_bf16_f32 v48, v112, v113
v_mfma_f32_16x16x32_bf16 v[192:195], v[20:23], a[112:115], v[192:195]
s_add_u32 s72, s54, 0
ds_read_b64_tr_b16 v[36:37], v10 offset:8192
v_cvt_pk_bf16_f32 v49, v114, v115
v_mfma_f32_16x16x32_bf16 v[196:199], v[20:23], a[116:119], v[196:199]
ds_read_b64_tr_b16 v[38:39], v10 offset:8704
v_mul_f32 v116, v52, v116
v_mfma_f32_16x16x32_bf16 v[200:203], v[20:23], a[120:123], v[200:203]
buffer_load_dwordx4 v5, s[12:15], s72 offen offset:0 lds
v_mul_f32 v117, v53, v117
v_mfma_f32_16x16x32_bf16 v[204:207], v[20:23], a[124:127], v[204:207]
s_waitcnt lgkmcnt(4)
v_mul_f32 v118, v54, v118
v_mul_f32 v119, v55, v119
v_mfma_f32_16x16x32_bf16 v[192:195], v[24:27], a[128:131], v[192:195]
s_add_u32 s73, s54, 72704
ds_read_b64_tr_b16 v[16:17], v10 offset:12288
v_cvt_pk_bf16_f32 v52, v116, v117
v_mfma_f32_16x16x32_bf16 v[196:199], v[24:27], a[132:135], v[196:199]
ds_read_b64_tr_b16 v[18:19], v10 offset:12800
v_cvt_pk_bf16_f32 v53, v118, v119
v_mfma_f32_16x16x32_bf16 v[200:203], v[24:27], a[136:139], v[200:203]
v_mul_f32 v120, v56, v120
v_mul_f32 v121, v57, v121
v_mfma_f32_16x16x32_bf16 v[204:207], v[24:27], a[140:143], v[204:207]
buffer_load_dwordx4 v6, s[12:15], s73 offen offset:1024 lds
v_mul_f32 v122, v58, v122
v_mfma_f32_16x16x32_bf16 v[192:195], v[28:31], a[144:147], v[192:195]
ds_read_b64_tr_b16 v[20:21], v10 offset:16384
v_mul_f32 v123, v59, v123
v_mfma_f32_16x16x32_bf16 v[196:199], v[28:31], a[148:151], v[196:199]
ds_read_b64_tr_b16 v[22:23], v10 offset:16896
v_cvt_pk_bf16_f32 v56, v120, v121
v_mfma_f32_16x16x32_bf16 v[200:203], v[28:31], a[152:155], v[200:203]
s_mul_i32 s87, s50, 9
v_cvt_pk_bf16_f32 v57, v122, v123
v_mul_f32 v124, v60, v124
v_mfma_f32_16x16x32_bf16 v[204:207], v[28:31], a[156:159], v[204:207]
s_waitcnt lgkmcnt(4)
v_mul_f32 v125, v61, v125
v_mul_f32 v126, v62, v126
v_mfma_f32_16x16x32_bf16 v[192:195], v[32:35], a[160:163], v[192:195]
s_add_u32 s88, s87, s48
ds_read_b64_tr_b16 v[24:25], v10 offset:20480
v_mul_f32 v127, v63, v127
v_mfma_f32_16x16x32_bf16 v[196:199], v[32:35], a[164:167], v[196:199]
s_lshl_b32 s88, s88, 10
ds_read_b64_tr_b16 v[26:27], v10 offset:20992
v_cvt_pk_bf16_f32 v60, v124, v125
v_mfma_f32_16x16x32_bf16 v[200:203], v[32:35], a[168:171], v[200:203]
s_add_u32 s88, s88, s82
v_cvt_pk_bf16_f32 v61, v126, v127
v_mul_f32 v40, s59, v64
v_mfma_f32_16x16x32_bf16 v[204:207], v[32:35], a[172:175], v[204:207]
s_lshl_b32 s87, s87, 10
v_exp_f32 v40, v40
v_mfma_f32_16x16x32_bf16 v[192:195], v[36:39], a[176:179], v[192:195]
s_add_u32 s87, s87, s82
ds_read_b64_tr_b16 v[28:29], v10 offset:24576
v_mul_f32 v41, s59, v65
v_mfma_f32_16x16x32_bf16 v[196:199], v[36:39], a[180:183], v[196:199]
s_add_u32 s87, s87, 8192
ds_read_b64_tr_b16 v[30:31], v10 offset:25088
s_waitcnt vmcnt(24)
v_or_b32 v210, v210, v220
v_mfma_f32_16x16x32_bf16 v[200:203], v[36:39], a[184:187], v[200:203]
v_exp_f32 v41, v41
v_mfma_f32_16x16x32_bf16 v[204:207], v[36:39], a[188:191], v[204:207]
s_waitcnt lgkmcnt(4)
s_waitcnt vmcnt(21)
v_or_b32 v214, v214, v221
s_waitcnt vmcnt(18)
v_or_b32 v218, v218, v222
v_mfma_f32_16x16x32_bf16 v[192:195], v[16:19], a[192:195], v[192:195]
s_mov_b32 s90, 0x84848484
ds_read_b64_tr_b16 v[32:33], v10 offset:28672
v_add_f32 v40, 1.0, v40
v_mfma_f32_16x16x32_bf16 v[196:199], v[16:19], a[196:199], v[196:199]
s_mov_b32 s91, 0x84848484
ds_read_b64_tr_b16 v[34:35], v10 offset:29184
v_mul_f32 v42, s59, v66
v_mfma_f32_16x16x32_bf16 v[200:203], v[16:19], a[200:203], v[200:203]
s_mov_b32 s92, 0x10101010
v_rcp_f32 v40, v40
v_mfma_f32_16x16x32_bf16 v[204:207], v[16:19], a[204:207], v[204:207]
s_mov_b32 s93, 0x10101010
v_exp_f32 v42, v42
v_mfma_f32_16x16x32_bf16 v[192:195], v[20:23], a[208:211], v[192:195]
ds_read_b64_tr_b16 v[36:37], v10 offset:32768
v_cndmask_b32 v209, v209, 0, s[90:91]
v_mfma_f32_16x16x32_bf16 v[196:199], v[20:23], a[212:215], v[196:199]
ds_read_b64_tr_b16 v[38:39], v10 offset:33280
v_cndmask_b32 v211, v211, 0, s[92:93]
v_mfma_f32_16x16x32_bf16 v[200:203], v[20:23], a[216:219], v[200:203]
v_cndmask_b32 v213, v213, 0, s[90:91]
v_cndmask_b32 v215, v215, 0, s[92:93]
v_mfma_f32_16x16x32_bf16 v[204:207], v[20:23], a[220:223], v[204:207]
s_waitcnt lgkmcnt(4)
v_cndmask_b32 v217, v217, 0, s[90:91]
v_cndmask_b32 v219, v219, 0, s[92:93]
v_mfma_f32_16x16x32_bf16 v[192:195], v[24:27], a[224:227], v[192:195]
buffer_store_dwordx4 v[208:211], v12, s[28:31], s88 offen sc1
v_xor_b32 v7, 64, v13
v_mfma_f32_16x16x32_bf16 v[196:199], v[24:27], a[228:231], v[196:199]
s_add_u32 s88, s88, 4096
buffer_store_dwordx4 v[212:215], v12, s[28:31], s88 offen sc1
buffer_store_dwordx4 v[216:219], v1, s[28:31], s87 offen sc1
v_mfma_f32_16x16x32_bf16 v[200:203], v[24:27], a[232:235], v[200:203]
v_add_u32 v8, 36864, v7
v_add_f32 v41, 1.0, v41
v_mfma_f32_16x16x32_bf16 v[204:207], v[24:27], a[236:239], v[204:207]
ds_read_b64_tr_b16 v[16:17], v7 offset:0
v_mul_f32 v43, s59, v67
v_mfma_f32_16x16x32_bf16 v[192:195], v[28:31], a[240:243], v[192:195]
ds_read_b64_tr_b16 v[18:19], v7 offset:512
v_mul_f32 v64, v64, v40
v_mfma_f32_16x16x32_bf16 v[196:199], v[28:31], a[244:247], v[196:199]
ds_read_b64_tr_b16 v[20:21], v7 offset:4096
v_add_f32 v42, 1.0, v42
v_mfma_f32_16x16x32_bf16 v[200:203], v[28:31], a[248:251], v[200:203]
ds_read_b64_tr_b16 v[22:23], v7 offset:4608
v_mul_f32 v44, s59, v68
v_mfma_f32_16x16x32_bf16 v[204:207], v[28:31], a[252:255], v[204:207]
s_waitcnt lgkmcnt(4)
v_rcp_f32 v41, v41
v_mfma_f32_16x16x32_bf16 v[192:195], v[32:35], v[224:227], v[192:195]
ds_read_b64_tr_b16 v[24:25], v7 offset:8192
v_mul_f32 v65, v65, v41
v_mfma_f32_16x16x32_bf16 v[196:199], v[32:35], v[228:231], v[196:199]
ds_read_b64_tr_b16 v[26:27], v7 offset:8704
v_mul_f32 v45, s59, v69
v_mfma_f32_16x16x32_bf16 v[200:203], v[32:35], v[232:235], v[200:203]
v_exp_f32 v43, v43
v_mfma_f32_16x16x32_bf16 v[204:207], v[32:35], v[236:239], v[204:207]
v_rcp_f32 v42, v42
v_mfma_f32_16x16x32_bf16 v[192:195], v[36:39], v[240:243], v[192:195]
ds_read_b64_tr_b16 v[28:29], v7 offset:12288
v_add_f32 v43, 1.0, v43
v_mfma_f32_16x16x32_bf16 v[196:199], v[36:39], v[244:247], v[196:199]
ds_read_b64_tr_b16 v[30:31], v7 offset:12800
v_mul_f32 v66, v66, v42
v_mfma_f32_16x16x32_bf16 v[200:203], v[36:39], v[248:251], v[200:203]
v_exp_f32 v44, v44
v_mfma_f32_16x16x32_bf16 v[204:207], v[36:39], v[252:255], v[204:207]
s_waitcnt lgkmcnt(4)
v_rcp_f32 v43, v43
v_mfma_f32_16x16x32_bf16 v[112:115], v[16:19], a[0:3], 0
ds_read_b64_tr_b16 v[32:33], v7 offset:16384
v_add_f32 v44, 1.0, v44
v_mfma_f32_16x16x32_bf16 v[116:119], v[16:19], a[4:7], 0
ds_read_b64_tr_b16 v[34:35], v7 offset:16896
v_mul_f32 v40, s59, v70
v_mfma_f32_16x16x32_bf16 v[120:123], v[16:19], a[8:11], 0
v_exp_f32 v45, v45
v_mfma_f32_16x16x32_bf16 v[124:127], v[16:19], a[12:15], 0
v_rcp_f32 v44, v44
v_mfma_f32_16x16x32_bf16 v[112:115], v[20:23], a[16:19], v[112:115]
ds_read_b64_tr_b16 v[36:37], v7 offset:20480
v_mul_f32 v67, v67, v43
v_mfma_f32_16x16x32_bf16 v[116:119], v[20:23], a[20:23], v[116:119]
ds_read_b64_tr_b16 v[38:39], v7 offset:20992
v_add_f32 v45, 1.0, v45
v_mfma_f32_16x16x32_bf16 v[120:123], v[20:23], a[24:27], v[120:123]
v_exp_f32 v40, v40
v_mfma_f32_16x16x32_bf16 v[124:127], v[20:23], a[28:31], v[124:127]
s_waitcnt lgkmcnt(4)
v_rcp_f32 v45, v45
v_mfma_f32_16x16x32_bf16 v[112:115], v[24:27], a[32:35], v[112:115]
ds_read_b64_tr_b16 v[16:17], v7 offset:24576
v_mul_f32 v41, s59, v71
v_mfma_f32_16x16x32_bf16 v[116:119], v[24:27], a[36:39], v[116:119]
ds_read_b64_tr_b16 v[18:19], v7 offset:25088
v_mul_f32 v68, v68, v44
v_mfma_f32_16x16x32_bf16 v[120:123], v[24:27], a[40:43], v[120:123]
v_exp_f32 v41, v41
v_mfma_f32_16x16x32_bf16 v[124:127], v[24:27], a[44:47], v[124:127]
v_add_f32 v40, 1.0, v40
v_mul_f32 v42, s59, v72
v_mfma_f32_16x16x32_bf16 v[112:115], v[28:31], a[48:51], v[112:115]
ds_read_b64_tr_b16 v[20:21], v7 offset:28672
v_mul_f32 v69, v69, v45
v_mfma_f32_16x16x32_bf16 v[116:119], v[28:31], a[52:55], v[116:119]
ds_read_b64_tr_b16 v[22:23], v7 offset:29184
v_add_f32 v41, 1.0, v41
v_mfma_f32_16x16x32_bf16 v[120:123], v[28:31], a[56:59], v[120:123]
v_rcp_f32 v40, v40
v_mfma_f32_16x16x32_bf16 v[124:127], v[28:31], a[60:63], v[124:127]
s_waitcnt lgkmcnt(4)
v_exp_f32 v42, v42
v_mfma_f32_16x16x32_bf16 v[112:115], v[32:35], a[64:67], v[112:115]
ds_read_b64_tr_b16 v[24:25], v7 offset:32768
v_mul_f32 v43, s59, v73
v_mfma_f32_16x16x32_bf16 v[116:119], v[32:35], a[68:71], v[116:119]
ds_read_b64_tr_b16 v[26:27], v7 offset:33280
v_mul_f32 v70, v70, v40
v_mfma_f32_16x16x32_bf16 v[120:123], v[32:35], a[72:75], v[120:123]
v_rcp_f32 v41, v41
v_mfma_f32_16x16x32_bf16 v[124:127], v[32:35], a[76:79], v[124:127]
v_exp_f32 v43, v43
v_mfma_f32_16x16x32_bf16 v[112:115], v[36:39], a[80:83], v[112:115]
ds_read_b64_tr_b16 v[28:29], v8 offset:0
v_add_f32 v42, 1.0, v42
v_mfma_f32_16x16x32_bf16 v[116:119], v[36:39], a[84:87], v[116:119]
ds_read_b64_tr_b16 v[30:31], v8 offset:512
v_mul_f32 v44, s59, v74
v_mfma_f32_16x16x32_bf16 v[120:123], v[36:39], a[88:91], v[120:123]
v_rcp_f32 v42, v42
v_mfma_f32_16x16x32_bf16 v[124:127], v[36:39], a[92:95], v[124:127]
s_waitcnt lgkmcnt(4)
v_exp_f32 v44, v44
v_mfma_f32_16x16x32_bf16 v[112:115], v[16:19], a[96:99], v[112:115]
ds_read_b64_tr_b16 v[32:33], v8 offset:4096
v_mul_f32 v71, v71, v41
v_mfma_f32_16x16x32_bf16 v[116:119], v[16:19], a[100:103], v[116:119]
ds_read_b64_tr_b16 v[34:35], v8 offset:4608
v_add_f32 v43, 1.0, v43
v_mfma_f32_16x16x32_bf16 v[120:123], v[16:19], a[104:107], v[120:123]
v_rcp_f32 v43, v43
v_mfma_f32_16x16x32_bf16 v[124:127], v[16:19], a[108:111], v[124:127]
v_mul_f32 v45, s59, v75
v_mul_f32 v72, v72, v42
v_mfma_f32_16x16x32_bf16 v[112:115], v[20:23], a[112:115], v[112:115]
ds_read_b64_tr_b16 v[36:37], v8 offset:8192
v_add_f32 v44, 1.0, v44
v_mfma_f32_16x16x32_bf16 v[116:119], v[20:23], a[116:119], v[116:119]
ds_read_b64_tr_b16 v[38:39], v8 offset:8704
v_mul_f32 v40, s59, v76
v_mfma_f32_16x16x32_bf16 v[120:123], v[20:23], a[120:123], v[120:123]
v_exp_f32 v45, v45
v_mfma_f32_16x16x32_bf16 v[124:127], v[20:23], a[124:127], v[124:127]
s_waitcnt lgkmcnt(4)
v_rcp_f32 v44, v44
v_mfma_f32_16x16x32_bf16 v[112:115], v[24:27], a[128:131], v[112:115]
ds_read_b64_tr_b16 v[16:17], v8 offset:12288
v_mul_f32 v73, v73, v43
v_mfma_f32_16x16x32_bf16 v[116:119], v[24:27], a[132:135], v[116:119]
ds_read_b64_tr_b16 v[18:19], v8 offset:12800
v_add_f32 v45, 1.0, v45
v_mfma_f32_16x16x32_bf16 v[120:123], v[24:27], a[136:139], v[120:123]
v_exp_f32 v40, v40
v_mfma_f32_16x16x32_bf16 v[124:127], v[24:27], a[140:143], v[124:127]
v_rcp_f32 v45, v45
v_mfma_f32_16x16x32_bf16 v[112:115], v[28:31], a[144:147], v[112:115]
ds_read_b64_tr_b16 v[20:21], v8 offset:16384
v_mul_f32 v41, s59, v77
v_mfma_f32_16x16x32_bf16 v[116:119], v[28:31], a[148:151], v[116:119]
ds_read_b64_tr_b16 v[22:23], v8 offset:16896
v_mul_f32 v74, v74, v44
v_mfma_f32_16x16x32_bf16 v[120:123], v[28:31], a[152:155], v[120:123]
v_exp_f32 v41, v41
v_mfma_f32_16x16x32_bf16 v[124:127], v[28:31], a[156:159], v[124:127]
s_waitcnt lgkmcnt(4)
v_add_f32 v40, 1.0, v40
v_mul_f32 v42, s59, v78
v_mfma_f32_16x16x32_bf16 v[112:115], v[32:35], a[160:163], v[112:115]
ds_read_b64_tr_b16 v[24:25], v8 offset:20480
v_mul_f32 v75, v75, v45
v_mfma_f32_16x16x32_bf16 v[116:119], v[32:35], a[164:167], v[116:119]
ds_read_b64_tr_b16 v[26:27], v8 offset:20992
v_add_f32 v41, 1.0, v41
v_mfma_f32_16x16x32_bf16 v[120:123], v[32:35], a[168:171], v[120:123]
v_rcp_f32 v40, v40
v_mfma_f32_16x16x32_bf16 v[124:127], v[32:35], a[172:175], v[124:127]
v_exp_f32 v42, v42
v_mfma_f32_16x16x32_bf16 v[112:115], v[36:39], a[176:179], v[112:115]
ds_read_b64_tr_b16 v[28:29], v8 offset:24576
v_mul_f32 v43, s59, v79
v_mfma_f32_16x16x32_bf16 v[116:119], v[36:39], a[180:183], v[116:119]
ds_read_b64_tr_b16 v[30:31], v8 offset:25088
v_mul_f32 v76, v76, v40
v_mfma_f32_16x16x32_bf16 v[120:123], v[36:39], a[184:187], v[120:123]
v_rcp_f32 v41, v41
v_mfma_f32_16x16x32_bf16 v[124:127], v[36:39], a[188:191], v[124:127]
s_waitcnt lgkmcnt(4)
v_exp_f32 v43, v43
v_mfma_f32_16x16x32_bf16 v[112:115], v[16:19], a[192:195], v[112:115]
ds_read_b64_tr_b16 v[32:33], v8 offset:28672
v_add_f32 v42, 1.0, v42
v_mfma_f32_16x16x32_bf16 v[116:119], v[16:19], a[196:199], v[116:119]
ds_read_b64_tr_b16 v[34:35], v8 offset:29184
v_mul_f32 v77, v77, v41
v_mfma_f32_16x16x32_bf16 v[120:123], v[16:19], a[200:203], v[120:123]
v_rcp_f32 v42, v42
v_mfma_f32_16x16x32_bf16 v[124:127], v[16:19], a[204:207], v[124:127]
v_add_f32 v43, 1.0, v43
v_mul_f32 v78, v78, v42
v_mfma_f32_16x16x32_bf16 v[112:115], v[20:23], a[208:211], v[112:115]
ds_read_b64_tr_b16 v[36:37], v8 offset:32768
v_mfma_f32_16x16x32_bf16 v[116:119], v[20:23], a[212:215], v[116:119]
ds_read_b64_tr_b16 v[38:39], v8 offset:33280
v_mfma_f32_16x16x32_bf16 v[120:123], v[20:23], a[216:219], v[120:123]
v_rcp_f32 v43, v43
v_mfma_f32_16x16x32_bf16 v[124:127], v[20:23], a[220:223], v[124:127]
s_waitcnt lgkmcnt(4)
v_mul_f32 v79, v79, v43
v_mul_f32 v128, v64, v128
v_mfma_f32_16x16x32_bf16 v[112:115], v[24:27], a[224:227], v[112:115]
v_xor_b32 v9, 96, v13
v_add_u32 v10, 36864, v9
v_mfma_f32_16x16x32_bf16 v[116:119], v[24:27], a[228:231], v[116:119]
ds_read_b64_tr_b16 v[16:17], v9 offset:0
v_mul_f32 v129, v65, v129
v_mfma_f32_16x16x32_bf16 v[120:123], v[24:27], a[232:235], v[120:123]
ds_read_b64_tr_b16 v[18:19], v9 offset:512
v_mul_f32 v130, v66, v130
v_mfma_f32_16x16x32_bf16 v[124:127], v[24:27], a[236:239], v[124:127]
v_mul_f32 v131, v67, v131
v_cvt_pk_bf16_f32 v50, v128, v129
v_mfma_f32_16x16x32_bf16 v[112:115], v[28:31], a[240:243], v[112:115]
ds_read_b64_tr_b16 v[20:21], v9 offset:4096
v_cvt_pk_bf16_f32 v51, v130, v131
v_mfma_f32_16x16x32_bf16 v[116:119], v[28:31], a[244:247], v[116:119]
ds_read_b64_tr_b16 v[22:23], v9 offset:4608
v_mul_f32 v132, v68, v132
v_mfma_f32_16x16x32_bf16 v[120:123], v[28:31], a[248:251], v[120:123]
v_mul_f32 v133, v69, v133
v_mul_f32 v134, v70, v134
v_mfma_f32_16x16x32_bf16 v[124:127], v[28:31], a[252:255], v[124:127]
s_waitcnt lgkmcnt(4)
v_mul_f32 v135, v71, v135
v_cvt_pk_bf16_f32 v54, v132, v133
v_mfma_f32_16x16x32_bf16 v[112:115], v[32:35], v[224:227], v[112:115]
ds_read_b64_tr_b16 v[24:25], v9 offset:8192
v_cvt_pk_bf16_f32 v55, v134, v135
v_mfma_f32_16x16x32_bf16 v[116:119], v[32:35], v[228:231], v[116:119]
ds_read_b64_tr_b16 v[26:27], v9 offset:8704
v_mul_f32 v136, v72, v136
v_mfma_f32_16x16x32_bf16 v[120:123], v[32:35], v[232:235], v[120:123]
v_mul_f32 v137, v73, v137
v_mul_f32 v138, v74, v138
v_mfma_f32_16x16x32_bf16 v[124:127], v[32:35], v[236:239], v[124:127]
v_mul_f32 v139, v75, v139
v_cvt_pk_bf16_f32 v58, v136, v137
v_mfma_f32_16x16x32_bf16 v[112:115], v[36:39], v[240:243], v[112:115]
ds_read_b64_tr_b16 v[28:29], v9 offset:12288
v_cvt_pk_bf16_f32 v59, v138, v139
v_mfma_f32_16x16x32_bf16 v[116:119], v[36:39], v[244:247], v[116:119]
ds_read_b64_tr_b16 v[30:31], v9 offset:12800
v_mul_f32 v140, v76, v140
v_mfma_f32_16x16x32_bf16 v[120:123], v[36:39], v[248:251], v[120:123]
v_mul_f32 v141, v77, v141
v_mul_f32 v142, v78, v142
v_mfma_f32_16x16x32_bf16 v[124:127], v[36:39], v[252:255], v[124:127]
s_waitcnt lgkmcnt(4)
v_mul_f32 v143, v79, v143
v_cvt_pk_bf16_f32 v62, v140, v141
v_mfma_f32_16x16x32_bf16 v[208:211], v[16:19], a[0:3], 0
ds_read_b64_tr_b16 v[32:33], v9 offset:16384
v_cvt_pk_bf16_f32 v63, v142, v143
v_mfma_f32_16x16x32_bf16 v[212:215], v[16:19], a[4:7], 0
s_add_u32 s76, s79, 0
ds_read_b64_tr_b16 v[34:35], v9 offset:16896
buffer_store_dwordx4 v[48:51], v12, s[28:31], s76 offen offset:0 sc1
v_mfma_f32_16x16x32_bf16 v[216:219], v[16:19], a[8:11], 0
buffer_store_dwordx4 v[52:55], v12, s[28:31], s76 offen offset:1024 sc1
buffer_store_dwordx4 v[56:59], v12, s[28:31], s76 offen offset:2048 sc1
v_mfma_f32_16x16x32_bf16 v[220:223], v[16:19], a[12:15], 0
buffer_store_dwordx4 v[60:63], v12, s[28:31], s76 offen offset:3072 sc1
v_mul_f32 v40, s59, v80
v_mfma_f32_16x16x32_bf16 v[208:211], v[20:23], a[16:19], v[208:211]
ds_read_b64_tr_b16 v[36:37], v9 offset:20480
v_mul_f32 v41, s59, v81
v_mfma_f32_16x16x32_bf16 v[212:215], v[20:23], a[20:23], v[212:215]
ds_read_b64_tr_b16 v[38:39], v9 offset:20992
v_mul_f32 v42, s59, v82
v_mfma_f32_16x16x32_bf16 v[216:219], v[20:23], a[24:27], v[216:219]
v_exp_f32 v40, v40
v_mfma_f32_16x16x32_bf16 v[220:223], v[20:23], a[28:31], v[220:223]
s_waitcnt lgkmcnt(4)
v_exp_f32 v41, v41
v_mfma_f32_16x16x32_bf16 v[208:211], v[24:27], a[32:35], v[208:211]
ds_read_b64_tr_b16 v[16:17], v9 offset:24576
v_add_f32 v40, 1.0, v40
v_mfma_f32_16x16x32_bf16 v[212:215], v[24:27], a[36:39], v[212:215]
ds_read_b64_tr_b16 v[18:19], v9 offset:25088
v_add_f32 v41, 1.0, v41
v_mfma_f32_16x16x32_bf16 v[216:219], v[24:27], a[40:43], v[216:219]
v_rcp_f32 v40, v40
v_mfma_f32_16x16x32_bf16 v[220:223], v[24:27], a[44:47], v[220:223]
v_exp_f32 v42, v42
v_mfma_f32_16x16x32_bf16 v[208:211], v[28:31], a[48:51], v[208:211]
ds_read_b64_tr_b16 v[20:21], v9 offset:28672
v_mul_f32 v43, s59, v83
v_mfma_f32_16x16x32_bf16 v[212:215], v[28:31], a[52:55], v[212:215]
ds_read_b64_tr_b16 v[22:23], v9 offset:29184
v_mul_f32 v80, v80, v40
v_mfma_f32_16x16x32_bf16 v[216:219], v[28:31], a[56:59], v[216:219]
v_rcp_f32 v41, v41
v_mfma_f32_16x16x32_bf16 v[220:223], v[28:31], a[60:63], v[220:223]
s_waitcnt lgkmcnt(4)
v_exp_f32 v43, v43
v_mfma_f32_16x16x32_bf16 v[208:211], v[32:35], a[64:67], v[208:211]
v_add_f32 v42, 1.0, v42
v_mul_f32 v44, s59, v84
v_mfma_f32_16x16x32_bf16 v[212:215], v[32:35], a[68:71], v[212:215]
v_rcp_f32 v42, v42
v_mfma_f32_16x16x32_bf16 v[216:219], v[32:35], a[72:75], v[216:219]
v_exp_f32 v44, v44
v_mfma_f32_16x16x32_bf16 v[220:223], v[32:35], a[76:79], v[220:223]
v_mul_f32 v81, v81, v41
v_add_f32 v43, 1.0, v43
v_mfma_f32_16x16x32_bf16 v[208:211], v[36:39], a[80:83], v[208:211]
s_waitcnt vmcnt(4)
v_rcp_f32 v43, v43
v_mfma_f32_16x16x32_bf16 v[212:215], v[36:39], a[84:87], v[212:215]
s_barrier
v_mov_b32 v15, s57
v_mul_f32 v45, s59, v85
v_mfma_f32_16x16x32_bf16 v[216:219], v[36:39], a[88:91], v[216:219]
s_add_u32 s77, s86, 34611200
buffer_store_dword v15, v0, s[28:31], s77 offen sc1
ds_read_b64_tr_b16 v[24:25], v9 offset:32768
v_mfma_f32_16x16x32_bf16 v[220:223], v[36:39], a[92:95], v[220:223]
s_waitcnt lgkmcnt(1)
ds_read_b64_tr_b16 v[26:27], v9 offset:33280
v_mul_f32 v82, v82, v42
v_mfma_f32_16x16x32_bf16 v[208:211], v[16:19], a[96:99], v[208:211]
ds_read_b64_tr_b16 v[28:29], v10 offset:0
v_add_f32 v44, 1.0, v44
v_mfma_f32_16x16x32_bf16 v[212:215], v[16:19], a[100:103], v[212:215]
ds_read_b64_tr_b16 v[30:31], v10 offset:512
v_mul_f32 v40, s59, v86
v_mfma_f32_16x16x32_bf16 v[216:219], v[16:19], a[104:107], v[216:219]
ds_read_b64_tr_b16 v[32:33], v10 offset:4096
v_mul_f32 v83, v83, v43
v_mfma_f32_16x16x32_bf16 v[220:223], v[16:19], a[108:111], v[220:223]
ds_read_b64_tr_b16 v[34:35], v10 offset:4608
v_mul_f32 v41, s59, v87
v_mfma_f32_16x16x32_bf16 v[208:211], v[20:23], a[112:115], v[208:211]
ds_read_b64_tr_b16 v[36:37], v10 offset:8192
v_mul_f32 v42, s59, v88
v_mfma_f32_16x16x32_bf16 v[212:215], v[20:23], a[116:119], v[212:215]
ds_read_b64_tr_b16 v[38:39], v10 offset:8704
v_mfma_f32_16x16x32_bf16 v[216:219], v[20:23], a[120:123], v[216:219]
v_exp_f32 v45, v45
v_mfma_f32_16x16x32_bf16 v[220:223], v[20:23], a[124:127], v[220:223]
s_waitcnt lgkmcnt(4)
v_rcp_f32 v44, v44
v_mfma_f32_16x16x32_bf16 v[208:211], v[24:27], a[128:131], v[208:211]
ds_read_b64_tr_b16 v[16:17], v10 offset:12288
v_add_f32 v45, 1.0, v45
v_mfma_f32_16x16x32_bf16 v[212:215], v[24:27], a[132:135], v[212:215]
ds_read_b64_tr_b16 v[18:19], v10 offset:12800
v_mul_f32 v84, v84, v44
v_mfma_f32_16x16x32_bf16 v[216:219], v[24:27], a[136:139], v[216:219]
v_exp_f32 v40, v40
v_mfma_f32_16x16x32_bf16 v[220:223], v[24:27], a[140:143], v[220:223]
v_rcp_f32 v45, v45
v_mfma_f32_16x16x32_bf16 v[208:211], v[28:31], a[144:147], v[208:211]
ds_read_b64_tr_b16 v[20:21], v10 offset:16384
v_add_f32 v40, 1.0, v40
v_mfma_f32_16x16x32_bf16 v[212:215], v[28:31], a[148:151], v[212:215]
ds_read_b64_tr_b16 v[22:23], v10 offset:16896
v_mul_f32 v85, v85, v45
v_mfma_f32_16x16x32_bf16 v[216:219], v[28:31], a[152:155], v[216:219]
v_exp_f32 v41, v41
v_mfma_f32_16x16x32_bf16 v[220:223], v[28:31], a[156:159], v[220:223]
s_waitcnt lgkmcnt(4)
v_rcp_f32 v40, v40
v_mfma_f32_16x16x32_bf16 v[208:211], v[32:35], a[160:163], v[208:211]
ds_read_b64_tr_b16 v[24:25], v10 offset:20480
v_add_f32 v41, 1.0, v41
v_mfma_f32_16x16x32_bf16 v[212:215], v[32:35], a[164:167], v[212:215]
ds_read_b64_tr_b16 v[26:27], v10 offset:20992
v_mul_f32 v43, s59, v89
v_mfma_f32_16x16x32_bf16 v[216:219], v[32:35], a[168:171], v[216:219]
v_exp_f32 v42, v42
v_mfma_f32_16x16x32_bf16 v[220:223], v[32:35], a[172:175], v[220:223]
v_rcp_f32 v41, v41
v_mfma_f32_16x16x32_bf16 v[208:211], v[36:39], a[176:179], v[208:211]
ds_read_b64_tr_b16 v[28:29], v10 offset:24576
v_mul_f32 v86, v86, v40
v_mfma_f32_16x16x32_bf16 v[212:215], v[36:39], a[180:183], v[212:215]
ds_read_b64_tr_b16 v[30:31], v10 offset:25088
v_add_f32 v42, 1.0, v42
v_mfma_f32_16x16x32_bf16 v[216:219], v[36:39], a[184:187], v[216:219]
v_exp_f32 v43, v43
v_mfma_f32_16x16x32_bf16 v[220:223], v[36:39], a[188:191], v[220:223]
s_waitcnt lgkmcnt(4)
v_rcp_f32 v42, v42
v_mfma_f32_16x16x32_bf16 v[208:211], v[16:19], a[192:195], v[208:211]
ds_read_b64_tr_b16 v[32:33], v10 offset:28672
v_mul_f32 v44, s59, v90
v_mfma_f32_16x16x32_bf16 v[212:215], v[16:19], a[196:199], v[212:215]
ds_read_b64_tr_b16 v[34:35], v10 offset:29184
v_mul_f32 v87, v87, v41
v_mfma_f32_16x16x32_bf16 v[216:219], v[16:19], a[200:203], v[216:219]
v_exp_f32 v44, v44
v_mfma_f32_16x16x32_bf16 v[220:223], v[16:19], a[204:207], v[220:223]
v_add_f32 v43, 1.0, v43
v_mul_f32 v45, s59, v91
v_mfma_f32_16x16x32_bf16 v[208:211], v[20:23], a[208:211], v[208:211]
ds_read_b64_tr_b16 v[36:37], v10 offset:32768
v_mul_f32 v88, v88, v42
v_mfma_f32_16x16x32_bf16 v[212:215], v[20:23], a[212:215], v[212:215]
ds_read_b64_tr_b16 v[38:39], v10 offset:33280
v_add_f32 v44, 1.0, v44
v_mfma_f32_16x16x32_bf16 v[216:219], v[20:23], a[216:219], v[216:219]
v_rcp_f32 v43, v43
v_mfma_f32_16x16x32_bf16 v[220:223], v[20:23], a[220:223], v[220:223]
s_waitcnt lgkmcnt(4)
v_exp_f32 v45, v45
v_mfma_f32_16x16x32_bf16 v[208:211], v[24:27], a[224:227], v[208:211]
v_rcp_f32 v44, v44
v_mfma_f32_16x16x32_bf16 v[212:215], v[24:27], a[228:231], v[212:215]
v_mul_f32 v40, s59, v92
v_mul_f32 v89, v89, v43
v_mfma_f32_16x16x32_bf16 v[216:219], v[24:27], a[232:235], v[216:219]
v_exp_f32 v40, v40
v_mfma_f32_16x16x32_bf16 v[220:223], v[24:27], a[236:239], v[220:223]
v_add_f32 v45, 1.0, v45
v_mul_f32 v41, s59, v93
v_mfma_f32_16x16x32_bf16 v[208:211], v[28:31], a[240:243], v[208:211]
s_waitcnt lgkmcnt(0)
v_rcp_f32 v45, v45
v_mfma_f32_16x16x32_bf16 v[212:215], v[28:31], a[244:247], v[212:215]
s_barrier
v_exp_f32 v41, v41
v_mfma_f32_16x16x32_bf16 v[216:219], v[28:31], a[248:251], v[216:219]
v_xor_b32 v7, 0, v13
v_add_u32 v7, 83712, v7
v_mfma_f32_16x16x32_bf16 v[220:223], v[28:31], a[252:255], v[220:223]
v_add_u32 v8, 36864, v7
v_and_b32 v5, 0x7f, v5
v_mfma_f32_16x16x32_bf16 v[208:211], v[32:35], v[224:227], v[208:211]
ds_read_b64_tr_b16 v[16:17], v7 offset:0
v_lshrrev_b32 v6, 3, v14
v_mfma_f32_16x16x32_bf16 v[212:215], v[32:35], v[228:231], v[212:215]
ds_read_b64_tr_b16 v[18:19], v7 offset:512
v_lshl_add_u32 v5, v6, 7, v5
v_mfma_f32_16x16x32_bf16 v[216:219], v[32:35], v[232:235], v[216:219]
ds_read_b64_tr_b16 v[20:21], v7 offset:4096
v_xor_b32 v6, 64, v5
v_mfma_f32_16x16x32_bf16 v[220:223], v[32:35], v[236:239], v[220:223]
ds_read_b64_tr_b16 v[22:23], v7 offset:4608
v_mul_f32 v90, v90, v44
v_mfma_f32_16x16x32_bf16 v[208:211], v[36:39], v[240:243], v[208:211]
ds_read_b64_tr_b16 v[24:25], v7 offset:8192
v_add_f32 v40, 1.0, v40
v_mfma_f32_16x16x32_bf16 v[212:215], v[36:39], v[244:247], v[212:215]
ds_read_b64_tr_b16 v[26:27], v7 offset:8704
v_mul_f32 v42, s59, v94
v_mfma_f32_16x16x32_bf16 v[216:219], v[36:39], v[248:251], v[216:219]
ds_read_b64_tr_b16 v[28:29], v7 offset:12288
v_mul_f32 v91, v91, v45
v_mfma_f32_16x16x32_bf16 v[220:223], v[36:39], v[252:255], v[220:223]
s_waitcnt lgkmcnt(3)
ds_read_b64_tr_b16 v[30:31], v7 offset:12800
v_add_f32 v41, 1.0, v41
v_mfma_f32_16x16x32_bf16 v[128:131], v[16:19], a[0:3], 0
ds_read_b64_tr_b16 v[32:33], v7 offset:16384
v_mul_f32 v43, s59, v95
v_mfma_f32_16x16x32_bf16 v[132:135], v[16:19], a[4:7], 0
ds_read_b64_tr_b16 v[34:35], v7 offset:16896
v_mfma_f32_16x16x32_bf16 v[136:139], v[16:19], a[8:11], 0
v_rcp_f32 v40, v40
v_mfma_f32_16x16x32_bf16 v[140:143], v[16:19], a[12:15], 0
v_exp_f32 v42, v42
v_mfma_f32_16x16x32_bf16 v[128:131], v[20:23], a[16:19], v[128:131]
ds_read_b64_tr_b16 v[36:37], v7 offset:20480
v_mul_f32 v92, v92, v40
v_mfma_f32_16x16x32_bf16 v[132:135], v[20:23], a[20:23], v[132:135]
ds_read_b64_tr_b16 v[38:39], v7 offset:20992
v_add_f32 v42, 1.0, v42
v_mfma_f32_16x16x32_bf16 v[136:139], v[20:23], a[24:27], v[136:139]
v_rcp_f32 v41, v41
v_mfma_f32_16x16x32_bf16 v[140:143], v[20:23], a[28:31], v[140:143]
s_waitcnt lgkmcnt(4)
v_exp_f32 v43, v43
v_mfma_f32_16x16x32_bf16 v[128:131], v[24:27], a[32:35], v[128:131]
ds_read_b64_tr_b16 v[16:17], v7 offset:24576
v_mul_f32 v93, v93, v41
v_mfma_f32_16x16x32_bf16 v[132:135], v[24:27], a[36:39], v[132:135]
ds_read_b64_tr_b16 v[18:19], v7 offset:25088
v_add_f32 v43, 1.0, v43
v_mfma_f32_16x16x32_bf16 v[136:139], v[24:27], a[40:43], v[136:139]
v_rcp_f32 v42, v42
v_mfma_f32_16x16x32_bf16 v[140:143], v[24:27], a[44:47], v[140:143]
v_rcp_f32 v43, v43
v_mfma_f32_16x16x32_bf16 v[128:131], v[28:31], a[48:51], v[128:131]
ds_read_b64_tr_b16 v[20:21], v7 offset:28672
v_mul_f32 v94, v94, v42
v_mfma_f32_16x16x32_bf16 v[132:135], v[28:31], a[52:55], v[132:135]
ds_read_b64_tr_b16 v[22:23], v7 offset:29184
v_mul_f32 v95, v95, v43
v_mfma_f32_16x16x32_bf16 v[136:139], v[28:31], a[56:59], v[136:139]
v_mul_f32 v144, v80, v144
v_mul_f32 v145, v81, v145
v_mfma_f32_16x16x32_bf16 v[140:143], v[28:31], a[60:63], v[140:143]
s_waitcnt lgkmcnt(4)
v_mul_f32 v146, v82, v146
v_mul_f32 v147, v83, v147
v_mfma_f32_16x16x32_bf16 v[128:131], v[32:35], a[64:67], v[128:131]
ds_read_b64_tr_b16 v[24:25], v7 offset:32768
v_cvt_pk_bf16_f32 v80, v144, v145
v_mfma_f32_16x16x32_bf16 v[132:135], v[32:35], a[68:71], v[132:135]
ds_read_b64_tr_b16 v[26:27], v7 offset:33280
v_cvt_pk_bf16_f32 v81, v146, v147
v_mfma_f32_16x16x32_bf16 v[136:139], v[32:35], a[72:75], v[136:139]
v_mul_f32 v148, v84, v148
v_mul_f32 v149, v85, v149
v_mfma_f32_16x16x32_bf16 v[140:143], v[32:35], a[76:79], v[140:143]
v_mul_f32 v150, v86, v150
v_mul_f32 v151, v87, v151
v_mfma_f32_16x16x32_bf16 v[128:131], v[36:39], a[80:83], v[128:131]
ds_read_b64_tr_b16 v[28:29], v8 offset:0
v_cvt_pk_bf16_f32 v84, v148, v149
v_mfma_f32_16x16x32_bf16 v[132:135], v[36:39], a[84:87], v[132:135]
ds_read_b64_tr_b16 v[30:31], v8 offset:512
v_cvt_pk_bf16_f32 v85, v150, v151
v_mfma_f32_16x16x32_bf16 v[136:139], v[36:39], a[88:91], v[136:139]
v_mul_f32 v152, v88, v152
v_mul_f32 v153, v89, v153
v_mfma_f32_16x16x32_bf16 v[140:143], v[36:39], a[92:95], v[140:143]
s_waitcnt lgkmcnt(4)
v_mul_f32 v154, v90, v154
v_mul_f32 v155, v91, v155
v_mfma_f32_16x16x32_bf16 v[128:131], v[16:19], a[96:99], v[128:131]
ds_read_b64_tr_b16 v[32:33], v8 offset:4096
v_cvt_pk_bf16_f32 v88, v152, v153
v_mfma_f32_16x16x32_bf16 v[132:135], v[16:19], a[100:103], v[132:135]
ds_read_b64_tr_b16 v[34:35], v8 offset:4608
v_cvt_pk_bf16_f32 v89, v154, v155
v_mfma_f32_16x16x32_bf16 v[136:139], v[16:19], a[104:107], v[136:139]
v_mul_f32 v156, v92, v156
v_mul_f32 v157, v93, v157
v_mfma_f32_16x16x32_bf16 v[140:143], v[16:19], a[108:111], v[140:143]
v_mul_f32 v158, v94, v158
v_mul_f32 v159, v95, v159
v_mfma_f32_16x16x32_bf16 v[128:131], v[20:23], a[112:115], v[128:131]
ds_read_b64_tr_b16 v[36:37], v8 offset:8192
v_cvt_pk_bf16_f32 v92, v156, v157
v_mfma_f32_16x16x32_bf16 v[132:135], v[20:23], a[116:119], v[132:135]
s_add_u32 s81, s83, 34611200
ds_read_b64_tr_b16 v[38:39], v8 offset:8704
buffer_load_dword v2, v11, s[28:31], s81 offen sc1
v_mfma_f32_16x16x32_bf16 v[136:139], v[20:23], a[120:123], v[136:139]
v_cvt_pk_bf16_f32 v93, v158, v159
v_mul_f32 v40, s59, v96
v_mfma_f32_16x16x32_bf16 v[140:143], v[20:23], a[124:127], v[140:143]
s_waitcnt lgkmcnt(4)
v_exp_f32 v40, v40
v_mfma_f32_16x16x32_bf16 v[128:131], v[24:27], a[128:131], v[128:131]
ds_read_b64_tr_b16 v[16:17], v8 offset:12288
v_mul_f32 v41, s59, v97
v_mfma_f32_16x16x32_bf16 v[132:135], v[24:27], a[132:135], v[132:135]
ds_read_b64_tr_b16 v[18:19], v8 offset:12800
v_add_f32 v40, 1.0, v40
v_mfma_f32_16x16x32_bf16 v[136:139], v[24:27], a[136:139], v[136:139]
v_exp_f32 v41, v41
v_mfma_f32_16x16x32_bf16 v[140:143], v[24:27], a[140:143], v[140:143]
v_rcp_f32 v40, v40
v_mfma_f32_16x16x32_bf16 v[128:131], v[28:31], a[144:147], v[128:131]
ds_read_b64_tr_b16 v[20:21], v8 offset:16384
v_mul_f32 v42, s59, v98
v_mfma_f32_16x16x32_bf16 v[132:135], v[28:31], a[148:151], v[132:135]
ds_read_b64_tr_b16 v[22:23], v8 offset:16896
v_add_f32 v41, 1.0, v41
v_mfma_f32_16x16x32_bf16 v[136:139], v[28:31], a[152:155], v[136:139]
v_exp_f32 v42, v42
v_mfma_f32_16x16x32_bf16 v[140:143], v[28:31], a[156:159], v[140:143]
s_waitcnt lgkmcnt(4)
v_rcp_f32 v41, v41
v_mfma_f32_16x16x32_bf16 v[128:131], v[32:35], a[160:163], v[128:131]
ds_read_b64_tr_b16 v[24:25], v8 offset:20480
v_mul_f32 v43, s59, v99
v_mfma_f32_16x16x32_bf16 v[132:135], v[32:35], a[164:167], v[132:135]
ds_read_b64_tr_b16 v[26:27], v8 offset:20992
v_mul_f32 v96, v96, v40
v_mfma_f32_16x16x32_bf16 v[136:139], v[32:35], a[168:171], v[136:139]
v_exp_f32 v43, v43
v_mfma_f32_16x16x32_bf16 v[140:143], v[32:35], a[172:175], v[140:143]
v_add_f32 v42, 1.0, v42
v_mul_f32 v44, s59, v100
v_mfma_f32_16x16x32_bf16 v[128:131], v[36:39], a[176:179], v[128:131]
ds_read_b64_tr_b16 v[28:29], v8 offset:24576
v_mul_f32 v97, v97, v41
v_mfma_f32_16x16x32_bf16 v[132:135], v[36:39], a[180:183], v[132:135]
ds_read_b64_tr_b16 v[30:31], v8 offset:25088
v_add_f32 v43, 1.0, v43
v_mfma_f32_16x16x32_bf16 v[136:139], v[36:39], a[184:187], v[136:139]
v_rcp_f32 v42, v42
v_mfma_f32_16x16x32_bf16 v[140:143], v[36:39], a[188:191], v[140:143]
s_waitcnt lgkmcnt(4)
v_exp_f32 v44, v44
v_mfma_f32_16x16x32_bf16 v[128:131], v[16:19], a[192:195], v[128:131]
ds_read_b64_tr_b16 v[32:33], v8 offset:28672
v_mul_f32 v45, s59, v101
v_mfma_f32_16x16x32_bf16 v[132:135], v[16:19], a[196:199], v[132:135]
ds_read_b64_tr_b16 v[34:35], v8 offset:29184
v_mul_f32 v98, v98, v42
v_mfma_f32_16x16x32_bf16 v[136:139], v[16:19], a[200:203], v[136:139]
v_rcp_f32 v43, v43
v_mfma_f32_16x16x32_bf16 v[140:143], v[16:19], a[204:207], v[140:143]
v_exp_f32 v45, v45
v_mfma_f32_16x16x32_bf16 v[128:131], v[20:23], a[208:211], v[128:131]
ds_read_b64_tr_b16 v[36:37], v8 offset:32768
v_add_f32 v44, 1.0, v44
v_mfma_f32_16x16x32_bf16 v[132:135], v[20:23], a[212:215], v[132:135]
ds_read_b64_tr_b16 v[38:39], v8 offset:33280
v_mul_f32 v40, s59, v102
v_mfma_f32_16x16x32_bf16 v[136:139], v[20:23], a[216:219], v[136:139]
v_rcp_f32 v44, v44
v_mfma_f32_16x16x32_bf16 v[140:143], v[20:23], a[220:223], v[140:143]
s_waitcnt lgkmcnt(4)
v_exp_f32 v40, v40
v_mfma_f32_16x16x32_bf16 v[128:131], v[24:27], a[224:227], v[128:131]
v_xor_b32 v9, 32, v13
v_add_u32 v9, 83712, v9
v_mfma_f32_16x16x32_bf16 v[132:135], v[24:27], a[228:231], v[132:135]
v_add_u32 v10, 36864, v9
v_mul_f32 v99, v99, v43
v_mfma_f32_16x16x32_bf16 v[136:139], v[24:27], a[232:235], v[136:139]
ds_read_b64_tr_b16 v[16:17], v9 offset:0
v_add_f32 v45, 1.0, v45
v_mfma_f32_16x16x32_bf16 v[140:143], v[24:27], a[236:239], v[140:143]
ds_read_b64_tr_b16 v[18:19], v9 offset:512
v_mul_f32 v41, s59, v103
v_mfma_f32_16x16x32_bf16 v[128:131], v[28:31], a[240:243], v[128:131]
ds_read_b64_tr_b16 v[20:21], v9 offset:4096
v_mul_f32 v100, v100, v44
v_mfma_f32_16x16x32_bf16 v[132:135], v[28:31], a[244:247], v[132:135]
ds_read_b64_tr_b16 v[22:23], v9 offset:4608
v_add_f32 v40, 1.0, v40
v_mfma_f32_16x16x32_bf16 v[136:139], v[28:31], a[248:251], v[136:139]
v_rcp_f32 v45, v45
v_mfma_f32_16x16x32_bf16 v[140:143], v[28:31], a[252:255], v[140:143]
s_waitcnt lgkmcnt(4)
v_exp_f32 v41, v41
v_mfma_f32_16x16x32_bf16 v[128:131], v[32:35], v[224:227], v[128:131]
ds_read_b64_tr_b16 v[24:25], v9 offset:8192
v_mul_f32 v42, s59, v104
v_mfma_f32_16x16x32_bf16 v[132:135], v[32:35], v[228:231], v[132:135]
ds_read_b64_tr_b16 v[26:27], v9 offset:8704
v_mul_f32 v101, v101, v45
v_mfma_f32_16x16x32_bf16 v[136:139], v[32:35], v[232:235], v[136:139]
v_rcp_f32 v40, v40
v_mfma_f32_16x16x32_bf16 v[140:143], v[32:35], v[236:239], v[140:143]
v_exp_f32 v42, v42
v_mfma_f32_16x16x32_bf16 v[128:131], v[36:39], v[240:243], v[128:131]
ds_read_b64_tr_b16 v[28:29], v9 offset:12288
v_add_f32 v41, 1.0, v41
v_mfma_f32_16x16x32_bf16 v[132:135], v[36:39], v[244:247], v[132:135]
ds_read_b64_tr_b16 v[30:31], v9 offset:12800
v_mul_f32 v43, s59, v105
v_mfma_f32_16x16x32_bf16 v[136:139], v[36:39], v[248:251], v[136:139]
v_rcp_f32 v41, v41
v_mfma_f32_16x16x32_bf16 v[140:143], v[36:39], v[252:255], v[140:143]
s_waitcnt lgkmcnt(4)
v_exp_f32 v43, v43
v_mfma_f32_16x16x32_bf16 v[64:67], v[16:19], a[0:3], 0
ds_read_b64_tr_b16 v[32:33], v9 offset:16384
v_mul_f32 v102, v102, v40
v_mfma_f32_16x16x32_bf16 v[68:71], v[16:19], a[4:7], 0
ds_read_b64_tr_b16 v[34:35], v9 offset:16896
v_add_f32 v42, 1.0, v42
v_mfma_f32_16x16x32_bf16 v[72:75], v[16:19], a[8:11], 0
v_rcp_f32 v42, v42
v_mfma_f32_16x16x32_bf16 v[76:79], v[16:19], a[12:15], 0
v_mul_f32 v44, s59, v106
v_mul_f32 v103, v103, v41
v_mfma_f32_16x16x32_bf16 v[64:67], v[20:23], a[16:19], v[64:67]
ds_read_b64_tr_b16 v[36:37], v9 offset:20480
v_add_f32 v43, 1.0, v43
v_mfma_f32_16x16x32_bf16 v[68:71], v[20:23], a[20:23], v[68:71]
ds_read_b64_tr_b16 v[38:39], v9 offset:20992
v_mul_f32 v45, s59, v107
v_mfma_f32_16x16x32_bf16 v[72:75], v[20:23], a[24:27], v[72:75]
v_exp_f32 v44, v44
v_mfma_f32_16x16x32_bf16 v[76:79], v[20:23], a[28:31], v[76:79]
s_waitcnt lgkmcnt(4)
v_rcp_f32 v43, v43
v_mfma_f32_16x16x32_bf16 v[64:67], v[24:27], a[32:35], v[64:67]
ds_read_b64_tr_b16 v[16:17], v9 offset:24576
v_mul_f32 v104, v104, v42
v_mfma_f32_16x16x32_bf16 v[68:71], v[24:27], a[36:39], v[68:71]
ds_read_b64_tr_b16 v[18:19], v9 offset:25088
v_add_f32 v44, 1.0, v44
v_mfma_f32_16x16x32_bf16 v[72:75], v[24:27], a[40:43], v[72:75]
v_exp_f32 v45, v45
v_mfma_f32_16x16x32_bf16 v[76:79], v[24:27], a[44:47], v[76:79]
v_rcp_f32 v44, v44
v_mfma_f32_16x16x32_bf16 v[64:67], v[28:31], a[48:51], v[64:67]
ds_read_b64_tr_b16 v[20:21], v9 offset:28672
v_mul_f32 v40, s59, v108
v_mfma_f32_16x16x32_bf16 v[68:71], v[28:31], a[52:55], v[68:71]
ds_read_b64_tr_b16 v[22:23], v9 offset:29184
v_mul_f32 v105, v105, v43
v_mfma_f32_16x16x32_bf16 v[72:75], v[28:31], a[56:59], v[72:75]
v_exp_f32 v40, v40
v_mfma_f32_16x16x32_bf16 v[76:79], v[28:31], a[60:63], v[76:79]
s_waitcnt lgkmcnt(4)
v_add_f32 v45, 1.0, v45
v_mul_f32 v41, s59, v109
v_mfma_f32_16x16x32_bf16 v[64:67], v[32:35], a[64:67], v[64:67]
ds_read_b64_tr_b16 v[24:25], v9 offset:32768
v_mul_f32 v106, v106, v44
v_mfma_f32_16x16x32_bf16 v[68:71], v[32:35], a[68:71], v[68:71]
ds_read_b64_tr_b16 v[26:27], v9 offset:33280
s_waitcnt vmcnt(0)
v_cmp_ne_u32 vcc, s57, v2
s_nop 1
s_cbranch_vccnz L_slow1
L_back1:
v_mfma_f32_16x16x32_bf16 v[72:75], v[32:35], a[72:75], v[72:75]
s_lshr_b32 s87, s48, 1
v_rcp_f32 v45, v45
v_mfma_f32_16x16x32_bf16 v[76:79], v[32:35], a[76:79], v[76:79]
s_add_u32 s87, s87, s0
v_exp_f32 v41, v41
v_mfma_f32_16x16x32_bf16 v[64:67], v[36:39], a[80:83], v[64:67]
s_add_u32 s87, s87, 0
ds_read_b64_tr_b16 v[28:29], v10 offset:0
v_add_f32 v40, 1.0, v40
v_mfma_f32_16x16x32_bf16 v[68:71], v[36:39], a[84:87], v[68:71]
s_sub_u32 s88, s87, 9
ds_read_b64_tr_b16 v[30:31], v10 offset:512
v_mul_f32 v42, s59, v110
v_mfma_f32_16x16x32_bf16 v[72:75], v[36:39], a[88:91], v[72:75]
s_min_u32 s87, s87, s88
v_rcp_f32 v40, v40
v_mfma_f32_16x16x32_bf16 v[76:79], v[36:39], a[92:95], v[76:79]
s_waitcnt lgkmcnt(4)
v_exp_f32 v42, v42
v_mfma_f32_16x16x32_bf16 v[64:67], v[16:19], a[96:99], v[64:67]
s_lshl_b32 s87, s87, 13
ds_read_b64_tr_b16 v[32:33], v10 offset:4096
v_mul_f32 v107, v107, v45
v_mfma_f32_16x16x32_bf16 v[68:71], v[16:19], a[100:103], v[68:71]
s_and_b32 s88, s48, 1
ds_read_b64_tr_b16 v[34:35], v10 offset:4608
v_add_f32 v41, 1.0, v41
v_mfma_f32_16x16x32_bf16 v[72:75], v[16:19], a[104:107], v[72:75]
s_lshl_b32 s88, s88, 12
v_rcp_f32 v41, v41
v_mfma_f32_16x16x32_bf16 v[76:79], v[16:19], a[108:111], v[76:79]
s_add_u32 s87, s87, s88
v_mul_f32 v43, s59, v111
v_mul_f32 v108, v108, v40
v_mfma_f32_16x16x32_bf16 v[64:67], v[20:23], a[112:115], v[64:67]
s_add_u32 s87, s87, s82
ds_read_b64_tr_b16 v[36:37], v10 offset:8192
v_add_f32 v42, 1.0, v42
v_mfma_f32_16x16x32_bf16 v[68:71], v[20:23], a[116:119], v[68:71]
s_add_u32 m0, s62, 0
ds_read_b64_tr_b16 v[38:39], v10 offset:8704
v_mul_f32 v109, v109, v41
v_mfma_f32_16x16x32_bf16 v[72:75], v[20:23], a[120:123], v[72:75]
s_nop 0
buffer_load_dwordx4 v5, s[28:31], s87 offen offset:0 sc1 lds
buffer_load_dwordx4 v6, s[28:31], s87 offen offset:1024 sc1 lds
v_mfma_f32_16x16x32_bf16 v[76:79], v[20:23], a[124:127], v[76:79]
s_waitcnt lgkmcnt(4)
buffer_load_dwordx4 v5, s[28:31], s87 offen offset:2048 sc1 lds
v_mfma_f32_16x16x32_bf16 v[64:67], v[24:27], a[128:131], v[64:67]
ds_read_b64_tr_b16 v[16:17], v10 offset:12288
v_mfma_f32_16x16x32_bf16 v[68:71], v[24:27], a[132:135], v[68:71]
ds_read_b64_tr_b16 v[18:19], v10 offset:12800
v_mfma_f32_16x16x32_bf16 v[72:75], v[24:27], a[136:139], v[72:75]
v_exp_f32 v43, v43
v_mfma_f32_16x16x32_bf16 v[76:79], v[24:27], a[140:143], v[76:79]
v_rcp_f32 v42, v42
v_mfma_f32_16x16x32_bf16 v[64:67], v[28:31], a[144:147], v[64:67]
ds_read_b64_tr_b16 v[20:21], v10 offset:16384
v_add_f32 v43, 1.0, v43
v_mfma_f32_16x16x32_bf16 v[68:71], v[28:31], a[148:151], v[68:71]
ds_read_b64_tr_b16 v[22:23], v10 offset:16896
buffer_load_dwordx4 v6, s[28:31], s87 offen offset:3072 sc1 lds
v_mfma_f32_16x16x32_bf16 v[72:75], v[28:31], a[152:155], v[72:75]
s_lshr_b32 s87, s48, 1
v_rcp_f32 v43, v43
v_mfma_f32_16x16x32_bf16 v[76:79], v[28:31], a[156:159], v[76:79]
s_waitcnt lgkmcnt(4)
v_mul_f32 v110, v110, v42
v_mul_f32 v111, v111, v43
v_mfma_f32_16x16x32_bf16 v[64:67], v[32:35], a[160:163], v[64:67]
s_add_u32 s87, s87, s0
ds_read_b64_tr_b16 v[24:25], v10 offset:20480
v_mul_f32 v160, v96, v160
v_mfma_f32_16x16x32_bf16 v[68:71], v[32:35], a[164:167], v[68:71]
s_add_u32 s87, s87, 2
ds_read_b64_tr_b16 v[26:27], v10 offset:20992
v_mul_f32 v161, v97, v161
v_mfma_f32_16x16x32_bf16 v[72:75], v[32:35], a[168:171], v[72:75]
s_sub_u32 s88, s87, 9
v_mul_f32 v162, v98, v162
v_mul_f32 v163, v99, v163
v_mfma_f32_16x16x32_bf16 v[76:79], v[32:35], a[172:175], v[76:79]
s_min_u32 s87, s87, s88
v_cvt_pk_bf16_f32 v82, v160, v161
v_cvt_pk_bf16_f32 v83, v162, v163
v_mfma_f32_16x16x32_bf16 v[64:67], v[36:39], a[176:179], v[64:67]
s_lshl_b32 s87, s87, 13
ds_read_b64_tr_b16 v[28:29], v10 offset:24576
v_mul_f32 v164, v100, v164
v_mfma_f32_16x16x32_bf16 v[68:71], v[36:39], a[180:183], v[68:71]
s_and_b32 s88, s48, 1
ds_read_b64_tr_b16 v[30:31], v10 offset:25088
v_mul_f32 v165, v101, v165
v_mfma_f32_16x16x32_bf16 v[72:75], v[36:39], a[184:187], v[72:75]
s_lshl_b32 s88, s88, 12
v_mul_f32 v166, v102, v166
v_mul_f32 v167, v103, v167
v_mfma_f32_16x16x32_bf16 v[76:79], v[36:39], a[188:191], v[76:79]
s_waitcnt lgkmcnt(4)
v_cvt_pk_bf16_f32 v86, v164, v165
v_cvt_pk_bf16_f32 v87, v166, v167
v_mfma_f32_16x16x32_bf16 v[64:67], v[16:19], a[192:195], v[64:67]
s_add_u32 s87, s87, s88
ds_read_b64_tr_b16 v[32:33], v10 offset:28672
v_mul_f32 v168, v104, v168
v_mfma_f32_16x16x32_bf16 v[68:71], v[16:19], a[196:199], v[68:71]
s_add_u32 s87, s87, s82
ds_read_b64_tr_b16 v[34:35], v10 offset:29184
v_mul_f32 v169, v105, v169
v_mfma_f32_16x16x32_bf16 v[72:75], v[16:19], a[200:203], v[72:75]
s_add_u32 m0, s62, 16384
v_mul_f32 v170, v106, v170
v_mul_f32 v171, v107, v171
v_mfma_f32_16x16x32_bf16 v[76:79], v[16:19], a[204:207], v[76:79]
s_nop 0
buffer_load_dwordx4 v5, s[28:31], s87 offen offset:0 sc1 lds
buffer_load_dwordx4 v6, s[28:31], s87 offen offset:1024 sc1 lds
v_mfma_f32_16x16x32_bf16 v[64:67], v[20:23], a[208:211], v[64:67]
ds_read_b64_tr_b16 v[36:37], v10 offset:32768
v_cvt_pk_bf16_f32 v90, v168, v169
v_mfma_f32_16x16x32_bf16 v[68:71], v[20:23], a[212:215], v[68:71]
ds_read_b64_tr_b16 v[38:39], v10 offset:33280
v_cvt_pk_bf16_f32 v91, v170, v171
v_mfma_f32_16x16x32_bf16 v[72:75], v[20:23], a[216:219], v[72:75]
v_mul_f32 v172, v108, v172
v_mul_f32 v173, v109, v173
v_mfma_f32_16x16x32_bf16 v[76:79], v[20:23], a[220:223], v[76:79]
s_waitcnt lgkmcnt(4)
v_mul_f32 v174, v110, v174
v_mul_f32 v175, v111, v175
v_mfma_f32_16x16x32_bf16 v[64:67], v[24:27], a[224:227], v[64:67]
v_xor_b32 v7, 64, v13
v_add_u32 v7, 83712, v7
v_mfma_f32_16x16x32_bf16 v[68:71], v[24:27], a[228:231], v[68:71]
buffer_load_dwordx4 v5, s[28:31], s87 offen offset:2048 sc1 lds
v_add_u32 v8, 36864, v7
v_mfma_f32_16x16x32_bf16 v[72:75], v[24:27], a[232:235], v[72:75]
ds_read_b64_tr_b16 v[16:17], v7 offset:0
v_cvt_pk_bf16_f32 v94, v172, v173
v_mfma_f32_16x16x32_bf16 v[76:79], v[24:27], a[236:239], v[76:79]
ds_read_b64_tr_b16 v[18:19], v7 offset:512
v_cvt_pk_bf16_f32 v95, v174, v175
v_mfma_f32_16x16x32_bf16 v[64:67], v[28:31], a[240:243], v[64:67]
s_add_u32 s76, s79, 16384
ds_read_b64_tr_b16 v[20:21], v7 offset:4096
buffer_store_dwordx4 v[80:83], v12, s[28:31], s76 offen offset:0 sc1
v_mfma_f32_16x16x32_bf16 v[68:71], v[28:31], a[244:247], v[68:71]
ds_read_b64_tr_b16 v[22:23], v7 offset:4608
buffer_store_dwordx4 v[84:87], v12, s[28:31], s76 offen offset:1024 sc1
v_mfma_f32_16x16x32_bf16 v[72:75], v[28:31], a[248:251], v[72:75]
buffer_store_dwordx4 v[88:91], v12, s[28:31], s76 offen offset:2048 sc1
buffer_store_dwordx4 v[92:95], v12, s[28:31], s76 offen offset:3072 sc1
v_mfma_f32_16x16x32_bf16 v[76:79], v[28:31], a[252:255], v[76:79]
s_waitcnt lgkmcnt(4)
buffer_load_dwordx4 v6, s[28:31], s87 offen offset:3072 sc1 lds
v_mul_f32 v40, s59, v176
v_mfma_f32_16x16x32_bf16 v[64:67], v[32:35], v[224:227], v[64:67]
s_lshr_b32 s87, s48, 1
ds_read_b64_tr_b16 v[24:25], v7 offset:8192
v_mul_f32 v41, s59, v177
v_mfma_f32_16x16x32_bf16 v[68:71], v[32:35], v[228:231], v[68:71]
s_add_u32 s87, s87, s0
ds_read_b64_tr_b16 v[26:27], v7 offset:8704
v_mul_f32 v42, s59, v178
v_mfma_f32_16x16x32_bf16 v[72:75], v[32:35], v[232:235], v[72:75]
s_add_u32 s87, s87, 4
v_exp_f32 v40, v40
v_mfma_f32_16x16x32_bf16 v[76:79], v[32:35], v[236:239], v[76:79]
s_sub_u32 s88, s87, 9
v_exp_f32 v41, v41
v_mfma_f32_16x16x32_bf16 v[64:67], v[36:39], v[240:243], v[64:67]
s_min_u32 s87, s87, s88
ds_read_b64_tr_b16 v[28:29], v7 offset:12288
v_add_f32 v40, 1.0, v40
v_mfma_f32_16x16x32_bf16 v[68:71], v[36:39], v[244:247], v[68:71]
s_lshl_b32 s87, s87, 13
ds_read_b64_tr_b16 v[30:31], v7 offset:12800
v_add_f32 v41, 1.0, v41
v_mfma_f32_16x16x32_bf16 v[72:75], v[36:39], v[248:251], v[72:75]
s_and_b32 s88, s48, 1
v_rcp_f32 v40, v40
v_mfma_f32_16x16x32_bf16 v[76:79], v[36:39], v[252:255], v[76:79]
s_waitcnt lgkmcnt(4)
v_exp_f32 v42, v42
v_mfma_f32_16x16x32_bf16 v[144:147], v[16:19], a[0:3], 0
s_lshl_b32 s88, s88, 12
ds_read_b64_tr_b16 v[32:33], v7 offset:16384
v_mul_f32 v43, s59, v179
v_mfma_f32_16x16x32_bf16 v[148:151], v[16:19], a[4:7], 0
s_add_u32 s87, s87, s88
ds_read_b64_tr_b16 v[34:35], v7 offset:16896
v_mul_f32 v176, v176, v40
v_mfma_f32_16x16x32_bf16 v[152:155], v[16:19], a[8:11], 0
s_add_u32 s87, s87, s82
v_rcp_f32 v41, v41
v_mfma_f32_16x16x32_bf16 v[156:159], v[16:19], a[12:15], 0
s_add_u32 m0, s62, 32768
v_exp_f32 v43, v43
v_mfma_f32_16x16x32_bf16 v[144:147], v[20:23], a[16:19], v[144:147]
s_nop 0
ds_read_b64_tr_b16 v[36:37], v7 offset:20480
buffer_load_dwordx4 v5, s[28:31], s87 offen offset:0 sc1 lds
v_mfma_f32_16x16x32_bf16 v[148:151], v[20:23], a[20:23], v[148:151]
ds_read_b64_tr_b16 v[38:39], v7 offset:20992
buffer_load_dwordx4 v6, s[28:31], s87 offen offset:1024 sc1 lds
v_mfma_f32_16x16x32_bf16 v[152:155], v[20:23], a[24:27], v[152:155]
v_add_f32 v42, 1.0, v42
v_mul_f32 v44, s59, v180
v_mfma_f32_16x16x32_bf16 v[156:159], v[20:23], a[28:31], v[156:159]
s_waitcnt lgkmcnt(4)
v_rcp_f32 v42, v42
v_mfma_f32_16x16x32_bf16 v[144:147], v[24:27], a[32:35], v[144:147]
ds_read_b64_tr_b16 v[16:17], v7 offset:24576
v_mul_f32 v177, v177, v41
v_mfma_f32_16x16x32_bf16 v[148:151], v[24:27], a[36:39], v[148:151]
ds_read_b64_tr_b16 v[18:19], v7 offset:25088
v_add_f32 v43, 1.0, v43
v_mfma_f32_16x16x32_bf16 v[152:155], v[24:27], a[40:43], v[152:155]
v_exp_f32 v44, v44
v_mfma_f32_16x16x32_bf16 v[156:159], v[24:27], a[44:47], v[156:159]
buffer_load_dwordx4 v5, s[28:31], s87 offen offset:2048 sc1 lds
v_mul_f32 v45, s59, v181
v_mfma_f32_16x16x32_bf16 v[144:147], v[28:31], a[48:51], v[144:147]
ds_read_b64_tr_b16 v[20:21], v7 offset:28672
v_mul_f32 v178, v178, v42
v_mfma_f32_16x16x32_bf16 v[148:151], v[28:31], a[52:55], v[148:151]
ds_read_b64_tr_b16 v[22:23], v7 offset:29184
v_add_f32 v44, 1.0, v44
v_mfma_f32_16x16x32_bf16 v[152:155], v[28:31], a[56:59], v[152:155]
v_rcp_f32 v43, v43
v_mfma_f32_16x16x32_bf16 v[156:159], v[28:31], a[60:63], v[156:159]
s_waitcnt lgkmcnt(4)
v_exp_f32 v45, v45
v_mfma_f32_16x16x32_bf16 v[144:147], v[32:35], a[64:67], v[144:147]
ds_read_b64_tr_b16 v[24:25], v7 offset:32768
v_mul_f32 v40, s59, v182
v_mfma_f32_16x16x32_bf16 v[148:151], v[32:35], a[68:71], v[148:151]
ds_read_b64_tr_b16 v[26:27], v7 offset:33280
v_mul_f32 v179, v179, v43
v_mfma_f32_16x16x32_bf16 v[152:155], v[32:35], a[72:75], v[152:155]
buffer_load_dwordx4 v6, s[28:31], s87 offen offset:3072 sc1 lds
v_add_f32 v45, 1.0, v45
v_mfma_f32_16x16x32_bf16 v[156:159], v[32:35], a[76:79], v[156:159]
s_lshr_b32 s87, s48, 1
v_rcp_f32 v44, v44
v_mfma_f32_16x16x32_bf16 v[144:147], v[36:39], a[80:83], v[144:147]
s_add_u32 s87, s87, s0
ds_read_b64_tr_b16 v[28:29], v8 offset:0
v_mul_f32 v41, s59, v183
v_mfma_f32_16x16x32_bf16 v[148:151], v[36:39], a[84:87], v[148:151]
s_add_u32 s87, s87, 6
ds_read_b64_tr_b16 v[30:31], v8 offset:512
v_mul_f32 v180, v180, v44
v_mfma_f32_16x16x32_bf16 v[152:155], v[36:39], a[88:91], v[152:155]
s_sub_u32 s88, s87, 9
v_exp_f32 v40, v40
v_mfma_f32_16x16x32_bf16 v[156:159], v[36:39], a[92:95], v[156:159]
s_waitcnt lgkmcnt(4)
v_rcp_f32 v45, v45
v_mfma_f32_16x16x32_bf16 v[144:147], v[16:19], a[96:99], v[144:147]
s_min_u32 s87, s87, s88
ds_read_b64_tr_b16 v[32:33], v8 offset:4096
v_add_f32 v40, 1.0, v40
v_mfma_f32_16x16x32_bf16 v[148:151], v[16:19], a[100:103], v[148:151]
s_lshl_b32 s87, s87, 13
ds_read_b64_tr_b16 v[34:35], v8 offset:4608
v_mul_f32 v42, s59, v184
v_mfma_f32_16x16x32_bf16 v[152:155], v[16:19], a[104:107], v[152:155]
s_and_b32 s88, s48, 1
v_exp_f32 v41, v41
v_mfma_f32_16x16x32_bf16 v[156:159], v[16:19], a[108:111], v[156:159]
s_lshl_b32 s88, s88, 12
v_rcp_f32 v40, v40
v_mfma_f32_16x16x32_bf16 v[144:147], v[20:23], a[112:115], v[144:147]
s_add_u32 s87, s87, s88
ds_read_b64_tr_b16 v[36:37], v8 offset:8192
v_mul_f32 v181, v181, v45
v_mfma_f32_16x16x32_bf16 v[148:151], v[20:23], a[116:119], v[148:151]
s_add_u32 s87, s87, s82
ds_read_b64_tr_b16 v[38:39], v8 offset:8704
v_add_f32 v41, 1.0, v41
v_mfma_f32_16x16x32_bf16 v[152:155], v[20:23], a[120:123], v[152:155]
s_add_u32 m0, s62, 49152
v_exp_f32 v42, v42
v_mfma_f32_16x16x32_bf16 v[156:159], v[20:23], a[124:127], v[156:159]
s_waitcnt lgkmcnt(4)
v_rcp_f32 v41, v41
v_mfma_f32_16x16x32_bf16 v[144:147], v[24:27], a[128:131], v[144:147]
s_nop 0
ds_read_b64_tr_b16 v[16:17], v8 offset:12288
buffer_load_dwordx4 v5, s[28:31], s87 offen offset:0 sc1 lds
v_mfma_f32_16x16x32_bf16 v[148:151], v[24:27], a[132:135], v[148:151]
ds_read_b64_tr_b16 v[18:19], v8 offset:12800
buffer_load_dwordx4 v6, s[28:31], s87 offen offset:1024 sc1 lds
v_mfma_f32_16x16x32_bf16 v[152:155], v[24:27], a[136:139], v[152:155]
v_mul_f32 v43, s59, v185
v_mul_f32 v182, v182, v40
v_mfma_f32_16x16x32_bf16 v[156:159], v[24:27], a[140:143], v[156:159]
v_exp_f32 v43, v43
v_mfma_f32_16x16x32_bf16 v[144:147], v[28:31], a[144:147], v[144:147]
ds_read_b64_tr_b16 v[20:21], v8 offset:16384
v_add_f32 v42, 1.0, v42
v_mfma_f32_16x16x32_bf16 v[148:151], v[28:31], a[148:151], v[148:151]
ds_read_b64_tr_b16 v[22:23], v8 offset:16896
v_mul_f32 v44, s59, v186
v_mfma_f32_16x16x32_bf16 v[152:155], v[28:31], a[152:155], v[152:155]
buffer_load_dwordx4 v5, s[28:31], s87 offen offset:2048 sc1 lds
v_mul_f32 v183, v183, v41
v_mfma_f32_16x16x32_bf16 v[156:159], v[28:31], a[156:159], v[156:159]
s_waitcnt lgkmcnt(4)
v_rcp_f32 v42, v42
v_mfma_f32_16x16x32_bf16 v[144:147], v[32:35], a[160:163], v[144:147]
ds_read_b64_tr_b16 v[24:25], v8 offset:20480
v_add_f32 v43, 1.0, v43
v_mfma_f32_16x16x32_bf16 v[148:151], v[32:35], a[164:167], v[148:151]
ds_read_b64_tr_b16 v[26:27], v8 offset:20992
v_mul_f32 v45, s59, v187
v_mfma_f32_16x16x32_bf16 v[152:155], v[32:35], a[168:171], v[152:155]
v_exp_f32 v44, v44
v_mfma_f32_16x16x32_bf16 v[156:159], v[32:35], a[172:175], v[156:159]
v_rcp_f32 v43, v43
v_mfma_f32_16x16x32_bf16 v[144:147], v[36:39], a[176:179], v[144:147]
ds_read_b64_tr_b16 v[28:29], v8 offset:24576
v_mul_f32 v184, v184, v42
v_mfma_f32_16x16x32_bf16 v[148:151], v[36:39], a[180:183], v[148:151]
ds_read_b64_tr_b16 v[30:31], v8 offset:25088
buffer_load_dwordx4 v6, s[28:31], s87 offen offset:3072 sc1 lds
v_mfma_f32_16x16x32_bf16 v[152:155], v[36:39], a[184:187], v[152:155]
s_add_u32 s87, s0, 8
v_exp_f32 v45, v45
v_mfma_f32_16x16x32_bf16 v[156:159], v[36:39], a[188:191], v[156:159]
s_waitcnt lgkmcnt(4)
v_add_f32 v44, 1.0, v44
v_mul_f32 v40, s59, v188
v_mfma_f32_16x16x32_bf16 v[144:147], v[16:19], a[192:195], v[144:147]
s_sub_u32 s88, s87, 9
ds_read_b64_tr_b16 v[32:33], v8 offset:28672
v_mul_f32 v185, v185, v43
v_mfma_f32_16x16x32_bf16 v[148:151], v[16:19], a[196:199], v[148:151]
s_min_u32 s87, s87, s88
ds_read_b64_tr_b16 v[34:35], v8 offset:29184
v_add_f32 v45, 1.0, v45
v_mfma_f32_16x16x32_bf16 v[152:155], v[16:19], a[200:203], v[152:155]
s_lshl_b32 s87, s87, 13
v_rcp_f32 v44, v44
v_mfma_f32_16x16x32_bf16 v[156:159], v[16:19], a[204:207], v[156:159]
s_lshl_b32 s88, s48, 11
v_exp_f32 v40, v40
v_mfma_f32_16x16x32_bf16 v[144:147], v[20:23], a[208:211], v[144:147]
s_add_u32 s87, s87, s88
ds_read_b64_tr_b16 v[36:37], v8 offset:32768
v_mul_f32 v41, s59, v189
v_mfma_f32_16x16x32_bf16 v[148:151], v[20:23], a[212:215], v[148:151]
s_add_u32 s87, s87, s82
ds_read_b64_tr_b16 v[38:39], v8 offset:33280
v_mul_f32 v186, v186, v44
v_mfma_f32_16x16x32_bf16 v[152:155], v[20:23], a[216:219], v[152:155]
s_add_u32 m0, s88, 65536
v_rcp_f32 v45, v45
v_mfma_f32_16x16x32_bf16 v[156:159], v[20:23], a[220:223], v[156:159]
s_waitcnt lgkmcnt(4)
v_exp_f32 v41, v41
v_mfma_f32_16x16x32_bf16 v[144:147], v[24:27], a[224:227], v[144:147]
s_nop 0
buffer_load_dwordx4 v5, s[28:31], s87 offen offset:0 sc1 lds
v_xor_b32 v9, 96, v13
v_mfma_f32_16x16x32_bf16 v[148:151], v[24:27], a[228:231], v[148:151]
v_add_u32 v9, 83712, v9
v_add_u32 v10, 36864, v9
v_mfma_f32_16x16x32_bf16 v[152:155], v[24:27], a[232:235], v[152:155]
ds_read_b64_tr_b16 v[16:17], v9 offset:0
buffer_load_dwordx4 v6, s[28:31], s87 offen offset:1024 sc1 lds
v_mfma_f32_16x16x32_bf16 v[156:159], v[24:27], a[236:239], v[156:159]
ds_read_b64_tr_b16 v[18:19], v9 offset:512
v_add_f32 v40, 1.0, v40
v_mfma_f32_16x16x32_bf16 v[144:147], v[28:31], a[240:243], v[144:147]
ds_read_b64_tr_b16 v[20:21], v9 offset:4096
v_mul_f32 v42, s59, v190
v_mfma_f32_16x16x32_bf16 v[148:151], v[28:31], a[244:247], v[148:151]
ds_read_b64_tr_b16 v[22:23], v9 offset:4608
v_mul_f32 v187, v187, v45
v_mfma_f32_16x16x32_bf16 v[152:155], v[28:31], a[248:251], v[152:155]
v_rcp_f32 v40, v40
v_mfma_f32_16x16x32_bf16 v[156:159], v[28:31], a[252:255], v[156:159]
s_waitcnt lgkmcnt(4)
v_exp_f32 v42, v42
v_mfma_f32_16x16x32_bf16 v[144:147], v[32:35], v[224:227], v[144:147]
ds_read_b64_tr_b16 v[24:25], v9 offset:8192
v_add_f32 v41, 1.0, v41
v_mfma_f32_16x16x32_bf16 v[148:151], v[32:35], v[228:231], v[148:151]
ds_read_b64_tr_b16 v[26:27], v9 offset:8704
v_mul_f32 v43, s59, v191
v_mfma_f32_16x16x32_bf16 v[152:155], v[32:35], v[232:235], v[152:155]
v_rcp_f32 v41, v41
v_mfma_f32_16x16x32_bf16 v[156:159], v[32:35], v[236:239], v[156:159]
v_exp_f32 v43, v43
v_mfma_f32_16x16x32_bf16 v[144:147], v[36:39], v[240:243], v[144:147]
ds_read_b64_tr_b16 v[28:29], v9 offset:12288
v_mul_f32 v188, v188, v40
v_mfma_f32_16x16x32_bf16 v[148:151], v[36:39], v[244:247], v[148:151]
ds_read_b64_tr_b16 v[30:31], v9 offset:12800
v_add_f32 v42, 1.0, v42
v_mfma_f32_16x16x32_bf16 v[152:155], v[36:39], v[248:251], v[152:155]
v_rcp_f32 v42, v42
v_mfma_f32_16x16x32_bf16 v[156:159], v[36:39], v[252:255], v[156:159]
s_waitcnt lgkmcnt(4)
v_mul_f32 v189, v189, v41
v_add_f32 v43, 1.0, v43
v_mfma_f32_16x16x32_bf16 v[160:163], v[16:19], a[0:3], 0
ds_read_b64_tr_b16 v[32:33], v9 offset:16384
v_mul_f32 v190, v190, v42
v_mfma_f32_16x16x32_bf16 v[164:167], v[16:19], a[4:7], 0
ds_read_b64_tr_b16 v[34:35], v9 offset:16896
v_mfma_f32_16x16x32_bf16 v[168:171], v[16:19], a[8:11], 0
v_rcp_f32 v43, v43
v_mfma_f32_16x16x32_bf16 v[172:175], v[16:19], a[12:15], 0
v_mul_f32 v191, v191, v43
v_mul_f32 v128, v176, v128
v_mfma_f32_16x16x32_bf16 v[160:163], v[20:23], a[16:19], v[160:163]
ds_read_b64_tr_b16 v[36:37], v9 offset:20480
v_mul_f32 v129, v177, v129
v_mfma_f32_16x16x32_bf16 v[164:167], v[20:23], a[20:23], v[164:167]
ds_read_b64_tr_b16 v[38:39], v9 offset:20992
v_mul_f32 v130, v178, v130
v_mfma_f32_16x16x32_bf16 v[168:171], v[20:23], a[24:27], v[168:171]
v_mul_f32 v131, v179, v131
v_cvt_pk_bf16_f32 v176, v128, v129
v_mfma_f32_16x16x32_bf16 v[172:175], v[20:23], a[28:31], v[172:175]
s_waitcnt lgkmcnt(4)
v_cvt_pk_bf16_f32 v177, v130, v131
v_mul_f32 v132, v180, v132
v_mfma_f32_16x16x32_bf16 v[160:163], v[24:27], a[32:35], v[160:163]
ds_read_b64_tr_b16 v[16:17], v9 offset:24576
v_mul_f32 v133, v181, v133
v_mfma_f32_16x16x32_bf16 v[164:167], v[24:27], a[36:39], v[164:167]
ds_read_b64_tr_b16 v[18:19], v9 offset:25088
v_mul_f32 v134, v182, v134
v_mfma_f32_16x16x32_bf16 v[168:171], v[24:27], a[40:43], v[168:171]
v_mul_f32 v135, v183, v135
v_cvt_pk_bf16_f32 v180, v132, v133
v_mfma_f32_16x16x32_bf16 v[172:175], v[24:27], a[44:47], v[172:175]
v_cvt_pk_bf16_f32 v181, v134, v135
v_mul_f32 v136, v184, v136
v_mfma_f32_16x16x32_bf16 v[160:163], v[28:31], a[48:51], v[160:163]
ds_read_b64_tr_b16 v[20:21], v9 offset:28672
v_mul_f32 v137, v185, v137
v_mfma_f32_16x16x32_bf16 v[164:167], v[28:31], a[52:55], v[164:167]
ds_read_b64_tr_b16 v[22:23], v9 offset:29184
v_mul_f32 v138, v186, v138
v_mfma_f32_16x16x32_bf16 v[168:171], v[28:31], a[56:59], v[168:171]
v_mul_f32 v139, v187, v139
v_cvt_pk_bf16_f32 v184, v136, v137
v_mfma_f32_16x16x32_bf16 v[172:175], v[28:31], a[60:63], v[172:175]
s_waitcnt lgkmcnt(4)
v_cvt_pk_bf16_f32 v185, v138, v139
v_mul_f32 v140, v188, v140
v_mfma_f32_16x16x32_bf16 v[160:163], v[32:35], a[64:67], v[160:163]
ds_read_b64_tr_b16 v[24:25], v9 offset:32768
v_mul_f32 v141, v189, v141
v_mfma_f32_16x16x32_bf16 v[164:167], v[32:35], a[68:71], v[164:167]
ds_read_b64_tr_b16 v[26:27], v9 offset:33280
v_mul_f32 v142, v190, v142
v_mfma_f32_16x16x32_bf16 v[168:171], v[32:35], a[72:75], v[168:171]
v_mul_f32 v143, v191, v143
v_cvt_pk_bf16_f32 v188, v140, v141
v_mfma_f32_16x16x32_bf16 v[172:175], v[32:35], a[76:79], v[172:175]
v_cvt_pk_bf16_f32 v189, v142, v143
v_mul_f32 v40, s59, v192
v_mfma_f32_16x16x32_bf16 v[160:163], v[36:39], a[80:83], v[160:163]
ds_read_b64_tr_b16 v[28:29], v10 offset:0
v_mul_f32 v41, s59, v193
v_mfma_f32_16x16x32_bf16 v[164:167], v[36:39], a[84:87], v[164:167]
ds_read_b64_tr_b16 v[30:31], v10 offset:512
v_mul_f32 v42, s59, v194
v_mfma_f32_16x16x32_bf16 v[168:171], v[36:39], a[88:91], v[168:171]
v_exp_f32 v40, v40
v_mfma_f32_16x16x32_bf16 v[172:175], v[36:39], a[92:95], v[172:175]
s_waitcnt lgkmcnt(4)
v_exp_f32 v41, v41
v_mfma_f32_16x16x32_bf16 v[160:163], v[16:19], a[96:99], v[160:163]
ds_read_b64_tr_b16 v[32:33], v10 offset:4096
v_add_f32 v40, 1.0, v40
v_mfma_f32_16x16x32_bf16 v[164:167], v[16:19], a[100:103], v[164:167]
ds_read_b64_tr_b16 v[34:35], v10 offset:4608
v_add_f32 v41, 1.0, v41
v_mfma_f32_16x16x32_bf16 v[168:171], v[16:19], a[104:107], v[168:171]
v_rcp_f32 v40, v40
v_mfma_f32_16x16x32_bf16 v[172:175], v[16:19], a[108:111], v[172:175]
v_exp_f32 v42, v42
v_mfma_f32_16x16x32_bf16 v[160:163], v[20:23], a[112:115], v[160:163]
ds_read_b64_tr_b16 v[36:37], v10 offset:8192
v_mul_f32 v43, s59, v195
v_mfma_f32_16x16x32_bf16 v[164:167], v[20:23], a[116:119], v[164:167]
ds_read_b64_tr_b16 v[38:39], v10 offset:8704
v_mul_f32 v192, v192, v40
v_mfma_f32_16x16x32_bf16 v[168:171], v[20:23], a[120:123], v[168:171]
v_rcp_f32 v41, v41
v_mfma_f32_16x16x32_bf16 v[172:175], v[20:23], a[124:127], v[172:175]
s_waitcnt lgkmcnt(4)
v_exp_f32 v43, v43
v_mfma_f32_16x16x32_bf16 v[160:163], v[24:27], a[128:131], v[160:163]
ds_read_b64_tr_b16 v[16:17], v10 offset:12288
v_add_f32 v42, 1.0, v42
v_mfma_f32_16x16x32_bf16 v[164:167], v[24:27], a[132:135], v[164:167]
ds_read_b64_tr_b16 v[18:19], v10 offset:12800
v_mul_f32 v44, s59, v196
v_mfma_f32_16x16x32_bf16 v[168:171], v[24:27], a[136:139], v[168:171]
v_rcp_f32 v42, v42
v_mfma_f32_16x16x32_bf16 v[172:175], v[24:27], a[140:143], v[172:175]
v_exp_f32 v44, v44
v_mfma_f32_16x16x32_bf16 v[160:163], v[28:31], a[144:147], v[160:163]
ds_read_b64_tr_b16 v[20:21], v10 offset:16384
v_mul_f32 v193, v193, v41
v_mfma_f32_16x16x32_bf16 v[164:167], v[28:31], a[148:151], v[164:167]
ds_read_b64_tr_b16 v[22:23], v10 offset:16896
v_add_f32 v43, 1.0, v43
v_mfma_f32_16x16x32_bf16 v[168:171], v[28:31], a[152:155], v[168:171]
v_rcp_f32 v43, v43
v_mfma_f32_16x16x32_bf16 v[172:175], v[28:31], a[156:159], v[172:175]
s_waitcnt lgkmcnt(4)
v_mul_f32 v45, s59, v197
v_mul_f32 v194, v194, v42
v_mfma_f32_16x16x32_bf16 v[160:163], v[32:35], a[160:163], v[160:163]
ds_read_b64_tr_b16 v[24:25], v10 offset:20480
v_add_f32 v44, 1.0, v44
v_mfma_f32_16x16x32_bf16 v[164:167], v[32:35], a[164:167], v[164:167]
ds_read_b64_tr_b16 v[26:27], v10 offset:20992
v_mul_f32 v40, s59, v198
v_mfma_f32_16x16x32_bf16 v[168:171], v[32:35], a[168:171], v[168:171]
v_exp_f32 v45, v45
v_mfma_f32_16x16x32_bf16 v[172:175], v[32:35], a[172:175], v[172:175]
v_rcp_f32 v44, v44
v_mfma_f32_16x16x32_bf16 v[160:163], v[36:39], a[176:179], v[160:163]
ds_read_b64_tr_b16 v[28:29], v10 offset:24576
v_mul_f32 v195, v195, v43
v_mfma_f32_16x16x32_bf16 v[164:167], v[36:39], a[180:183], v[164:167]
ds_read_b64_tr_b16 v[30:31], v10 offset:25088
v_add_f32 v45, 1.0, v45
v_mfma_f32_16x16x32_bf16 v[168:171], v[36:39], a[184:187], v[168:171]
v_exp_f32 v40, v40
v_mfma_f32_16x16x32_bf16 v[172:175], v[36:39], a[188:191], v[172:175]
s_waitcnt lgkmcnt(4)
v_rcp_f32 v45, v45
v_mfma_f32_16x16x32_bf16 v[160:163], v[16:19], a[192:195], v[160:163]
ds_read_b64_tr_b16 v[32:33], v10 offset:28672
v_mul_f32 v41, s59, v199
v_mfma_f32_16x16x32_bf16 v[164:167], v[16:19], a[196:199], v[164:167]
ds_read_b64_tr_b16 v[34:35], v10 offset:29184
v_mul_f32 v196, v196, v44
v_mfma_f32_16x16x32_bf16 v[168:171], v[16:19], a[200:203], v[168:171]
v_exp_f32 v41, v41
v_mfma_f32_16x16x32_bf16 v[172:175], v[16:19], a[204:207], v[172:175]
v_add_f32 v40, 1.0, v40
v_mul_f32 v42, s59, v200
v_mfma_f32_16x16x32_bf16 v[160:163], v[20:23], a[208:211], v[160:163]
ds_read_b64_tr_b16 v[36:37], v10 offset:32768
v_mul_f32 v197, v197, v45
v_mfma_f32_16x16x32_bf16 v[164:167], v[20:23], a[212:215], v[164:167]
ds_read_b64_tr_b16 v[38:39], v10 offset:33280
v_add_f32 v41, 1.0, v41
v_mfma_f32_16x16x32_bf16 v[168:171], v[20:23], a[216:219], v[168:171]
v_rcp_f32 v40, v40
v_mfma_f32_16x16x32_bf16 v[172:175], v[20:23], a[220:223], v[172:175]
s_waitcnt lgkmcnt(4)
v_exp_f32 v42, v42
v_mfma_f32_16x16x32_bf16 v[160:163], v[24:27], a[224:227], v[160:163]
v_rcp_f32 v41, v41
v_mfma_f32_16x16x32_bf16 v[164:167], v[24:27], a[228:231], v[164:167]
v_mul_f32 v43, s59, v201
v_mul_f32 v198, v198, v40
v_mfma_f32_16x16x32_bf16 v[168:171], v[24:27], a[232:235], v[168:171]
v_exp_f32 v43, v43
v_mfma_f32_16x16x32_bf16 v[172:175], v[24:27], a[236:239], v[172:175]
v_add_f32 v42, 1.0, v42
v_mul_f32 v44, s59, v202
v_mfma_f32_16x16x32_bf16 v[160:163], v[28:31], a[240:243], v[160:163]
s_waitcnt vmcnt(0) lgkmcnt(0)
v_rcp_f32 v42, v42
v_mfma_f32_16x16x32_bf16 v[164:167], v[28:31], a[244:247], v[164:167]
s_barrier
v_exp_f32 v44, v44
v_mfma_f32_16x16x32_bf16 v[168:171], v[28:31], a[248:251], v[168:171]
v_and_b32 v46, 0x18, v13
v_and_b32 v47, 0xffffffe7, v13
v_mfma_f32_16x16x32_bf16 v[172:175], v[28:31], a[252:255], v[172:175]
s_mov_b32 s84, 3072
buffer_load_dword v11, v12, s[96:99], s84 offen
v_xor_b32 v7, v46, v47
v_mfma_f32_16x16x32_bf16 v[160:163], v[32:35], v[224:227], v[160:163]
v_add_u32 v8, 36864, v7
v_mul_f32 v199, v199, v41
v_mfma_f32_16x16x32_bf16 v[164:167], v[32:35], v[228:231], v[164:167]
ds_read_b64_tr_b16 v[16:17], v7 offset:0
ds_read_b64_tr_b16 v[18:19], v7 offset:512
v_mfma_f32_16x16x32_bf16 v[168:171], v[32:35], v[232:235], v[168:171]
ds_read_b64_tr_b16 v[20:21], v7 offset:4096
s_mov_b32 s84, 1024
buffer_load_dwordx3 v[2:4], v12, s[96:99], s84 offen
v_mfma_f32_16x16x32_bf16 v[172:175], v[32:35], v[236:239], v[172:175]
ds_read_b64_tr_b16 v[22:23], v7 offset:4608
v_add_f32 v43, 1.0, v43
v_mfma_f32_16x16x32_bf16 v[160:163], v[36:39], v[240:243], v[160:163]
ds_read_b64_tr_b16 v[24:25], v7 offset:8192
s_mov_b32 s84, 2048
buffer_load_dword v1, v12, s[96:99], s84 offen
v_mfma_f32_16x16x32_bf16 v[164:167], v[36:39], v[244:247], v[164:167]
ds_read_b64_tr_b16 v[26:27], v7 offset:8704
v_mul_f32 v45, s59, v203
v_mfma_f32_16x16x32_bf16 v[168:171], v[36:39], v[248:251], v[168:171]
ds_read_b64_tr_b16 v[28:29], v7 offset:12288
v_mul_f32 v200, v200, v42
v_mfma_f32_16x16x32_bf16 v[172:175], v[36:39], v[252:255], v[172:175]
s_waitcnt lgkmcnt(3)
ds_read_b64_tr_b16 v[30:31], v7 offset:12800
v_add_f32 v44, 1.0, v44
v_mfma_f32_16x16x32_bf16 v[96:99], v[16:19], a[0:3], 0
ds_read_b64_tr_b16 v[32:33], v7 offset:16384
v_mul_f32 v40, s59, v204
v_mfma_f32_16x16x32_bf16 v[100:103], v[16:19], a[4:7], 0
ds_read_b64_tr_b16 v[34:35], v7 offset:16896
v_mul_f32 v41, s59, v205
v_mfma_f32_16x16x32_bf16 v[104:107], v[16:19], a[8:11], 0
s_cmp_lt_u32 s48, 2
s_cselect_b32 s40, s8, s12
s_cselect_b32 s41, s9, s13
v_mfma_f32_16x16x32_bf16 v[108:111], v[16:19], a[12:15], 0
s_mul_i32 s78, s53, 224
v_rcp_f32 v43, v43
v_mfma_f32_16x16x32_bf16 v[96:99], v[20:23], a[16:19], v[96:99]
s_sub_u32 s78, s60, s78
ds_read_b64_tr_b16 v[36:37], v7 offset:20480
v_mul_f32 v201, v201, v43
v_mfma_f32_16x16x32_bf16 v[100:103], v[20:23], a[20:23], v[100:103]
s_add_u32 s72, s78, 5120
ds_read_b64_tr_b16 v[38:39], v7 offset:20992
v_mul_f32 v42, s59, v206
v_mfma_f32_16x16x32_bf16 v[104:107], v[20:23], a[24:27], v[104:107]
s_and_b32 s87, s48, 1
v_exp_f32 v45, v45
v_mfma_f32_16x16x32_bf16 v[108:111], v[20:23], a[28:31], v[108:111]
s_waitcnt lgkmcnt(4)
v_rcp_f32 v44, v44
v_mfma_f32_16x16x32_bf16 v[96:99], v[24:27], a[32:35], v[96:99]
s_mul_i32 s87, s87, 9
ds_read_b64_tr_b16 v[16:17], v7 offset:24576
v_add_f32 v45, 1.0, v45
v_mfma_f32_16x16x32_bf16 v[100:103], v[24:27], a[36:39], v[100:103]
s_lshl1_add_u32 s87, s0, s87
ds_read_b64_tr_b16 v[18:19], v7 offset:25088
v_mul_f32 v202, v202, v44
v_mfma_f32_16x16x32_bf16 v[104:107], v[24:27], a[40:43], v[104:107]
s_mul_i32 s74, s87, 294912
v_exp_f32 v40, v40
v_mfma_f32_16x16x32_bf16 v[108:111], v[24:27], a[44:47], v[108:111]
s_mul_i32 s78, s48, 9216
v_rcp_f32 v45, v45
v_mfma_f32_16x16x32_bf16 v[96:99], v[28:31], a[48:51], v[96:99]
s_add_u32 s73, s78, 110592
ds_read_b64_tr_b16 v[20:21], v7 offset:28672
v_add_f32 v40, 1.0, v40
v_mfma_f32_16x16x32_bf16 v[100:103], v[28:31], a[52:55], v[100:103]
s_mov_b32 s66, s83
ds_read_b64_tr_b16 v[22:23], v7 offset:29184
v_mul_f32 v203, v203, v45
v_mfma_f32_16x16x32_bf16 v[104:107], v[28:31], a[56:59], v[104:107]
s_mov_b32 s67, s86
v_exp_f32 v41, v41
v_mfma_f32_16x16x32_bf16 v[108:111], v[28:31], a[60:63], v[108:111]
s_waitcnt lgkmcnt(4)
v_rcp_f32 v40, v40
v_mfma_f32_16x16x32_bf16 v[96:99], v[32:35], a[64:67], v[96:99]
s_sub_u32 s87, s74, 5308416
ds_read_b64_tr_b16 v[24:25], v7 offset:32768
v_add_f32 v41, 1.0, v41
v_mfma_f32_16x16x32_bf16 v[100:103], v[32:35], a[68:71], v[100:103]
s_min_u32 s74, s74, s87
ds_read_b64_tr_b16 v[26:27], v7 offset:33280
v_mul_f32 v43, s59, v207
v_mfma_f32_16x16x32_bf16 v[104:107], v[32:35], a[72:75], v[104:107]
s_add_u32 s78, s72, s74
v_exp_f32 v42, v42
v_mfma_f32_16x16x32_bf16 v[108:111], v[32:35], a[76:79], v[108:111]
s_add_u32 m0, s73, 0
v_rcp_f32 v41, v41
v_mfma_f32_16x16x32_bf16 v[96:99], v[36:39], a[80:83], v[96:99]
s_add_u32 s74, s74, 294912
ds_read_b64_tr_b16 v[28:29], v8 offset:0
s_waitcnt vmcnt(2)
buffer_load_dwordx4 v11, s[40:43], s78 offen lds
v_mfma_f32_16x16x32_bf16 v[100:103], v[36:39], a[84:87], v[100:103]
s_sub_u32 s87, s74, 5308416
ds_read_b64_tr_b16 v[30:31], v8 offset:512
v_mul_f32 v204, v204, v40
v_mfma_f32_16x16x32_bf16 v[104:107], v[36:39], a[88:91], v[104:107]
s_min_u32 s74, s74, s87
v_exp_f32 v43, v43
v_mfma_f32_16x16x32_bf16 v[108:111], v[36:39], a[92:95], v[108:111]
s_waitcnt lgkmcnt(4)
v_add_f32 v42, 1.0, v42
v_mul_f32 v205, v205, v41
v_mfma_f32_16x16x32_bf16 v[96:99], v[16:19], a[96:99], v[96:99]
s_add_u32 s78, s72, s74
ds_read_b64_tr_b16 v[32:33], v8 offset:4096
v_add_f32 v43, 1.0, v43
v_mfma_f32_16x16x32_bf16 v[100:103], v[16:19], a[100:103], v[100:103]
s_add_u32 m0, s73, 1024
ds_read_b64_tr_b16 v[34:35], v8 offset:4608
s_add_u32 s74, s74, 294912
v_mfma_f32_16x16x32_bf16 v[104:107], v[16:19], a[104:107], v[104:107]
buffer_load_dwordx4 v11, s[40:43], s78 offen lds
s_sub_u32 s87, s74, 5308416
v_mfma_f32_16x16x32_bf16 v[108:111], v[16:19], a[108:111], v[108:111]
s_min_u32 s74, s74, s87
v_rcp_f32 v42, v42
v_mfma_f32_16x16x32_bf16 v[96:99], v[20:23], a[112:115], v[96:99]
s_add_u32 s78, s72, s74
ds_read_b64_tr_b16 v[36:37], v8 offset:8192
v_mul_f32 v206, v206, v42
v_mfma_f32_16x16x32_bf16 v[100:103], v[20:23], a[116:119], v[100:103]
s_add_u32 m0, s73, 2048
ds_read_b64_tr_b16 v[38:39], v8 offset:8704
s_add_u32 s74, s74, 294912
v_mfma_f32_16x16x32_bf16 v[104:107], v[20:23], a[120:123], v[104:107]
buffer_load_dwordx4 v11, s[40:43], s78 offen lds
s_sub_u32 s87, s74, 5308416
v_mfma_f32_16x16x32_bf16 v[108:111], v[20:23], a[124:127], v[108:111]
s_waitcnt lgkmcnt(4)
v_rcp_f32 v43, v43
v_mfma_f32_16x16x32_bf16 v[96:99], v[24:27], a[128:131], v[96:99]
s_min_u32 s74, s74, s87
ds_read_b64_tr_b16 v[16:17], v8 offset:12288
v_mul_f32 v207, v207, v43
v_mfma_f32_16x16x32_bf16 v[100:103], v[24:27], a[132:135], v[100:103]
s_add_u32 s78, s72, s74
ds_read_b64_tr_b16 v[18:19], v8 offset:12800
v_mul_f32 v64, v192, v64
v_mfma_f32_16x16x32_bf16 v[104:107], v[24:27], a[136:139], v[104:107]
s_add_u32 m0, s73, 3072
v_mul_f32 v65, v193, v65
v_mul_f32 v66, v194, v66
v_mfma_f32_16x16x32_bf16 v[108:111], v[24:27], a[140:143], v[108:111]
s_add_u32 s74, s74, 294912
v_mul_f32 v67, v195, v67
v_cvt_pk_bf16_f32 v178, v64, v65
v_mfma_f32_16x16x32_bf16 v[96:99], v[28:31], a[144:147], v[96:99]
ds_read_b64_tr_b16 v[20:21], v8 offset:16384
v_cvt_pk_bf16_f32 v179, v66, v67
v_mfma_f32_16x16x32_bf16 v[100:103], v[28:31], a[148:151], v[100:103]
ds_read_b64_tr_b16 v[22:23], v8 offset:16896
v_mul_f32 v68, v196, v68
v_mfma_f32_16x16x32_bf16 v[104:107], v[28:31], a[152:155], v[104:107]
buffer_load_dwordx4 v11, s[40:43], s78 offen lds
v_mul_f32 v69, v197, v69
v_mfma_f32_16x16x32_bf16 v[108:111], v[28:31], a[156:159], v[108:111]
s_waitcnt lgkmcnt(4)
v_mul_f32 v70, v198, v70
v_mul_f32 v71, v199, v71
v_mfma_f32_16x16x32_bf16 v[96:99], v[32:35], a[160:163], v[96:99]
s_sub_u32 s87, s74, 5308416
ds_read_b64_tr_b16 v[24:25], v8 offset:20480
v_cvt_pk_bf16_f32 v182, v68, v69
v_mfma_f32_16x16x32_bf16 v[100:103], v[32:35], a[164:167], v[100:103]
s_min_u32 s74, s74, s87
ds_read_b64_tr_b16 v[26:27], v8 offset:20992
v_cvt_pk_bf16_f32 v183, v70, v71
v_mfma_f32_16x16x32_bf16 v[104:107], v[32:35], a[168:171], v[104:107]
s_add_u32 s78, s72, s74
v_mul_f32 v72, v200, v72
v_mul_f32 v73, v201, v73
v_mfma_f32_16x16x32_bf16 v[108:111], v[32:35], a[172:175], v[108:111]
s_add_u32 m0, s73, 4096
v_mul_f32 v74, v202, v74
v_mul_f32 v75, v203, v75
v_mfma_f32_16x16x32_bf16 v[96:99], v[36:39], a[176:179], v[96:99]
s_add_u32 s74, s74, 294912
ds_read_b64_tr_b16 v[28:29], v8 offset:24576
v_cvt_pk_bf16_f32 v186, v72, v73
v_mfma_f32_16x16x32_bf16 v[100:103], v[36:39], a[180:183], v[100:103]
ds_read_b64_tr_b16 v[30:31], v8 offset:25088
v_cvt_pk_bf16_f32 v187, v74, v75
v_mfma_f32_16x16x32_bf16 v[104:107], v[36:39], a[184:187], v[104:107]
v_mul_f32 v76, v204, v76
v_mul_f32 v77, v205, v77
v_mfma_f32_16x16x32_bf16 v[108:111], v[36:39], a[188:191], v[108:111]
s_waitcnt lgkmcnt(4)
v_mul_f32 v78, v206, v78
v_mul_f32 v79, v207, v79
v_mfma_f32_16x16x32_bf16 v[96:99], v[16:19], a[192:195], v[96:99]
ds_read_b64_tr_b16 v[32:33], v8 offset:28672
v_cvt_pk_bf16_f32 v190, v76, v77
v_mfma_f32_16x16x32_bf16 v[100:103], v[16:19], a[196:199], v[100:103]
ds_read_b64_tr_b16 v[34:35], v8 offset:29184
buffer_load_dwordx4 v11, s[40:43], s78 offen lds
v_mfma_f32_16x16x32_bf16 v[104:107], v[16:19], a[200:203], v[104:107]
s_sub_u32 s87, s74, 5308416
v_cvt_pk_bf16_f32 v191, v78, v79
v_mul_f32 v40, s59, v112
v_mfma_f32_16x16x32_bf16 v[108:111], v[16:19], a[204:207], v[108:111]
s_min_u32 s74, s74, s87
v_exp_f32 v40, v40
v_mfma_f32_16x16x32_bf16 v[96:99], v[20:23], a[208:211], v[96:99]
s_add_u32 s78, s72, s74
ds_read_b64_tr_b16 v[36:37], v8 offset:32768
v_mul_f32 v41, s59, v113
v_mfma_f32_16x16x32_bf16 v[100:103], v[20:23], a[212:215], v[100:103]
s_add_u32 m0, s73, 5120
ds_read_b64_tr_b16 v[38:39], v8 offset:33280
v_add_f32 v40, 1.0, v40
v_mfma_f32_16x16x32_bf16 v[104:107], v[20:23], a[216:219], v[104:107]
s_add_u32 s74, s74, 294912
v_exp_f32 v41, v41
v_mfma_f32_16x16x32_bf16 v[108:111], v[20:23], a[220:223], v[108:111]
s_waitcnt lgkmcnt(4)
v_rcp_f32 v40, v40
v_mfma_f32_16x16x32_bf16 v[96:99], v[24:27], a[224:227], v[96:99]
s_add_u32 s76, s79, 32768
buffer_store_dwordx4 v[176:179], v12, s[28:31], s76 offen offset:0 sc1
buffer_store_dwordx4 v[180:183], v12, s[28:31], s76 offen offset:1024 sc1
v_mfma_f32_16x16x32_bf16 v[100:103], v[24:27], a[228:231], v[100:103]
buffer_store_dwordx4 v[184:187], v12, s[28:31], s76 offen offset:2048 sc1
buffer_store_dwordx4 v[188:191], v12, s[28:31], s76 offen offset:3072 sc1
v_mfma_f32_16x16x32_bf16 v[104:107], v[24:27], a[232:235], v[104:107]
v_and_b32 v46, 0x18, v13
v_add_u32 v46, 40, v46
v_mfma_f32_16x16x32_bf16 v[108:111], v[24:27], a[236:239], v[108:111]
v_and_b32 v47, 0xffffffe7, v13
v_xor_b32 v9, v46, v47
v_mfma_f32_16x16x32_bf16 v[96:99], v[28:31], a[240:243], v[96:99]
buffer_load_dwordx4 v11, s[40:43], s78 offen lds
v_add_u32 v10, 36864, v9
v_mfma_f32_16x16x32_bf16 v[100:103], v[28:31], a[244:247], v[100:103]
s_sub_u32 s87, s74, 5308416
ds_read_b64_tr_b16 v[16:17], v9 offset:0
v_mul_f32 v42, s59, v114
v_mfma_f32_16x16x32_bf16 v[104:107], v[28:31], a[248:251], v[104:107]
s_min_u32 s74, s74, s87
ds_read_b64_tr_b16 v[18:19], v9 offset:512
v_add_f32 v41, 1.0, v41
v_mfma_f32_16x16x32_bf16 v[108:111], v[28:31], a[252:255], v[108:111]
s_waitcnt lgkmcnt(2)
ds_read_b64_tr_b16 v[20:21], v9 offset:4096
v_mul_f32 v43, s59, v115
v_mfma_f32_16x16x32_bf16 v[96:99], v[32:35], v[224:227], v[96:99]
s_add_u32 s78, s72, s74
ds_read_b64_tr_b16 v[22:23], v9 offset:4608
v_mul_f32 v112, v112, v40
v_mfma_f32_16x16x32_bf16 v[100:103], v[32:35], v[228:231], v[100:103]
s_add_u32 m0, s73, 6144
ds_read_b64_tr_b16 v[24:25], v9 offset:8192
v_mul_f32 v44, s59, v116
v_mfma_f32_16x16x32_bf16 v[104:107], v[32:35], v[232:235], v[104:107]
s_add_u32 s74, s74, 294912
ds_read_b64_tr_b16 v[26:27], v9 offset:8704
v_mul_f32 v45, s59, v117
v_mfma_f32_16x16x32_bf16 v[108:111], v[32:35], v[236:239], v[108:111]
v_exp_f32 v42, v42
v_mfma_f32_16x16x32_bf16 v[96:99], v[36:39], v[240:243], v[96:99]
ds_read_b64_tr_b16 v[28:29], v9 offset:12288
v_add_f32 v42, 1.0, v42
v_mfma_f32_16x16x32_bf16 v[100:103], v[36:39], v[244:247], v[100:103]
ds_read_b64_tr_b16 v[30:31], v9 offset:12800
v_mfma_f32_16x16x32_bf16 v[104:107], v[36:39], v[248:251], v[104:107]
v_rcp_f32 v41, v41
v_mfma_f32_16x16x32_bf16 v[108:111], v[36:39], v[252:255], v[108:111]
s_waitcnt lgkmcnt(4)
buffer_load_dwordx4 v11, s[40:43], s78 offen lds
v_mul_f32 v113, v113, v41
v_mfma_f32_16x16x32_bf16 v[48:51], v[16:19], a[0:3], 0
s_sub_u32 s87, s74, 5308416
ds_read_b64_tr_b16 v[32:33], v9 offset:16384
v_mul_f32 v40, s59, v118
v_mfma_f32_16x16x32_bf16 v[52:55], v[16:19], a[4:7], 0
s_min_u32 s74, s74, s87
ds_read_b64_tr_b16 v[34:35], v9 offset:16896
s_add_u32 s78, s72, s74
v_mfma_f32_16x16x32_bf16 v[56:59], v[16:19], a[8:11], 0
s_add_u32 m0, s73, 7168
v_exp_f32 v43, v43
v_mfma_f32_16x16x32_bf16 v[60:63], v[16:19], a[12:15], 0
s_add_u32 s74, s74, 294912
v_rcp_f32 v42, v42
v_mfma_f32_16x16x32_bf16 v[48:51], v[20:23], a[16:19], v[48:51]
ds_read_b64_tr_b16 v[36:37], v9 offset:20480
v_add_f32 v43, 1.0, v43
v_mfma_f32_16x16x32_bf16 v[52:55], v[20:23], a[20:23], v[52:55]
ds_read_b64_tr_b16 v[38:39], v9 offset:20992
v_mul_f32 v114, v114, v42
v_mfma_f32_16x16x32_bf16 v[56:59], v[20:23], a[24:27], v[56:59]
v_exp_f32 v44, v44
v_mfma_f32_16x16x32_bf16 v[60:63], v[20:23], a[28:31], v[60:63]
s_waitcnt lgkmcnt(4)
v_rcp_f32 v43, v43
v_mfma_f32_16x16x32_bf16 v[48:51], v[24:27], a[32:35], v[48:51]
ds_read_b64_tr_b16 v[16:17], v9 offset:24576
v_add_f32 v44, 1.0, v44
v_mfma_f32_16x16x32_bf16 v[52:55], v[24:27], a[36:39], v[52:55]
ds_read_b64_tr_b16 v[18:19], v9 offset:25088
v_mul_f32 v115, v115, v43
v_mfma_f32_16x16x32_bf16 v[56:59], v[24:27], a[40:43], v[56:59]
buffer_load_dwordx4 v11, s[40:43], s78 offen lds
v_mul_f32 v41, s59, v119
v_mfma_f32_16x16x32_bf16 v[60:63], v[24:27], a[44:47], v[60:63]
s_sub_u32 s87, s74, 5308416
v_exp_f32 v45, v45
v_mfma_f32_16x16x32_bf16 v[48:51], v[28:31], a[48:51], v[48:51]
s_min_u32 s74, s74, s87
ds_read_b64_tr_b16 v[20:21], v9 offset:28672
v_add_f32 v45, 1.0, v45
v_mfma_f32_16x16x32_bf16 v[52:55], v[28:31], a[52:55], v[52:55]
s_add_u32 s78, s72, s74
ds_read_b64_tr_b16 v[22:23], v9 offset:29184
v_mul_f32 v42, s59, v120
v_mfma_f32_16x16x32_bf16 v[56:59], v[28:31], a[56:59], v[56:59]
s_add_u32 m0, s73, 8192
v_rcp_f32 v44, v44
v_mfma_f32_16x16x32_bf16 v[60:63], v[28:31], a[60:63], v[60:63]
s_waitcnt lgkmcnt(4)
v_exp_f32 v40, v40
v_mfma_f32_16x16x32_bf16 v[48:51], v[32:35], a[64:67], v[48:51]
s_add_u32 s74, s74, 294912
ds_read_b64_tr_b16 v[24:25], v9 offset:32768
v_mul_f32 v116, v116, v44
v_mfma_f32_16x16x32_bf16 v[52:55], v[32:35], a[68:71], v[52:55]
ds_read_b64_tr_b16 v[26:27], v9 offset:33280
v_add_f32 v40, 1.0, v40
v_mfma_f32_16x16x32_bf16 v[56:59], v[32:35], a[72:75], v[56:59]
v_rcp_f32 v45, v45
v_mfma_f32_16x16x32_bf16 v[60:63], v[32:35], a[76:79], v[60:63]
v_exp_f32 v41, v41
v_mfma_f32_16x16x32_bf16 v[48:51], v[36:39], a[80:83], v[48:51]
ds_read_b64_tr_b16 v[28:29], v10 offset:0
v_mul_f32 v117, v117, v45
v_mfma_f32_16x16x32_bf16 v[52:55], v[36:39], a[84:87], v[52:55]
ds_read_b64_tr_b16 v[30:31], v10 offset:512
buffer_load_dwordx4 v11, s[40:43], s78 offen lds
v_mfma_f32_16x16x32_bf16 v[56:59], v[36:39], a[88:91], v[56:59]
v_rcp_f32 v40, v40
v_mfma_f32_16x16x32_bf16 v[60:63], v[36:39], a[92:95], v[60:63]
s_waitcnt lgkmcnt(4)
v_exp_f32 v42, v42
v_mfma_f32_16x16x32_bf16 v[48:51], v[16:19], a[96:99], v[48:51]
ds_read_b64_tr_b16 v[32:33], v10 offset:4096
v_add_f32 v41, 1.0, v41
v_mfma_f32_16x16x32_bf16 v[52:55], v[16:19], a[100:103], v[52:55]
ds_read_b64_tr_b16 v[34:35], v10 offset:4608
v_mul_f32 v43, s59, v121
v_mfma_f32_16x16x32_bf16 v[56:59], v[16:19], a[104:107], v[56:59]
v_rcp_f32 v41, v41
v_mfma_f32_16x16x32_bf16 v[60:63], v[16:19], a[108:111], v[60:63]
v_exp_f32 v43, v43
v_mfma_f32_16x16x32_bf16 v[48:51], v[20:23], a[112:115], v[48:51]
ds_read_b64_tr_b16 v[36:37], v10 offset:8192
v_mul_f32 v118, v118, v40
v_mfma_f32_16x16x32_bf16 v[52:55], v[20:23], a[116:119], v[52:55]
ds_read_b64_tr_b16 v[38:39], v10 offset:8704
v_add_f32 v42, 1.0, v42
v_mfma_f32_16x16x32_bf16 v[56:59], v[20:23], a[120:123], v[56:59]
v_rcp_f32 v42, v42
v_mfma_f32_16x16x32_bf16 v[60:63], v[20:23], a[124:127], v[60:63]
s_waitcnt lgkmcnt(4)
v_mul_f32 v44, s59, v122
v_mul_f32 v119, v119, v41
v_mfma_f32_16x16x32_bf16 v[48:51], v[24:27], a[128:131], v[48:51]
ds_read_b64_tr_b16 v[16:17], v10 offset:12288
v_add_f32 v43, 1.0, v43
v_mfma_f32_16x16x32_bf16 v[52:55], v[24:27], a[132:135], v[52:55]
ds_read_b64_tr_b16 v[18:19], v10 offset:12800
v_mul_f32 v45, s59, v123
v_mfma_f32_16x16x32_bf16 v[56:59], v[24:27], a[136:139], v[56:59]
v_exp_f32 v44, v44
v_mfma_f32_16x16x32_bf16 v[60:63], v[24:27], a[140:143], v[60:63]
v_rcp_f32 v43, v43
v_mfma_f32_16x16x32_bf16 v[48:51], v[28:31], a[144:147], v[48:51]
ds_read_b64_tr_b16 v[20:21], v10 offset:16384
v_mul_f32 v120, v120, v42
v_mfma_f32_16x16x32_bf16 v[52:55], v[28:31], a[148:151], v[52:55]
ds_read_b64_tr_b16 v[22:23], v10 offset:16896
v_add_f32 v44, 1.0, v44
v_mfma_f32_16x16x32_bf16 v[56:59], v[28:31], a[152:155], v[56:59]
v_exp_f32 v45, v45
v_mfma_f32_16x16x32_bf16 v[60:63], v[28:31], a[156:159], v[60:63]
s_waitcnt lgkmcnt(4)
v_rcp_f32 v44, v44
v_mfma_f32_16x16x32_bf16 v[48:51], v[32:35], a[160:163], v[48:51]
ds_read_b64_tr_b16 v[24:25], v10 offset:20480
v_min_u32 v6, 10, v14
v_mfma_f32_16x16x32_bf16 v[52:55], v[32:35], a[164:167], v[52:55]
ds_read_b64_tr_b16 v[26:27], v10 offset:20992
v_lshlrev_b32 v6, 7, v6
v_mfma_f32_16x16x32_bf16 v[56:59], v[32:35], a[168:171], v[56:59]
s_lshr_b32 s87, s2, 3
v_mul_f32 v40, s59, v124
v_mul_f32 v121, v121, v43
v_mfma_f32_16x16x32_bf16 v[60:63], v[32:35], a[172:175], v[60:63]
s_lshl_b32 s87, s87, 2
v_exp_f32 v40, v40
v_mfma_f32_16x16x32_bf16 v[48:51], v[36:39], a[176:179], v[48:51]
s_add_u32 s87, s87, s48
ds_read_b64_tr_b16 v[28:29], v10 offset:24576
v_add_f32 v45, 1.0, v45
v_mfma_f32_16x16x32_bf16 v[52:55], v[36:39], a[180:183], v[52:55]
s_mul_i32 s78, s87, 1296
ds_read_b64_tr_b16 v[30:31], v10 offset:25088
v_mul_f32 v41, s59, v125
v_mfma_f32_16x16x32_bf16 v[56:59], v[36:39], a[184:187], v[56:59]
s_mul_i32 s88, s49, 165888
v_rcp_f32 v45, v45
v_mfma_f32_16x16x32_bf16 v[60:63], v[36:39], a[188:191], v[60:63]
s_waitcnt lgkmcnt(4)
v_exp_f32 v41, v41
v_mfma_f32_16x16x32_bf16 v[48:51], v[16:19], a[192:195], v[48:51]
s_add_u32 s78, s78, s88
ds_read_b64_tr_b16 v[32:33], v10 offset:28672
v_mul_f32 v122, v122, v44
v_mfma_f32_16x16x32_bf16 v[52:55], v[16:19], a[196:199], v[52:55]
s_add_u32 s78, s78, 4096
ds_read_b64_tr_b16 v[34:35], v10 offset:29184
v_add_f32 v40, 1.0, v40
v_mfma_f32_16x16x32_bf16 v[56:59], v[16:19], a[200:203], v[56:59]
s_mov_b32 m0, 163584
v_rcp_f32 v40, v40
v_mfma_f32_16x16x32_bf16 v[60:63], v[16:19], a[204:207], v[60:63]
s_nop 0
buffer_load_dword v6, s[24:27], s78 offen lds
v_min_u32 v6, 8, v14
v_mfma_f32_16x16x32_bf16 v[48:51], v[20:23], a[208:211], v[48:51]
ds_read_b64_tr_b16 v[36:37], v10 offset:32768
v_lshlrev_b32 v6, 7, v6
v_mfma_f32_16x16x32_bf16 v[52:55], v[20:23], a[212:215], v[52:55]
s_lshr_b32 s88, s87, 6
ds_read_b64_tr_b16 v[38:39], v10 offset:33280
v_mul_f32 v42, s59, v126
v_mfma_f32_16x16x32_bf16 v[56:59], v[20:23], a[216:219], v[56:59]
s_mul_i32 s88, s88, 576
v_exp_f32 v42, v42
v_mfma_f32_16x16x32_bf16 v[60:63], v[20:23], a[220:223], v[60:63]
s_waitcnt lgkmcnt(4)
v_mul_f32 v123, v123, v45
v_add_f32 v41, 1.0, v41
v_mfma_f32_16x16x32_bf16 v[48:51], v[24:27], a[224:227], v[48:51]
s_and_b32 s87, s87, 63
v_rcp_f32 v41, v41
v_mfma_f32_16x16x32_bf16 v[52:55], v[24:27], a[228:231], v[52:55]
s_add_u32 s87, s87, s88
v_and_b32 v46, 0x18, v13
v_add_u32 v46, 80, v46
v_mfma_f32_16x16x32_bf16 v[56:59], v[24:27], a[232:235], v[56:59]
s_mul_i32 s88, s49, 1152
v_and_b32 v47, 0xffffffe7, v13
v_xor_b32 v7, v46, v47
v_mfma_f32_16x16x32_bf16 v[60:63], v[24:27], a[236:239], v[60:63]
s_add_u32 s87, s87, s88
v_add_u32 v8, 36864, v7
v_mul_f32 v43, s59, v127
v_mfma_f32_16x16x32_bf16 v[48:51], v[28:31], a[240:243], v[48:51]
s_mul_i32 s78, s87, 1152
ds_read_b64_tr_b16 v[16:17], v7 offset:0
v_mul_f32 v124, v124, v40
v_mfma_f32_16x16x32_bf16 v[52:55], v[28:31], a[244:247], v[52:55]
s_add_u32 s78, s78, 593920
ds_read_b64_tr_b16 v[18:19], v7 offset:512
v_add_f32 v42, 1.0, v42
v_mfma_f32_16x16x32_bf16 v[56:59], v[28:31], a[248:251], v[56:59]
s_mov_b32 m0, 163584
ds_read_b64_tr_b16 v[20:21], v7 offset:4096
v_mul_f32 v125, v125, v41
v_mfma_f32_16x16x32_bf16 v[60:63], v[28:31], a[252:255], v[60:63]
s_waitcnt lgkmcnt(3)
ds_read_b64_tr_b16 v[22:23], v7 offset:4608
s_nop 0
v_mfma_f32_16x16x32_bf16 v[48:51], v[32:35], v[224:227], v[48:51]
ds_read_b64_tr_b16 v[24:25], v7 offset:8192
buffer_load_dword v6, s[20:23], s78 offen lds
v_mfma_f32_16x16x32_bf16 v[52:55], v[32:35], v[228:231], v[52:55]
s_mul_i32 s82, s49, 1327104
ds_read_b64_tr_b16 v[26:27], v7 offset:8704
s_mul_i32 s78, s55, 288
v_mfma_f32_16x16x32_bf16 v[56:59], v[32:35], v[232:235], v[56:59]
s_add_u32 s82, s82, s78
v_exp_f32 v43, v43
v_mfma_f32_16x16x32_bf16 v[60:63], v[32:35], v[236:239], v[60:63]
s_lshr_b32 s78, s48, 1
v_rcp_f32 v42, v42
v_mfma_f32_16x16x32_bf16 v[48:51], v[36:39], v[240:243], v[48:51]
s_and_b32 s89, s48, 1
ds_read_b64_tr_b16 v[28:29], v7 offset:12288
v_add_f32 v43, 1.0, v43
v_mfma_f32_16x16x32_bf16 v[52:55], v[36:39], v[244:247], v[52:55]
s_mul_i32 s83, s78, 18
ds_read_b64_tr_b16 v[30:31], v7 offset:12800
v_mul_f32 v126, v126, v42
v_mfma_f32_16x16x32_bf16 v[56:59], v[36:39], v[248:251], v[56:59]
s_add_u32 s83, s83, s89
v_rcp_f32 v43, v43
v_mfma_f32_16x16x32_bf16 v[60:63], v[36:39], v[252:255], v[60:63]
s_waitcnt lgkmcnt(4)
v_mul_f32 v127, v127, v43
v_mul_f32 v144, v112, v144
v_mfma_f32_16x16x32_bf16 v[80:83], v[16:19], a[0:3], 0
s_mul_i32 s83, s83, 36864
ds_read_b64_tr_b16 v[32:33], v7 offset:16384
v_mul_f32 v145, v113, v145
v_mfma_f32_16x16x32_bf16 v[84:87], v[16:19], a[4:7], 0
s_add_u32 s83, s83, s82
ds_read_b64_tr_b16 v[34:35], v7 offset:16896
v_mul_f32 v146, v114, v146
v_mfma_f32_16x16x32_bf16 v[88:91], v[16:19], a[8:11], 0
s_lshl_b32 s78, s78, 2
v_mul_f32 v147, v115, v147
v_cvt_pk_bf16_f32 v112, v144, v145
v_mfma_f32_16x16x32_bf16 v[92:95], v[16:19], a[12:15], 0
s_add_u32 s78, s78, s89
v_cvt_pk_bf16_f32 v113, v146, v147
v_mul_f32 v148, v116, v148
v_mfma_f32_16x16x32_bf16 v[80:83], v[20:23], a[16:19], v[80:83]
s_mul_i32 s78, s78, 36864
ds_read_b64_tr_b16 v[36:37], v7 offset:20480
v_mul_f32 v149, v117, v149
v_mfma_f32_16x16x32_bf16 v[84:87], v[20:23], a[20:23], v[84:87]
s_add_u32 s82, s82, s78
ds_read_b64_tr_b16 v[38:39], v7 offset:20992
v_mul_f32 v150, v118, v150
v_mfma_f32_16x16x32_bf16 v[88:91], v[20:23], a[24:27], v[88:91]
s_mul_i32 s62, s48, 9216
v_mul_f32 v151, v119, v151
v_cvt_pk_bf16_f32 v116, v148, v149
v_mfma_f32_16x16x32_bf16 v[92:95], v[20:23], a[28:31], v[92:95]
s_waitcnt lgkmcnt(4)
v_cvt_pk_bf16_f32 v117, v150, v151
v_mul_f32 v152, v120, v152
v_mfma_f32_16x16x32_bf16 v[80:83], v[24:27], a[32:35], v[80:83]
s_and_b32 s78, s56, 1
ds_read_b64_tr_b16 v[16:17], v7 offset:24576
v_mul_f32 v153, v121, v153
v_mfma_f32_16x16x32_bf16 v[84:87], v[24:27], a[36:39], v[84:87]
s_lshl_b32 s78, s78, 3
ds_read_b64_tr_b16 v[18:19], v7 offset:25088
v_mul_f32 v154, v122, v154
v_mfma_f32_16x16x32_bf16 v[88:91], v[24:27], a[40:43], v[88:91]
s_add_u32 s80, s85, s78
v_mul_f32 v155, v123, v155
v_cvt_pk_bf16_f32 v120, v152, v153
v_mfma_f32_16x16x32_bf16 v[92:95], v[24:27], a[44:47], v[92:95]
s_lshl_b32 s78, s48, 1
v_cvt_pk_bf16_f32 v121, v154, v155
v_mul_f32 v156, v124, v156
v_mfma_f32_16x16x32_bf16 v[80:83], v[28:31], a[48:51], v[80:83]
s_sub_u32 s80, s80, s78
ds_read_b64_tr_b16 v[20:21], v7 offset:28672
v_mul_f32 v157, v125, v157
v_mfma_f32_16x16x32_bf16 v[84:87], v[28:31], a[52:55], v[84:87]
s_lshl_b32 s80, s80, 10
ds_read_b64_tr_b16 v[22:23], v7 offset:29184
v_mul_f32 v158, v126, v158
v_mfma_f32_16x16x32_bf16 v[88:91], v[28:31], a[56:59], v[88:91]
s_and_b32 s88, s56, 7
v_mul_f32 v159, v127, v159
v_cvt_pk_bf16_f32 v124, v156, v157
v_mfma_f32_16x16x32_bf16 v[92:95], v[28:31], a[60:63], v[92:95]
s_waitcnt lgkmcnt(4)
v_cvt_pk_bf16_f32 v125, v158, v159
v_mul_f32 v40, s59, v208
v_mfma_f32_16x16x32_bf16 v[80:83], v[32:35], a[64:67], v[80:83]
s_lshl_b32 s87, s55, 1
ds_read_b64_tr_b16 v[24:25], v7 offset:32768
v_mul_f32 v41, s59, v209
v_mfma_f32_16x16x32_bf16 v[84:87], v[32:35], a[68:71], v[84:87]
s_add_u32 s88, s88, s87
ds_read_b64_tr_b16 v[26:27], v7 offset:33280
v_mul_f32 v42, s59, v210
v_mfma_f32_16x16x32_bf16 v[88:91], v[32:35], a[72:75], v[88:91]
s_mul_i32 s88, s88, 1
v_exp_f32 v40, v40
v_mfma_f32_16x16x32_bf16 v[92:95], v[32:35], a[76:79], v[92:95]
s_add_u32 s78, s88, 0
v_exp_f32 v41, v41
v_mfma_f32_16x16x32_bf16 v[80:83], v[36:39], a[80:83], v[80:83]
s_bfe_u32 s87, s78, 0x10001
ds_read_b64_tr_b16 v[28:29], v8 offset:0
v_add_f32 v40, 1.0, v40
v_mfma_f32_16x16x32_bf16 v[84:87], v[36:39], a[84:87], v[84:87]
s_mul_i32 s87, s87, 18
ds_read_b64_tr_b16 v[30:31], v8 offset:512
v_add_f32 v41, 1.0, v41
v_mfma_f32_16x16x32_bf16 v[88:91], v[36:39], a[88:91], v[88:91]
s_bfe_u32 s89, s78, 0x10002
v_rcp_f32 v40, v40
v_mfma_f32_16x16x32_bf16 v[92:95], v[36:39], a[92:95], v[92:95]
s_waitcnt lgkmcnt(4)
v_exp_f32 v42, v42
v_mfma_f32_16x16x32_bf16 v[80:83], v[16:19], a[96:99], v[80:83]
s_lshl1_add_u32 s87, s89, s87
ds_read_b64_tr_b16 v[32:33], v8 offset:4096
v_mul_f32 v43, s59, v211
v_mfma_f32_16x16x32_bf16 v[84:87], v[16:19], a[100:103], v[84:87]
s_and_b32 s78, s78, 1
ds_read_b64_tr_b16 v[34:35], v8 offset:4608
v_mul_f32 v208, v208, v40
v_mfma_f32_16x16x32_bf16 v[88:91], v[16:19], a[104:107], v[88:91]
s_lshl3_add_u32 s78, s78, s87
v_rcp_f32 v41, v41
v_mfma_f32_16x16x32_bf16 v[92:95], v[16:19], a[108:111], v[92:95]
s_mul_i32 s87, s78, 36864
v_exp_f32 v43, v43
v_mfma_f32_16x16x32_bf16 v[80:83], v[20:23], a[112:115], v[80:83]
s_add_u32 s4, s87, s82
ds_read_b64_tr_b16 v[36:37], v8 offset:8192
v_add_f32 v42, 1.0, v42
v_mfma_f32_16x16x32_bf16 v[84:87], v[20:23], a[116:119], v[84:87]
s_mul_i32 s87, s78, 16384
ds_read_b64_tr_b16 v[38:39], v8 offset:8704
v_mul_f32 v44, s59, v212
v_mfma_f32_16x16x32_bf16 v[88:91], v[20:23], a[120:123], v[88:91]
s_add_u32 s44, s87, s80
v_rcp_f32 v42, v42
v_mfma_f32_16x16x32_bf16 v[92:95], v[20:23], a[124:127], v[92:95]
s_waitcnt lgkmcnt(4)
v_exp_f32 v44, v44
v_mfma_f32_16x16x32_bf16 v[80:83], v[24:27], a[128:131], v[80:83]
s_add_u32 s78, s88, 1
ds_read_b64_tr_b16 v[16:17], v8 offset:12288
v_mul_f32 v209, v209, v41
v_mfma_f32_16x16x32_bf16 v[84:87], v[24:27], a[132:135], v[84:87]
s_bfe_u32 s87, s78, 0x10001
ds_read_b64_tr_b16 v[18:19], v8 offset:12800
v_add_f32 v43, 1.0, v43
v_mfma_f32_16x16x32_bf16 v[88:91], v[24:27], a[136:139], v[88:91]
s_mul_i32 s87, s87, 18
v_rcp_f32 v43, v43
v_mfma_f32_16x16x32_bf16 v[92:95], v[24:27], a[140:143], v[92:95]
s_bfe_u32 s89, s78, 0x10002
v_mul_f32 v45, s59, v213
v_mul_f32 v210, v210, v42
v_mfma_f32_16x16x32_bf16 v[80:83], v[28:31], a[144:147], v[80:83]
s_lshl1_add_u32 s87, s89, s87
ds_read_b64_tr_b16 v[20:21], v8 offset:16384
v_add_f32 v44, 1.0, v44
v_mfma_f32_16x16x32_bf16 v[84:87], v[28:31], a[148:151], v[84:87]
s_and_b32 s78, s78, 1
ds_read_b64_tr_b16 v[22:23], v8 offset:16896
v_mul_f32 v40, s59, v214
v_mfma_f32_16x16x32_bf16 v[88:91], v[28:31], a[152:155], v[88:91]
s_lshl3_add_u32 s78, s78, s87
v_exp_f32 v45, v45
v_mfma_f32_16x16x32_bf16 v[92:95], v[28:31], a[156:159], v[92:95]
s_waitcnt lgkmcnt(4)
v_rcp_f32 v44, v44
v_mfma_f32_16x16x32_bf16 v[80:83], v[32:35], a[160:163], v[80:83]
s_mul_i32 s87, s78, 36864
ds_read_b64_tr_b16 v[24:25], v8 offset:20480
v_mul_f32 v211, v211, v43
v_mfma_f32_16x16x32_bf16 v[84:87], v[32:35], a[164:167], v[84:87]
s_add_u32 s5, s87, s82
ds_read_b64_tr_b16 v[26:27], v8 offset:20992
v_add_f32 v45, 1.0, v45
v_mfma_f32_16x16x32_bf16 v[88:91], v[32:35], a[168:171], v[88:91]
s_mul_i32 s87, s78, 16384
v_exp_f32 v40, v40
v_mfma_f32_16x16x32_bf16 v[92:95], v[32:35], a[172:175], v[92:95]
s_add_u32 s45, s87, s80
v_rcp_f32 v45, v45
v_mfma_f32_16x16x32_bf16 v[80:83], v[36:39], a[176:179], v[80:83]
s_add_u32 s78, s88, 2
ds_read_b64_tr_b16 v[28:29], v8 offset:24576
v_mul_f32 v41, s59, v215
v_mfma_f32_16x16x32_bf16 v[84:87], v[36:39], a[180:183], v[84:87]
s_bfe_u32 s87, s78, 0x10001
ds_read_b64_tr_b16 v[30:31], v8 offset:25088
v_mul_f32 v212, v212, v44
v_mfma_f32_16x16x32_bf16 v[88:91], v[36:39], a[184:187], v[88:91]
s_mul_i32 s87, s87, 18
v_exp_f32 v41, v41
v_mfma_f32_16x16x32_bf16 v[92:95], v[36:39], a[188:191], v[92:95]
s_waitcnt lgkmcnt(4)
v_add_f32 v40, 1.0, v40
v_mul_f32 v42, s59, v216
v_mfma_f32_16x16x32_bf16 v[80:83], v[16:19], a[192:195], v[80:83]
s_bfe_u32 s89, s78, 0x10002
ds_read_b64_tr_b16 v[32:33], v8 offset:28672
v_mul_f32 v213, v213, v45
v_mfma_f32_16x16x32_bf16 v[84:87], v[16:19], a[196:199], v[84:87]
s_lshl1_add_u32 s87, s89, s87
ds_read_b64_tr_b16 v[34:35], v8 offset:29184
v_add_f32 v41, 1.0, v41
v_mfma_f32_16x16x32_bf16 v[88:91], v[16:19], a[200:203], v[88:91]
s_and_b32 s78, s78, 1
v_rcp_f32 v40, v40
v_mfma_f32_16x16x32_bf16 v[92:95], v[16:19], a[204:207], v[92:95]
s_lshl3_add_u32 s78, s78, s87
v_exp_f32 v42, v42
v_mfma_f32_16x16x32_bf16 v[80:83], v[20:23], a[208:211], v[80:83]
s_mul_i32 s87, s78, 36864
ds_read_b64_tr_b16 v[36:37], v8 offset:32768
v_mul_f32 v43, s59, v217
v_mfma_f32_16x16x32_bf16 v[84:87], v[20:23], a[212:215], v[84:87]
s_add_u32 s6, s87, s82
ds_read_b64_tr_b16 v[38:39], v8 offset:33280
v_mul_f32 v214, v214, v40
v_mfma_f32_16x16x32_bf16 v[88:91], v[20:23], a[216:219], v[88:91]
s_mul_i32 s87, s78, 16384
v_rcp_f32 v41, v41
v_mfma_f32_16x16x32_bf16 v[92:95], v[20:23], a[220:223], v[92:95]
s_waitcnt lgkmcnt(4)
v_exp_f32 v43, v43
v_mfma_f32_16x16x32_bf16 v[80:83], v[24:27], a[224:227], v[80:83]
s_add_u32 s46, s87, s80
v_and_b32 v46, 0x18, v13
v_mul_u32_u24 v46, 5, v46
v_mfma_f32_16x16x32_bf16 v[84:87], v[24:27], a[228:231], v[84:87]
s_add_u32 s78, s88, 3
v_add_u32 v46, 32, v46
v_min_u32 v46, 120, v46
v_mfma_f32_16x16x32_bf16 v[88:91], v[24:27], a[232:235], v[88:91]
s_bfe_u32 s87, s78, 0x10001
v_and_b32 v47, 0xffffffe7, v13
v_xor_b32 v9, v46, v47
v_mfma_f32_16x16x32_bf16 v[92:95], v[24:27], a[236:239], v[92:95]
s_mul_i32 s87, s87, 18
v_add_u32 v10, 36864, v9
v_add_f32 v42, 1.0, v42
v_mfma_f32_16x16x32_bf16 v[80:83], v[28:31], a[240:243], v[80:83]
s_bfe_u32 s89, s78, 0x10002
ds_read_b64_tr_b16 v[16:17], v9 offset:0
v_mul_f32 v44, s59, v218
v_mfma_f32_16x16x32_bf16 v[84:87], v[28:31], a[244:247], v[84:87]
s_lshl1_add_u32 s87, s89, s87
ds_read_b64_tr_b16 v[18:19], v9 offset:512
v_mul_f32 v215, v215, v41
v_mfma_f32_16x16x32_bf16 v[88:91], v[28:31], a[248:251], v[88:91]
s_and_b32 s78, s78, 1
ds_read_b64_tr_b16 v[20:21], v9 offset:4096
v_add_f32 v43, 1.0, v43
v_mfma_f32_16x16x32_bf16 v[92:95], v[28:31], a[252:255], v[92:95]
s_waitcnt lgkmcnt(3)
ds_read_b64_tr_b16 v[22:23], v9 offset:4608
v_mul_f32 v45, s59, v219
v_mfma_f32_16x16x32_bf16 v[80:83], v[32:35], v[224:227], v[80:83]
s_lshl3_add_u32 s78, s78, s87
ds_read_b64_tr_b16 v[24:25], v9 offset:8192
v_mul_f32 v40, s59, v220
v_mfma_f32_16x16x32_bf16 v[84:87], v[32:35], v[228:231], v[84:87]
s_mul_i32 s87, s78, 36864
ds_read_b64_tr_b16 v[26:27], v9 offset:8704
s_add_u32 s7, s87, s82
v_mfma_f32_16x16x32_bf16 v[88:91], v[32:35], v[232:235], v[88:91]
s_mul_i32 s87, s78, 16384
v_rcp_f32 v42, v42
v_mfma_f32_16x16x32_bf16 v[92:95], v[32:35], v[236:239], v[92:95]
s_add_u32 s47, s87, s80
v_exp_f32 v44, v44
v_mfma_f32_16x16x32_bf16 v[80:83], v[36:39], v[240:243], v[80:83]
s_add_u32 s78, s88, 4
ds_read_b64_tr_b16 v[28:29], v9 offset:12288
v_mul_f32 v216, v216, v42
v_mfma_f32_16x16x32_bf16 v[84:87], v[36:39], v[244:247], v[84:87]
s_bfe_u32 s87, s78, 0x10001
ds_read_b64_tr_b16 v[30:31], v9 offset:12800
v_add_f32 v44, 1.0, v44
v_mfma_f32_16x16x32_bf16 v[88:91], v[36:39], v[248:251], v[88:91]
s_mul_i32 s87, s87, 18
v_rcp_f32 v43, v43
v_mfma_f32_16x16x32_bf16 v[92:95], v[36:39], v[252:255], v[92:95]
s_waitcnt lgkmcnt(4)
v_exp_f32 v45, v45
v_mfma_f32_16x16x32_bf16 v[128:131], v[16:19], a[0:3], 0
s_bfe_u32 s89, s78, 0x10002
ds_read_b64_tr_b16 v[32:33], v9 offset:16384
v_mul_f32 v217, v217, v43
v_mfma_f32_16x16x32_bf16 v[132:135], v[16:19], a[4:7], 0
s_lshl1_add_u32 s87, s89, s87
ds_read_b64_tr_b16 v[34:35], v9 offset:16896
v_add_f32 v45, 1.0, v45
v_mfma_f32_16x16x32_bf16 v[136:139], v[16:19], a[8:11], 0
s_and_b32 s78, s78, 1
v_rcp_f32 v44, v44
v_mfma_f32_16x16x32_bf16 v[140:143], v[16:19], a[12:15], 0
s_lshl3_add_u32 s78, s78, s87
v_exp_f32 v40, v40
v_mfma_f32_16x16x32_bf16 v[128:131], v[20:23], a[16:19], v[128:131]
s_mul_i32 s87, s78, 36864
ds_read_b64_tr_b16 v[36:37], v9 offset:20480
v_mul_f32 v41, s59, v221
v_mfma_f32_16x16x32_bf16 v[132:135], v[20:23], a[20:23], v[132:135]
s_add_u32 s16, s87, s82
ds_read_b64_tr_b16 v[38:39], v9 offset:20992
v_mul_f32 v218, v218, v44
v_mfma_f32_16x16x32_bf16 v[136:139], v[20:23], a[24:27], v[136:139]
s_mul_i32 s87, s78, 16384
v_rcp_f32 v45, v45
v_mfma_f32_16x16x32_bf16 v[140:143], v[20:23], a[28:31], v[140:143]
s_waitcnt lgkmcnt(4)
v_exp_f32 v41, v41
v_mfma_f32_16x16x32_bf16 v[128:131], v[24:27], a[32:35], v[128:131]
s_add_u32 s3, s87, s80
ds_read_b64_tr_b16 v[16:17], v9 offset:24576
v_add_f32 v40, 1.0, v40
v_mfma_f32_16x16x32_bf16 v[132:135], v[24:27], a[36:39], v[132:135]
s_add_u32 s78, s88, 5
ds_read_b64_tr_b16 v[18:19], v9 offset:25088
v_mul_f32 v42, s59, v222
v_mfma_f32_16x16x32_bf16 v[136:139], v[24:27], a[40:43], v[136:139]
s_bfe_u32 s87, s78, 0x10001
v_rcp_f32 v40, v40
v_mfma_f32_16x16x32_bf16 v[140:143], v[24:27], a[44:47], v[140:143]
s_mul_i32 s87, s87, 18
v_exp_f32 v42, v42
v_mfma_f32_16x16x32_bf16 v[128:131], v[28:31], a[48:51], v[128:131]
s_bfe_u32 s89, s78, 0x10002
ds_read_b64_tr_b16 v[20:21], v9 offset:28672
v_mul_f32 v219, v219, v45
v_mfma_f32_16x16x32_bf16 v[132:135], v[28:31], a[52:55], v[132:135]
s_lshl1_add_u32 s87, s89, s87
ds_read_b64_tr_b16 v[22:23], v9 offset:29184
v_add_f32 v41, 1.0, v41
v_mfma_f32_16x16x32_bf16 v[136:139], v[28:31], a[56:59], v[136:139]
s_and_b32 s78, s78, 1
v_rcp_f32 v41, v41
v_mfma_f32_16x16x32_bf16 v[140:143], v[28:31], a[60:63], v[140:143]
s_waitcnt lgkmcnt(4)
v_mul_f32 v43, s59, v223
v_mul_f32 v220, v220, v40
v_mfma_f32_16x16x32_bf16 v[128:131], v[32:35], a[64:67], v[128:131]
s_lshl3_add_u32 s78, s78, s87
ds_read_b64_tr_b16 v[24:25], v9 offset:32768
v_add_f32 v42, 1.0, v42
v_mfma_f32_16x16x32_bf16 v[132:135], v[32:35], a[68:71], v[132:135]
s_mul_i32 s87, s78, 36864
ds_read_b64_tr_b16 v[26:27], v9 offset:33280
v_mul_f32 v221, v221, v41
v_mfma_f32_16x16x32_bf16 v[136:139], v[32:35], a[72:75], v[136:139]
s_add_u32 s17, s87, s82
v_exp_f32 v43, v43
v_mfma_f32_16x16x32_bf16 v[140:143], v[32:35], a[76:79], v[140:143]
s_mul_i32 s87, s78, 16384
v_rcp_f32 v42, v42
v_mfma_f32_16x16x32_bf16 v[128:131], v[36:39], a[80:83], v[128:131]
s_add_u32 s94, s87, s80
ds_read_b64_tr_b16 v[28:29], v10 offset:0
v_add_f32 v43, 1.0, v43
v_mfma_f32_16x16x32_bf16 v[132:135], v[36:39], a[84:87], v[132:135]
s_add_u32 s78, s88, 6
ds_read_b64_tr_b16 v[30:31], v10 offset:512
v_mul_f32 v222, v222, v42
v_mfma_f32_16x16x32_bf16 v[136:139], v[36:39], a[88:91], v[136:139]
s_bfe_u32 s87, s78, 0x10001
v_rcp_f32 v43, v43
v_mfma_f32_16x16x32_bf16 v[140:143], v[36:39], a[92:95], v[140:143]
s_waitcnt lgkmcnt(4)
v_mul_f32 v223, v223, v43
v_mul_f32 v160, v208, v160
v_mfma_f32_16x16x32_bf16 v[128:131], v[16:19], a[96:99], v[128:131]
s_mul_i32 s87, s87, 18
ds_read_b64_tr_b16 v[32:33], v10 offset:4096
v_mul_f32 v161, v209, v161
v_mfma_f32_16x16x32_bf16 v[132:135], v[16:19], a[100:103], v[132:135]
s_bfe_u32 s89, s78, 0x10002
ds_read_b64_tr_b16 v[34:35], v10 offset:4608
v_mul_f32 v162, v210, v162
v_mfma_f32_16x16x32_bf16 v[136:139], v[16:19], a[104:107], v[136:139]
s_lshl1_add_u32 s87, s89, s87
v_mul_f32 v163, v211, v163
v_cvt_pk_bf16_f32 v114, v160, v161
v_mfma_f32_16x16x32_bf16 v[140:143], v[16:19], a[108:111], v[140:143]
s_and_b32 s78, s78, 1
v_cvt_pk_bf16_f32 v115, v162, v163
v_mul_f32 v164, v212, v164
v_mfma_f32_16x16x32_bf16 v[128:131], v[20:23], a[112:115], v[128:131]
s_lshl3_add_u32 s78, s78, s87
ds_read_b64_tr_b16 v[36:37], v10 offset:8192
v_mul_f32 v165, v213, v165
v_mfma_f32_16x16x32_bf16 v[132:135], v[20:23], a[116:119], v[132:135]
s_mul_i32 s87, s78, 36864
ds_read_b64_tr_b16 v[38:39], v10 offset:8704
v_mul_f32 v166, v214, v166
v_mfma_f32_16x16x32_bf16 v[136:139], v[20:23], a[120:123], v[136:139]
s_add_u32 s18, s87, s82
v_mul_f32 v167, v215, v167
v_cvt_pk_bf16_f32 v118, v164, v165
v_mfma_f32_16x16x32_bf16 v[140:143], v[20:23], a[124:127], v[140:143]
s_waitcnt lgkmcnt(4)
v_cvt_pk_bf16_f32 v119, v166, v167
v_mul_f32 v168, v216, v168
v_mfma_f32_16x16x32_bf16 v[128:131], v[24:27], a[128:131], v[128:131]
s_mul_i32 s87, s78, 16384
ds_read_b64_tr_b16 v[16:17], v10 offset:12288
v_mul_f32 v169, v217, v169
v_mfma_f32_16x16x32_bf16 v[132:135], v[24:27], a[132:135], v[132:135]
s_add_u32 s95, s87, s80
ds_read_b64_tr_b16 v[18:19], v10 offset:12800
v_mul_f32 v170, v218, v170
v_mfma_f32_16x16x32_bf16 v[136:139], v[24:27], a[136:139], v[136:139]
s_add_u32 s78, s88, 7
v_mul_f32 v171, v219, v171
v_cvt_pk_bf16_f32 v122, v168, v169
v_mfma_f32_16x16x32_bf16 v[140:143], v[24:27], a[140:143], v[140:143]
s_bfe_u32 s87, s78, 0x10001
v_cvt_pk_bf16_f32 v123, v170, v171
v_mul_f32 v172, v220, v172
v_mfma_f32_16x16x32_bf16 v[128:131], v[28:31], a[144:147], v[128:131]
s_mul_i32 s87, s87, 18
ds_read_b64_tr_b16 v[20:21], v10 offset:16384
v_mul_f32 v173, v221, v173
v_mfma_f32_16x16x32_bf16 v[132:135], v[28:31], a[148:151], v[132:135]
s_bfe_u32 s89, s78, 0x10002
ds_read_b64_tr_b16 v[22:23], v10 offset:16896
v_mul_f32 v174, v222, v174
v_mfma_f32_16x16x32_bf16 v[136:139], v[28:31], a[152:155], v[136:139]
s_lshl1_add_u32 s87, s89, s87
v_mul_f32 v175, v223, v175
v_cvt_pk_bf16_f32 v126, v172, v173
v_mfma_f32_16x16x32_bf16 v[140:143], v[28:31], a[156:159], v[140:143]
s_waitcnt lgkmcnt(4)
v_cvt_pk_bf16_f32 v127, v174, v175
v_add_u32 v154, 0, v14
v_mfma_f32_16x16x32_bf16 v[128:131], v[32:35], a[160:163], v[128:131]
s_and_b32 s78, s78, 1
ds_read_b64_tr_b16 v[24:25], v10 offset:20480
v_mul_u32_u24 v155, 3641, v154
v_mfma_f32_16x16x32_bf16 v[132:135], v[32:35], a[164:167], v[132:135]
s_lshl3_add_u32 s78, s78, s87
ds_read_b64_tr_b16 v[26:27], v10 offset:20992
v_lshrrev_b32 v155, 16, v155
v_mfma_f32_16x16x32_bf16 v[136:139], v[32:35], a[168:171], v[136:139]
s_mul_i32 s87, s78, 36864
v_mul_u32_u24 v155, 864, v155
v_lshl_add_u32 v144, v154, 4, v155
v_mfma_f32_16x16x32_bf16 v[140:143], v[32:35], a[172:175], v[140:143]
s_add_u32 s19, s87, s82
v_add_u32 v144, 4096, v144
v_add_u32 v154, 64, v14
v_mfma_f32_16x16x32_bf16 v[128:131], v[36:39], a[176:179], v[128:131]
s_mul_i32 s87, s78, 16384
ds_read_b64_tr_b16 v[28:29], v10 offset:24576
v_mul_u32_u24 v155, 3641, v154
v_mfma_f32_16x16x32_bf16 v[132:135], v[36:39], a[180:183], v[132:135]
s_add_u32 s61, s87, s80
ds_read_b64_tr_b16 v[30:31], v10 offset:25088
v_lshrrev_b32 v155, 16, v155
v_mfma_f32_16x16x32_bf16 v[136:139], v[36:39], a[184:187], v[136:139]
s_add_u32 s76, s79, 49152
buffer_store_dwordx4 v[112:115], v12, s[28:31], s76 offen offset:0 sc1
buffer_store_dwordx4 v[116:119], v12, s[28:31], s76 offen offset:1024 sc1
v_mfma_f32_16x16x32_bf16 v[140:143], v[36:39], a[188:191], v[140:143]
s_waitcnt lgkmcnt(4)
buffer_store_dwordx4 v[120:123], v12, s[28:31], s76 offen offset:2048 sc1
buffer_store_dwordx4 v[124:127], v12, s[28:31], s76 offen offset:3072 sc1
v_mfma_f32_16x16x32_bf16 v[128:131], v[16:19], a[192:195], v[128:131]
ds_read_b64_tr_b16 v[32:33], v10 offset:28672
v_mul_u32_u24 v155, 864, v155
v_mfma_f32_16x16x32_bf16 v[132:135], v[16:19], a[196:199], v[132:135]
ds_read_b64_tr_b16 v[34:35], v10 offset:29184
v_lshl_add_u32 v145, v154, 4, v155
v_mfma_f32_16x16x32_bf16 v[136:139], v[16:19], a[200:203], v[136:139]
v_add_u32 v145, 3072, v145
v_add_u32 v154, 128, v14
v_mfma_f32_16x16x32_bf16 v[140:143], v[16:19], a[204:207], v[140:143]
v_mul_u32_u24 v155, 3641, v154
v_lshrrev_b32 v155, 16, v155
v_mfma_f32_16x16x32_bf16 v[128:131], v[20:23], a[208:211], v[128:131]
ds_read_b64_tr_b16 v[36:37], v10 offset:32768
v_mul_u32_u24 v155, 864, v155
v_mfma_f32_16x16x32_bf16 v[132:135], v[20:23], a[212:215], v[132:135]
ds_read_b64_tr_b16 v[38:39], v10 offset:33280
v_lshl_add_u32 v146, v154, 4, v155
v_mfma_f32_16x16x32_bf16 v[136:139], v[20:23], a[216:219], v[136:139]
v_add_u32 v146, 2048, v146
v_add_u32 v154, 192, v14
v_mfma_f32_16x16x32_bf16 v[140:143], v[20:23], a[220:223], v[140:143]
s_waitcnt lgkmcnt(4)
v_mul_u32_u24 v155, 3641, v154
v_lshrrev_b32 v155, 16, v155
v_mfma_f32_16x16x32_bf16 v[128:131], v[24:27], a[224:227], v[128:131]
v_mul_u32_u24 v155, 864, v155
v_lshl_add_u32 v147, v154, 4, v155
v_mfma_f32_16x16x32_bf16 v[132:135], v[24:27], a[228:231], v[132:135]
v_add_u32 v147, 1024, v147
v_add_u32 v154, 256, v14
v_mfma_f32_16x16x32_bf16 v[136:139], v[24:27], a[232:235], v[136:139]
v_mul_u32_u24 v155, 3641, v154
v_lshrrev_b32 v155, 16, v155
v_mfma_f32_16x16x32_bf16 v[140:143], v[24:27], a[236:239], v[140:143]
v_mul_u32_u24 v155, 864, v155
v_lshl_add_u32 v148, v154, 4, v155
v_mfma_f32_16x16x32_bf16 v[128:131], v[28:31], a[240:243], v[128:131]
v_add_u32 v148, 4096, v148
v_add_u32 v154, 320, v14
v_mfma_f32_16x16x32_bf16 v[132:135], v[28:31], a[244:247], v[132:135]
v_mul_u32_u24 v155, 3641, v154
v_lshrrev_b32 v155, 16, v155
v_mfma_f32_16x16x32_bf16 v[136:139], v[28:31], a[248:251], v[136:139]
v_mul_u32_u24 v155, 864, v155
v_lshl_add_u32 v149, v154, 4, v155
v_mfma_f32_16x16x32_bf16 v[140:143], v[28:31], a[252:255], v[140:143]
s_waitcnt lgkmcnt(0)
v_add_u32 v149, 3072, v149
v_add_u32 v154, 384, v14
v_mfma_f32_16x16x32_bf16 v[128:131], v[32:35], v[224:227], v[128:131]
v_mul_u32_u24 v155, 3641, v154
v_lshrrev_b32 v155, 16, v155
v_mfma_f32_16x16x32_bf16 v[132:135], v[32:35], v[228:231], v[132:135]
v_mul_u32_u24 v155, 864, v155
v_lshl_add_u32 v150, v154, 4, v155
v_mfma_f32_16x16x32_bf16 v[136:139], v[32:35], v[232:235], v[136:139]
v_add_u32 v150, 2048, v150
v_add_u32 v154, 448, v14
v_mfma_f32_16x16x32_bf16 v[140:143], v[32:35], v[236:239], v[140:143]
v_mul_u32_u24 v155, 3641, v154
v_lshrrev_b32 v155, 16, v155
v_mfma_f32_16x16x32_bf16 v[128:131], v[36:39], v[240:243], v[128:131]
v_mul_u32_u24 v155, 864, v155
v_lshl_add_u32 v151, v154, 4, v155
v_mfma_f32_16x16x32_bf16 v[132:135], v[36:39], v[244:247], v[132:135]
v_add_u32 v151, 1024, v151
v_add_u32 v154, 512, v14
v_mfma_f32_16x16x32_bf16 v[136:139], v[36:39], v[248:251], v[136:139]
v_mul_u32_u24 v155, 3641, v154
v_lshrrev_b32 v155, 16, v155
v_mfma_f32_16x16x32_bf16 v[140:143], v[36:39], v[252:255], v[140:143]
v_mul_u32_u24 v155, 864, v155
v_lshl_add_u32 v152, v154, 4, v155
v_add_u32 v152, 4096, v152
v_and_b32 v159, 7, v14
v_lshlrev_b32 v159, 2, v159
v_bfe_u32 v154, v14, 2, 4
v_mul_u32_u24 v154, 288, v154
v_and_b32 v155, 3, v14
v_lshl_add_u32 v153, v155, 3, v154
s_waitcnt vmcnt(19)
ds_read_b64_tr_b16 v[176:177], v1 offset:0
ds_read_b64_tr_b16 v[178:179], v2 offset:0
ds_read_b64_tr_b16 v[180:181], v3 offset:0
ds_read_b64_tr_b16 v[182:183], v4 offset:0
ds_read_b64_tr_b16 v[184:185], v1 offset:8
ds_read_b64_tr_b16 v[186:187], v2 offset:8
ds_read_b64_tr_b16 v[188:189], v3 offset:8
ds_read_b64_tr_b16 v[190:191], v4 offset:8
ds_read_b64_tr_b16 v[192:193], v1 offset:16
ds_read_b64_tr_b16 v[194:195], v2 offset:16
ds_read_b64_tr_b16 v[196:197], v3 offset:16
ds_read_b64_tr_b16 v[198:199], v4 offset:16
ds_read_b64_tr_b16 v[200:201], v1 offset:24
ds_read_b64_tr_b16 v[202:203], v2 offset:24
ds_read_b64_tr_b16 v[204:205], v3 offset:24
ds_read_b64_tr_b16 v[206:207], v4 offset:24
ds_read_b64_tr_b16 v[208:209], v1 offset:32
ds_read_b64_tr_b16 v[210:211], v2 offset:32
ds_read_b64_tr_b16 v[212:213], v3 offset:32
ds_read_b64_tr_b16 v[214:215], v4 offset:32
v_cvt_pk_bf16_f32 v16, v96, v97
v_cvt_pk_bf16_f32 v17, v98, v99
v_cvt_pk_bf16_f32 v18, v128, v129
v_cvt_pk_bf16_f32 v19, v130, v131
v_cvt_pk_bf16_f32 v20, v48, v49
v_cvt_pk_bf16_f32 v21, v50, v51
v_cvt_pk_bf16_f32 v22, v100, v101
v_cvt_pk_bf16_f32 v23, v102, v103
v_cvt_pk_bf16_f32 v24, v132, v133
v_cvt_pk_bf16_f32 v25, v134, v135
v_cvt_pk_bf16_f32 v26, v52, v53
v_cvt_pk_bf16_f32 v27, v54, v55
v_cvt_pk_bf16_f32 v28, v104, v105
v_cvt_pk_bf16_f32 v29, v106, v107
v_cvt_pk_bf16_f32 v30, v136, v137
v_cvt_pk_bf16_f32 v31, v138, v139
v_cvt_pk_bf16_f32 v32, v56, v57
v_cvt_pk_bf16_f32 v33, v58, v59
v_cvt_pk_bf16_f32 v34, v108, v109
v_cvt_pk_bf16_f32 v35, v110, v111
v_cvt_pk_bf16_f32 v36, v140, v141
v_cvt_pk_bf16_f32 v37, v142, v143
v_cvt_pk_bf16_f32 v38, v60, v61
v_cvt_pk_bf16_f32 v39, v62, v63
s_waitcnt lgkmcnt(15)
v_mfma_f32_16x16x32_bf16 v[160:163], v[176:179], v[16:19], 0
v_mul_f32 v40, s59, v128
v_mul_f32 v41, s59, v132
s_waitcnt lgkmcnt(14)
v_mfma_f32_16x16x32_bf16 v[164:167], v[184:187], v[16:19], 0
v_exp_f32 v40, v40
s_waitcnt lgkmcnt(10)
v_mfma_f32_16x16x32_bf16 v[168:171], v[192:195], v[16:19], 0
v_exp_f32 v41, v41
s_waitcnt lgkmcnt(6)
v_mfma_f32_16x16x32_bf16 v[172:175], v[200:203], v[16:19], 0
v_mul_f32 v42, s59, v136
v_mul_f32 v43, s59, v140
s_waitcnt lgkmcnt(2)
v_mfma_f32_16x16x32_bf16 v[220:223], v[208:211], v[16:19], 0
v_cvt_pk_bf16_f32 v80, v80, v81
v_cvt_pk_bf16_f32 v81, v82, v83
v_mfma_f32_16x16x32_bf16 v[160:163], v[180:183], v[18:21], v[160:163]
v_exp_f32 v42, v42
v_mfma_f32_16x16x32_bf16 v[164:167], v[188:191], v[18:21], v[164:167]
v_mov_b32 v82, v18
v_mov_b32 v83, 0x3f80
v_mfma_f32_16x16x32_bf16 v[168:171], v[196:199], v[18:21], v[168:171]
v_cvt_pk_bf16_f32 v84, v84, v85
v_cvt_pk_bf16_f32 v85, v86, v87
v_mfma_f32_16x16x32_bf16 v[172:175], v[204:207], v[18:21], v[172:175]
v_exp_f32 v43, v43
s_waitcnt lgkmcnt(0)
v_mfma_f32_16x16x32_bf16 v[220:223], v[212:215], v[18:21], v[220:223]
v_mov_b32 v86, v24
v_mov_b32 v87, 0x3f80
v_cvt_pk_bf16_f32 v88, v88, v89
v_cvt_pk_bf16_f32 v89, v90, v91
v_mov_b32 v90, v30
v_mov_b32 v91, 0x3f80
v_cvt_pk_bf16_f32 v92, v92, v93
v_cvt_pk_bf16_f32 v93, v94, v95
v_mov_b32 v94, v36
v_mov_b32 v95, 0x3f80
v_add_f32 v40, 1.0, v40
v_add_f32 v41, 1.0, v41
v_add_f32 v42, 1.0, v42
v_add_f32 v43, 1.0, v43
v_rcp_f32 v40, v40
v_rcp_f32 v41, v41
v_rcp_f32 v42, v42
v_rcp_f32 v43, v43
v_and_b32 v46, 15, v14
v_lshrrev_b32 v47, 4, v14
v_lshl_add_u32 v46, s48, 6, v46
v_mul_u32_u24 v8, 5, v46
v_lshlrev_b32 v9, 2, v46
v_mul_u32_u24 v10, 5, v47
v_lshl_add_u32 v10, v8, 1, v10
v_add_u32 v8, v8, v47
v_add_u32 v9, 157440, v9
v_lshlrev_b32 v8, 3, v8
v_lshlrev_b32 v10, 3, v10
v_add_u32 v8, 94224, v8
v_add_u32 v10, 73648, v10
s_barrier
ds_write_b64 v8, v[80:81] offset:0
ds_write_b64 v8, v[84:85] offset:640
ds_write_b64 v8, v[88:89] offset:1280
ds_write_b64 v8, v[92:93] offset:1920
s_mov_b32 exec_lo, 0
s_mov_b32 exec_hi, 0xffff
ds_write_b64 v8, v[82:83] offset:16
ds_write_b64 v8, v[86:87] offset:656
ds_write_b64 v8, v[90:91] offset:1296
ds_write_b64 v8, v[94:95] offset:1936
s_mov_b32 exec_hi, 0xffff0000
ds_write_b32 v9, v40 offset:0
ds_write_b32 v9, v41 offset:64
ds_write_b32 v9, v42 offset:128
ds_write_b32 v9, v43 offset:192
s_mov_b64 exec, -1
s_mov_b32 s64, s58
s_mov_b32 s65, s58
v_max3_f32 v46, v160, v161, v162
v_max3_f32 v47, v163, v164, v165
v_max3_f32 v46, v46, v166, v167
v_max3_f32 v47, v47, v168, v169
v_max3_f32 v46, v46, v170, v171
v_max3_f32 v47, v47, v172, v173
v_max3_f32 v46, v46, v174, v175
v_max3_f32 v47, v47, v220, v221
v_max_f32 v46, v46, v47
v_mul_f32 v46, s59, v46
s_mov_b32 s78, s4
s_add_u32 m0, s62, 0
s_nop 0
buffer_load_dwordx4 v144, s[20:23], s78 offen offset:0 lds
buffer_load_dwordx4 v145, s[20:23], s78 offen offset:1024 lds
v_pk_fma_f32 v[160:161], v[160:161], s[64:65], v[46:47] op_sel_hi:[1,1,0]
v_pk_fma_f32 v[162:163], v[162:163], s[64:65], v[46:47] op_sel_hi:[1,1,0]
v_pk_fma_f32 v[164:165], v[164:165], s[64:65], v[46:47] op_sel_hi:[1,1,0]
v_pk_fma_f32 v[166:167], v[166:167], s[64:65], v[46:47] op_sel_hi:[1,1,0]
v_pk_fma_f32 v[168:169], v[168:169], s[64:65], v[46:47] op_sel_hi:[1,1,0]
v_pk_fma_f32 v[170:171], v[170:171], s[64:65], v[46:47] op_sel_hi:[1,1,0]
v_pk_fma_f32 v[172:173], v[172:173], s[64:65], v[46:47] op_sel_hi:[1,1,0]
v_pk_fma_f32 v[174:175], v[174:175], s[64:65], v[46:47] op_sel_hi:[1,1,0]
v_pk_fma_f32 v[220:221], v[220:221], s[64:65], v[46:47] op_sel_hi:[1,1,0]
v_mfma_f32_16x16x32_bf16 v[112:115], v[176:179], v[22:25], 0
v_exp_f32 v160, v160
v_mfma_f32_16x16x32_bf16 v[116:119], v[184:187], v[22:25], 0
v_exp_f32 v161, v161
v_mfma_f32_16x16x32_bf16 v[120:123], v[192:195], v[22:25], 0
v_exp_f32 v162, v162
v_mfma_f32_16x16x32_bf16 v[124:127], v[200:203], v[22:25], 0
v_exp_f32 v163, v163
v_mfma_f32_16x16x32_bf16 v[216:219], v[208:211], v[22:25], 0
v_exp_f32 v164, v164
v_mfma_f32_16x16x32_bf16 v[112:115], v[180:183], v[24:27], v[112:115]
v_exp_f32 v165, v165
v_mfma_f32_16x16x32_bf16 v[116:119], v[188:191], v[24:27], v[116:119]
v_exp_f32 v166, v166
v_mfma_f32_16x16x32_bf16 v[120:123], v[196:199], v[24:27], v[120:123]
v_exp_f32 v167, v167
v_mfma_f32_16x16x32_bf16 v[124:127], v[204:207], v[24:27], v[124:127]
v_exp_f32 v168, v168
v_mfma_f32_16x16x32_bf16 v[216:219], v[212:215], v[24:27], v[216:219]
v_exp_f32 v169, v169
v_exp_f32 v170, v170
v_exp_f32 v171, v171
v_exp_f32 v172, v172
v_exp_f32 v173, v173
v_exp_f32 v174, v174
v_exp_f32 v175, v175
v_exp_f32 v220, v220
v_exp_f32 v221, v221
v_mov_b32 v57, 0
v_pk_add_f32 v[46:47], v[160:161], v[162:163]
v_pk_add_f32 v[46:47], v[46:47], v[164:165]
v_pk_add_f32 v[46:47], v[46:47], v[166:167]
v_pk_add_f32 v[46:47], v[46:47], v[168:169]
v_pk_add_f32 v[46:47], v[46:47], v[170:171]
v_pk_add_f32 v[46:47], v[46:47], v[172:173]
v_pk_add_f32 v[46:47], v[46:47], v[174:175]
v_pk_add_f32 v[46:47], v[46:47], v[220:221]
v_add_f32 v46, v46, v47
v_rcp_f32 v46, v46
buffer_load_dwordx4 v146, s[20:23], s78 offen offset:2048 lds
buffer_load_dwordx4 v147, s[20:23], s78 offen offset:3072 lds
v_pk_mul_f32 v[160:161], v[160:161], v[46:47] op_sel_hi:[1,0]
v_pk_mul_f32 v[162:163], v[162:163], v[46:47] op_sel_hi:[1,0]
v_pk_mul_f32 v[164:165], v[164:165], v[46:47] op_sel_hi:[1,0]
v_pk_mul_f32 v[166:167], v[166:167], v[46:47] op_sel_hi:[1,0]
v_pk_mul_f32 v[168:169], v[168:169], v[46:47] op_sel_hi:[1,0]
v_pk_mul_f32 v[170:171], v[170:171], v[46:47] op_sel_hi:[1,0]
v_pk_mul_f32 v[172:173], v[172:173], v[46:47] op_sel_hi:[1,0]
v_pk_mul_f32 v[174:175], v[174:175], v[46:47] op_sel_hi:[1,0]
v_pk_mul_f32 v[220:221], v[220:221], v[46:47] op_sel_hi:[1,0]
v_cvt_pk_bf16_f32 v48, v160, v161
v_cvt_pk_bf16_f32 v49, v162, v163
v_cvt_pk_bf16_f32 v50, v164, v165
v_cvt_pk_bf16_f32 v51, v166, v167
v_cvt_pk_bf16_f32 v52, v168, v169
v_cvt_pk_bf16_f32 v53, v170, v171
v_cvt_pk_bf16_f32 v54, v172, v173
v_cvt_pk_bf16_f32 v55, v174, v175
v_cvt_pk_bf16_f32 v56, v220, v221
s_mov_b32 exec_lo, 0
ds_write_b64 v10, v[48:49] offset:0
ds_write_b64 v10, v[50:51] offset:8
ds_write_b64 v10, v[52:53] offset:16
ds_write_b64 v10, v[54:55] offset:24
ds_write_b64 v10, v[56:57] offset:32
s_mov_b32 exec_lo, -1
v_max3_f32 v46, v112, v113, v114
v_max3_f32 v47, v115, v116, v117
v_max3_f32 v46, v46, v118, v119
v_max3_f32 v47, v47, v120, v121
v_max3_f32 v46, v46, v122, v123
v_max3_f32 v47, v47, v124, v125
v_max3_f32 v46, v46, v126, v127
v_max3_f32 v47, v47, v216, v217
v_max_f32 v46, v46, v47
v_mul_f32 v46, s59, v46
s_add_u32 m0, s62, 4096
s_nop 0
buffer_load_dwordx4 v148, s[20:23], s78 offen offset:0 lds
buffer_load_dwordx4 v149, s[20:23], s78 offen offset:1024 lds
v_pk_fma_f32 v[112:113], v[112:113], s[64:65], v[46:47] op_sel_hi:[1,1,0]
v_pk_fma_f32 v[114:115], v[114:115], s[64:65], v[46:47] op_sel_hi:[1,1,0]
v_pk_fma_f32 v[116:117], v[116:117], s[64:65], v[46:47] op_sel_hi:[1,1,0]
v_pk_fma_f32 v[118:119], v[118:119], s[64:65], v[46:47] op_sel_hi:[1,1,0]
v_pk_fma_f32 v[120:121], v[120:121], s[64:65], v[46:47] op_sel_hi:[1,1,0]
v_pk_fma_f32 v[122:123], v[122:123], s[64:65], v[46:47] op_sel_hi:[1,1,0]
v_pk_fma_f32 v[124:125], v[124:125], s[64:65], v[46:47] op_sel_hi:[1,1,0]
v_pk_fma_f32 v[126:127], v[126:127], s[64:65], v[46:47] op_sel_hi:[1,1,0]
v_pk_fma_f32 v[216:217], v[216:217], s[64:65], v[46:47] op_sel_hi:[1,1,0]
v_mfma_f32_16x16x32_bf16 v[160:163], v[176:179], v[28:31], 0
v_exp_f32 v112, v112
v_mfma_f32_16x16x32_bf16 v[164:167], v[184:187], v[28:31], 0
v_exp_f32 v113, v113
v_mfma_f32_16x16x32_bf16 v[168:171], v[192:195], v[28:31], 0
v_exp_f32 v114, v114
v_mfma_f32_16x16x32_bf16 v[172:175], v[200:203], v[28:31], 0
v_exp_f32 v115, v115
v_mfma_f32_16x16x32_bf16 v[220:223], v[208:211], v[28:31], 0
v_exp_f32 v116, v116
v_mfma_f32_16x16x32_bf16 v[160:163], v[180:183], v[30:33], v[160:163]
v_exp_f32 v117, v117
v_mfma_f32_16x16x32_bf16 v[164:167], v[188:191], v[30:33], v[164:167]
v_exp_f32 v118, v118
v_mfma_f32_16x16x32_bf16 v[168:171], v[196:199], v[30:33], v[168:171]
v_exp_f32 v119, v119
v_mfma_f32_16x16x32_bf16 v[172:175], v[204:207], v[30:33], v[172:175]
v_exp_f32 v120, v120
v_mfma_f32_16x16x32_bf16 v[220:223], v[212:215], v[30:33], v[220:223]
v_exp_f32 v121, v121
v_exp_f32 v122, v122
v_exp_f32 v123, v123
v_exp_f32 v124, v124
v_exp_f32 v125, v125
v_exp_f32 v126, v126
v_exp_f32 v127, v127
v_exp_f32 v216, v216
v_exp_f32 v217, v217
v_mov_b32 v67, 0
v_pk_add_f32 v[46:47], v[112:113], v[114:115]
v_pk_add_f32 v[46:47], v[46:47], v[116:117]
v_pk_add_f32 v[46:47], v[46:47], v[118:119]
v_pk_add_f32 v[46:47], v[46:47], v[120:121]
v_pk_add_f32 v[46:47], v[46:47], v[122:123]
v_pk_add_f32 v[46:47], v[46:47], v[124:125]
v_pk_add_f32 v[46:47], v[46:47], v[126:127]
v_pk_add_f32 v[46:47], v[46:47], v[216:217]
v_add_f32 v46, v46, v47
v_rcp_f32 v46, v46
buffer_load_dwordx4 v150, s[20:23], s78 offen offset:2048 lds
buffer_load_dwordx4 v151, s[20:23], s78 offen offset:3072 lds
v_pk_mul_f32 v[112:113], v[112:113], v[46:47] op_sel_hi:[1,0]
v_pk_mul_f32 v[114:115], v[114:115], v[46:47] op_sel_hi:[1,0]
v_pk_mul_f32 v[116:117], v[116:117], v[46:47] op_sel_hi:[1,0]
v_pk_mul_f32 v[118:119], v[118:119], v[46:47] op_sel_hi:[1,0]
v_pk_mul_f32 v[120:121], v[120:121], v[46:47] op_sel_hi:[1,0]
v_pk_mul_f32 v[122:123], v[122:123], v[46:47] op_sel_hi:[1,0]
v_pk_mul_f32 v[124:125], v[124:125], v[46:47] op_sel_hi:[1,0]
v_pk_mul_f32 v[126:127], v[126:127], v[46:47] op_sel_hi:[1,0]
v_pk_mul_f32 v[216:217], v[216:217], v[46:47] op_sel_hi:[1,0]
v_cvt_pk_bf16_f32 v58, v112, v113
v_cvt_pk_bf16_f32 v59, v114, v115
v_cvt_pk_bf16_f32 v60, v116, v117
v_cvt_pk_bf16_f32 v61, v118, v119
v_cvt_pk_bf16_f32 v62, v120, v121
v_cvt_pk_bf16_f32 v63, v122, v123
v_cvt_pk_bf16_f32 v64, v124, v125
v_cvt_pk_bf16_f32 v65, v126, v127
v_cvt_pk_bf16_f32 v66, v216, v217
s_mov_b32 exec_lo, 0
ds_write_b64 v10, v[58:59] offset:1280
ds_write_b64 v10, v[60:61] offset:1288
ds_write_b64 v10, v[62:63] offset:1296
ds_write_b64 v10, v[64:65] offset:1304
ds_write_b64 v10, v[66:67] offset:1312
s_mov_b32 exec_lo, -1
v_max3_f32 v46, v160, v161, v162
v_max3_f32 v47, v163, v164, v165
v_max3_f32 v46, v46, v166, v167
v_max3_f32 v47, v47, v168, v169
v_max3_f32 v46, v46, v170, v171
v_max3_f32 v47, v47, v172, v173
v_max3_f32 v46, v46, v174, v175
v_max3_f32 v47, v47, v220, v221
v_max_f32 v46, v46, v47
v_mul_f32 v46, s59, v46
s_add_u32 m0, s62, 8192
s_nop 0
buffer_load_dwordx4 v152, s[20:23], s78 offen offset:0 lds
v_pk_fma_f32 v[160:161], v[160:161], s[64:65], v[46:47] op_sel_hi:[1,1,0]
v_pk_fma_f32 v[162:163], v[162:163], s[64:65], v[46:47] op_sel_hi:[1,1,0]
v_pk_fma_f32 v[164:165], v[164:165], s[64:65], v[46:47] op_sel_hi:[1,1,0]
v_pk_fma_f32 v[166:167], v[166:167], s[64:65], v[46:47] op_sel_hi:[1,1,0]
v_pk_fma_f32 v[168:169], v[168:169], s[64:65], v[46:47] op_sel_hi:[1,1,0]
v_pk_fma_f32 v[170:171], v[170:171], s[64:65], v[46:47] op_sel_hi:[1,1,0]
v_pk_fma_f32 v[172:173], v[172:173], s[64:65], v[46:47] op_sel_hi:[1,1,0]
v_pk_fma_f32 v[174:175], v[174:175], s[64:65], v[46:47] op_sel_hi:[1,1,0]
v_pk_fma_f32 v[220:221], v[220:221], s[64:65], v[46:47] op_sel_hi:[1,1,0]
v_mfma_f32_16x16x32_bf16 v[112:115], v[176:179], v[34:37], 0
v_exp_f32 v160, v160
v_mfma_f32_16x16x32_bf16 v[116:119], v[184:187], v[34:37], 0
v_exp_f32 v161, v161
v_mfma_f32_16x16x32_bf16 v[120:123], v[192:195], v[34:37], 0
v_exp_f32 v162, v162
v_mfma_f32_16x16x32_bf16 v[124:127], v[200:203], v[34:37], 0
v_exp_f32 v163, v163
v_mfma_f32_16x16x32_bf16 v[216:219], v[208:211], v[34:37], 0
v_exp_f32 v164, v164
v_mfma_f32_16x16x32_bf16 v[112:115], v[180:183], v[36:39], v[112:115]
v_exp_f32 v165, v165
v_mfma_f32_16x16x32_bf16 v[116:119], v[188:191], v[36:39], v[116:119]
v_exp_f32 v166, v166
v_mfma_f32_16x16x32_bf16 v[120:123], v[196:199], v[36:39], v[120:123]
v_exp_f32 v167, v167
v_mfma_f32_16x16x32_bf16 v[124:127], v[204:207], v[36:39], v[124:127]
v_exp_f32 v168, v168
v_mfma_f32_16x16x32_bf16 v[216:219], v[212:215], v[36:39], v[216:219]
v_exp_f32 v169, v169
v_exp_f32 v170, v170
v_exp_f32 v171, v171
v_exp_f32 v172, v172
v_exp_f32 v173, v173
v_exp_f32 v174, v174
v_exp_f32 v175, v175
v_exp_f32 v220, v220
v_exp_f32 v221, v221
v_mov_b32 v77, 0
v_mov_b32 v78, 0
v_mov_b32 v79, 0
v_pk_add_f32 v[46:47], v[160:161], v[162:163]
v_pk_add_f32 v[46:47], v[46:47], v[164:165]
v_pk_add_f32 v[46:47], v[46:47], v[166:167]
v_pk_add_f32 v[46:47], v[46:47], v[168:169]
v_pk_add_f32 v[46:47], v[46:47], v[170:171]
v_pk_add_f32 v[46:47], v[46:47], v[172:173]
v_pk_add_f32 v[46:47], v[46:47], v[174:175]
v_pk_add_f32 v[46:47], v[46:47], v[220:221]
v_add_f32 v46, v46, v47
v_rcp_f32 v46, v46
s_nop 0
v_pk_mul_f32 v[160:161], v[160:161], v[46:47] op_sel_hi:[1,0]
v_pk_mul_f32 v[162:163], v[162:163], v[46:47] op_sel_hi:[1,0]
v_pk_mul_f32 v[164:165], v[164:165], v[46:47] op_sel_hi:[1,0]
v_pk_mul_f32 v[166:167], v[166:167], v[46:47] op_sel_hi:[1,0]
v_pk_mul_f32 v[168:169], v[168:169], v[46:47] op_sel_hi:[1,0]
v_pk_mul_f32 v[170:171], v[170:171], v[46:47] op_sel_hi:[1,0]
v_pk_mul_f32 v[172:173], v[172:173], v[46:47] op_sel_hi:[1,0]
v_pk_mul_f32 v[174:175], v[174:175], v[46:47] op_sel_hi:[1,0]
v_pk_mul_f32 v[220:221], v[220:221], v[46:47] op_sel_hi:[1,0]
v_cvt_pk_bf16_f32 v68, v160, v161
v_cvt_pk_bf16_f32 v69, v162, v163
v_cvt_pk_bf16_f32 v70, v164, v165
v_cvt_pk_bf16_f32 v71, v166, v167
v_cvt_pk_bf16_f32 v72, v168, v169
v_cvt_pk_bf16_f32 v73, v170, v171
v_cvt_pk_bf16_f32 v74, v172, v173
v_cvt_pk_bf16_f32 v75, v174, v175
v_cvt_pk_bf16_f32 v76, v220, v221
s_mov_b32 exec_lo, 0
ds_write_b64 v10, v[68:69] offset:2560
ds_write_b64 v10, v[70:71] offset:2568
ds_write_b64 v10, v[72:73] offset:2576
ds_write_b64 v10, v[74:75] offset:2584
ds_write_b64 v10, v[76:77] offset:2592
s_mov_b32 exec_lo, -1
v_max3_f32 v46, v112, v113, v114
v_max3_f32 v47, v115, v116, v117
v_max3_f32 v46, v46, v118, v119
v_max3_f32 v47, v47, v120, v121
v_max3_f32 v46, v46, v122, v123
v_max3_f32 v47, v47, v124, v125
v_max3_f32 v46, v46, v126, v127
v_max3_f32 v47, v47, v216, v217
v_max_f32 v46, v46, v47
v_mul_f32 v46, s59, v46
v_pk_fma_f32 v[112:113], v[112:113], s[64:65], v[46:47] op_sel_hi:[1,1,0]
v_pk_fma_f32 v[114:115], v[114:115], s[64:65], v[46:47] op_sel_hi:[1,1,0]
v_pk_fma_f32 v[116:117], v[116:117], s[64:65], v[46:47] op_sel_hi:[1,1,0]
v_pk_fma_f32 v[118:119], v[118:119], s[64:65], v[46:47] op_sel_hi:[1,1,0]
v_pk_fma_f32 v[120:121], v[120:121], s[64:65], v[46:47] op_sel_hi:[1,1,0]
v_pk_fma_f32 v[122:123], v[122:123], s[64:65], v[46:47] op_sel_hi:[1,1,0]
v_pk_fma_f32 v[124:125], v[124:125], s[64:65], v[46:47] op_sel_hi:[1,1,0]
v_pk_fma_f32 v[126:127], v[126:127], s[64:65], v[46:47] op_sel_hi:[1,1,0]
v_pk_fma_f32 v[216:217], v[216:217], s[64:65], v[46:47] op_sel_hi:[1,1,0]
v_exp_f32 v112, v112
v_exp_f32 v113, v113
v_exp_f32 v114, v114
v_exp_f32 v115, v115
v_exp_f32 v116, v116
v_exp_f32 v117, v117
v_exp_f32 v118, v118
v_exp_f32 v119, v119
v_exp_f32 v120, v120
v_exp_f32 v121, v121
v_exp_f32 v122, v122
v_exp_f32 v123, v123
v_exp_f32 v124, v124
v_exp_f32 v125, v125
v_exp_f32 v126, v126
v_exp_f32 v127, v127
v_exp_f32 v216, v216
v_exp_f32 v217, v217
v_mov_b32 v137, 0
v_mov_b32 v138, 0
v_mov_b32 v139, 0
v_pk_add_f32 v[46:47], v[112:113], v[114:115]
v_pk_add_f32 v[46:47], v[46:47], v[116:117]
v_pk_add_f32 v[46:47], v[46:47], v[118:119]
v_pk_add_f32 v[46:47], v[46:47], v[120:121]
v_pk_add_f32 v[46:47], v[46:47], v[122:123]
v_pk_add_f32 v[46:47], v[46:47], v[124:125]
v_pk_add_f32 v[46:47], v[46:47], v[126:127]
v_pk_add_f32 v[46:47], v[46:47], v[216:217]
v_add_f32 v46, v46, v47
v_rcp_f32 v46, v46
s_nop 0
v_pk_mul_f32 v[112:113], v[112:113], v[46:47] op_sel_hi:[1,0]
v_pk_mul_f32 v[114:115], v[114:115], v[46:47] op_sel_hi:[1,0]
v_pk_mul_f32 v[116:117], v[116:117], v[46:47] op_sel_hi:[1,0]
v_pk_mul_f32 v[118:119], v[118:119], v[46:47] op_sel_hi:[1,0]
v_pk_mul_f32 v[120:121], v[120:121], v[46:47] op_sel_hi:[1,0]
v_pk_mul_f32 v[122:123], v[122:123], v[46:47] op_sel_hi:[1,0]
v_pk_mul_f32 v[124:125], v[124:125], v[46:47] op_sel_hi:[1,0]
v_pk_mul_f32 v[126:127], v[126:127], v[46:47] op_sel_hi:[1,0]
v_pk_mul_f32 v[216:217], v[216:217], v[46:47] op_sel_hi:[1,0]
v_cvt_pk_bf16_f32 v128, v112, v113
v_cvt_pk_bf16_f32 v129, v114, v115
v_cvt_pk_bf16_f32 v130, v116, v117
v_cvt_pk_bf16_f32 v131, v118, v119
v_cvt_pk_bf16_f32 v132, v120, v121
v_cvt_pk_bf16_f32 v133, v122, v123
v_cvt_pk_bf16_f32 v134, v124, v125
v_cvt_pk_bf16_f32 v135, v126, v127
v_cvt_pk_bf16_f32 v136, v216, v217
s_mov_b32 exec_lo, 0
ds_write_b64 v10, v[128:129] offset:3840
ds_write_b64 v10, v[130:131] offset:3848
ds_write_b64 v10, v[132:133] offset:3856
ds_write_b64 v10, v[134:135] offset:3864
ds_write_b64 v10, v[136:137] offset:3872
s_mov_b32 exec_lo, -1
v_lshrrev_b32 v4, 4, v14
v_bfe_u32 v46, v14, 2, 2
v_lshl_add_u32 v46, v4, 3, v46
v_mul_u32_u24 v46, 40, v46
v_and_b32 v47, 3, v14
v_lshlrev_b32 v47, 3, v47
v_lshl_add_u32 v1, v46, 1, v47
v_add_u32 v2, v46, v47
v_lshl_add_u32 v1, s48, 5, v1
v_add_u32 v2, 94224, v2
v_add_u32 v1, 73728, v1
s_lshl3_add_u32 s87, s52, s50
s_lshl2_add_u32 s87, s87, s48
s_lshl_b32 s87, s87, 11
s_add_u32 s65, s48, 1
s_lshl_b32 s65, s65, 29
s_and_b32 s65, s65, 0x80000000
v_or_b32 v3, s65, v12
s_add_u32 s87, s87, 41943040
s_waitcnt vmcnt(9) lgkmcnt(0)
s_barrier
s_lshl_b32 s86, s50, 2
s_add_u32 s86, s86, s49
s_lshl_b32 s86, s86, 7
s_lshl_b32 s78, s51, 2
s_add_u32 s86, s86, s78
v_mov_b32 v15, s57
s_add_u32 s77, s86, 34635776
buffer_store_dword v15, v0, s[28:31], s77 offen sc1
v_lshrrev_b32 v46, 5, v14
v_lshlrev_b32 v46, 9, v46
v_and_b32 v47, 31, v14
v_lshl_add_u32 v46, v47, 3, v46
v_add_u32 v7, 110592, v46
ds_read_b64_tr_b16 v[16:17], v7 offset:0
ds_read_b64_tr_b16 v[18:19], v7 offset:256
ds_read_b64_tr_b16 v[20:21], v7 offset:1024
ds_read_b64_tr_b16 v[22:23], v7 offset:1280
ds_read_b64_tr_b16 v[112:113], v1 offset:0
ds_read_b64_tr_b16 v[114:115], v1 offset:320
ds_read_b64_tr_b16 v[116:117], v2 offset:0
ds_read_b64_tr_b16 v[118:119], v2 offset:160
ds_read_b64_tr_b16 v[120:121], v2 offset:32
ds_read_b64_tr_b16 v[122:123], v2 offset:192
ds_read_b64_tr_b16 v[28:29], v7 offset:2048
ds_read_b64_tr_b16 v[30:31], v7 offset:2304
s_waitcnt lgkmcnt(10)
v_mfma_f32_16x16x32_bf16 v[80:83], v[16:19], a[0:3], 0
ds_read_b64_tr_b16 v[32:33], v7 offset:3072
v_mfma_f32_16x16x32_bf16 v[84:87], v[16:19], a[4:7], 0
ds_read_b64_tr_b16 v[34:35], v7 offset:3328
v_mfma_f32_16x16x32_bf16 v[88:91], v[16:19], a[8:11], 0
v_mfma_f32_16x16x32_bf16 v[92:95], v[16:19], a[12:15], 0
s_waitcnt lgkmcnt(10)
v_mfma_f32_16x16x32_bf16 v[80:83], v[20:23], a[16:19], v[80:83]
s_and_b32 s68, s86, 0xffffff80
ds_read_b64_tr_b16 v[208:209], v1 offset:2560
s_and_b32 s76, s55, 1
v_mfma_f32_16x16x32_bf16 v[84:87], v[20:23], a[20:23], v[84:87]
s_lshl_b32 s75, s76, 5
ds_read_b64_tr_b16 v[210:211], v1 offset:2880
s_xor_b32 s76, s76, 1
v_mfma_f32_16x16x32_bf16 v[88:91], v[20:23], a[24:27], v[88:91]
s_lshl_b32 s76, s76, 8
ds_read_b64_tr_b16 v[212:213], v2 offset:1280
v_add_u32 v157, s76, v153
v_mfma_f32_16x16x32_bf16 v[92:95], v[20:23], a[28:31], v[92:95]
s_waitcnt lgkmcnt(5)
ds_read_b64_tr_b16 v[214:215], v2 offset:1440
s_add_u32 s76, s49, 1
v_mfma_f32_16x16x32_bf16 v[160:163], v[112:115], v[116:119], 0
s_and_b32 s76, s76, 3
ds_read_b64_tr_b16 v[216:217], v2 offset:1312
ds_read_b64_tr_b16 v[218:219], v2 offset:1472
v_mfma_f32_16x16x32_bf16 v[164:167], v[112:115], v[120:123], 0
s_lshl_b32 s76, s76, 6
ds_read_b64_tr_b16 v[16:17], v7 offset:4096
ds_read_b64_tr_b16 v[18:19], v7 offset:4352
v_mfma_f32_16x16x32_bf16 v[80:83], v[28:31], a[32:35], v[80:83]
s_add_u32 s76, s76, s75
ds_read_b64_tr_b16 v[20:21], v7 offset:5120
v_add_u32 v154, s76, v153
v_mfma_f32_16x16x32_bf16 v[84:87], v[28:31], a[36:39], v[84:87]
s_add_u32 s76, s49, 2
ds_read_b64_tr_b16 v[22:23], v7 offset:5376
s_and_b32 s76, s76, 3
v_mfma_f32_16x16x32_bf16 v[88:91], v[28:31], a[40:43], v[88:91]
s_lshl_b32 s76, s76, 6
s_add_u32 s76, s76, s75
v_add_u32 v155, s76, v153
v_mfma_f32_16x16x32_bf16 v[92:95], v[28:31], a[44:47], v[92:95]
s_waitcnt lgkmcnt(4)
s_add_u32 s76, s49, 3
s_and_b32 s76, s76, 3
v_mfma_f32_16x16x32_bf16 v[80:83], v[32:35], a[48:51], v[80:83]
s_lshl_b32 s76, s76, 6
ds_read_b64_tr_b16 v[176:177], v1 offset:5120
s_add_u32 s76, s76, s75
v_mfma_f32_16x16x32_bf16 v[84:87], v[32:35], a[52:55], v[84:87]
ds_read_b64_tr_b16 v[178:179], v1 offset:5440
v_add_u32 v156, s76, v153
v_mfma_f32_16x16x32_bf16 v[88:91], v[32:35], a[56:59], v[88:91]
s_add_u32 s76, s49, 0
ds_read_b64_tr_b16 v[180:181], v2 offset:2560
s_and_b32 s76, s76, 3
v_mfma_f32_16x16x32_bf16 v[92:95], v[32:35], a[60:63], v[92:95]
s_lshl_b32 s76, s76, 6
ds_read_b64_tr_b16 v[182:183], v2 offset:2720
s_add_u32 s76, s76, s75
v_mfma_f32_16x16x32_bf16 v[160:163], v[208:211], v[212:215], v[160:163]
ds_read_b64_tr_b16 v[184:185], v2 offset:2592
ds_read_b64_tr_b16 v[186:187], v2 offset:2752
v_mfma_f32_16x16x32_bf16 v[164:167], v[208:211], v[216:219], v[164:167]
s_waitcnt lgkmcnt(6)
ds_read_b64_tr_b16 v[28:29], v7 offset:6144
ds_read_b64_tr_b16 v[30:31], v7 offset:6400
v_mfma_f32_16x16x32_bf16 v[80:83], v[16:19], a[64:67], v[80:83]
ds_read_b64_tr_b16 v[32:33], v7 offset:7168
v_add_u32 v153, s76, v153
v_mfma_f32_16x16x32_bf16 v[84:87], v[16:19], a[68:71], v[84:87]
ds_read_b64_tr_b16 v[34:35], v7 offset:7424
v_mfma_f32_16x16x32_bf16 v[88:91], v[16:19], a[72:75], v[88:91]
v_mfma_f32_16x16x32_bf16 v[92:95], v[16:19], a[76:79], v[92:95]
s_add_u32 s81, s68, 34635776
buffer_load_dword v158, v159, s[28:31], s81 offen sc1
s_mov_b32 s78, s5
v_mfma_f32_16x16x32_bf16 v[80:83], v[20:23], a[80:83], v[80:83]
s_add_u32 m0, s62, 36864
ds_read_b64_tr_b16 v[112:113], v1 offset:7680
buffer_load_dwordx4 v144, s[20:23], s78 offen offset:0 lds
v_mfma_f32_16x16x32_bf16 v[84:87], v[20:23], a[84:87], v[84:87]
ds_read_b64_tr_b16 v[114:115], v1 offset:8000
v_mfma_f32_16x16x32_bf16 v[88:91], v[20:23], a[88:91], v[88:91]
ds_read_b64_tr_b16 v[116:117], v2 offset:3840
v_mfma_f32_16x16x32_bf16 v[92:95], v[20:23], a[92:95], v[92:95]
s_waitcnt lgkmcnt(5)
ds_read_b64_tr_b16 v[118:119], v2 offset:4000
buffer_load_dwordx4 v145, s[20:23], s78 offen offset:1024 lds
v_mfma_f32_16x16x32_bf16 v[160:163], v[176:179], v[180:183], v[160:163]
ds_read_b64_tr_b16 v[120:121], v2 offset:3872
ds_read_b64_tr_b16 v[122:123], v2 offset:4032
v_mfma_f32_16x16x32_bf16 v[164:167], v[176:179], v[184:187], v[164:167]
ds_read_b64_tr_b16 v[16:17], v7 offset:8192
ds_read_b64_tr_b16 v[18:19], v7 offset:8448
v_mfma_f32_16x16x32_bf16 v[80:83], v[28:31], a[96:99], v[80:83]
ds_read_b64_tr_b16 v[20:21], v7 offset:9216
v_mfma_f32_16x16x32_bf16 v[84:87], v[28:31], a[100:103], v[84:87]
ds_read_b64_tr_b16 v[22:23], v7 offset:9472
buffer_load_dwordx4 v146, s[20:23], s78 offen offset:2048 lds
v_mfma_f32_16x16x32_bf16 v[88:91], v[28:31], a[104:107], v[88:91]
v_mfma_f32_16x16x32_bf16 v[92:95], v[28:31], a[108:111], v[92:95]
s_waitcnt lgkmcnt(4)
v_mfma_f32_16x16x32_bf16 v[80:83], v[32:35], a[112:115], v[80:83]
ds_read_b64_tr_b16 v[208:209], v1 offset:10240
v_mfma_f32_16x16x32_bf16 v[84:87], v[32:35], a[116:119], v[84:87]
ds_read_b64_tr_b16 v[210:211], v1 offset:10560
buffer_load_dwordx4 v147, s[20:23], s78 offen offset:3072 lds
v_mfma_f32_16x16x32_bf16 v[88:91], v[32:35], a[120:123], v[88:91]
s_add_u32 m0, s62, 40960
ds_read_b64_tr_b16 v[212:213], v2 offset:5120
v_mfma_f32_16x16x32_bf16 v[92:95], v[32:35], a[124:127], v[92:95]
ds_read_b64_tr_b16 v[214:215], v2 offset:5280
v_mfma_f32_16x16x32_bf16 v[160:163], v[112:115], v[116:119], v[160:163]
ds_read_b64_tr_b16 v[216:217], v2 offset:5152
ds_read_b64_tr_b16 v[218:219], v2 offset:5312
v_mfma_f32_16x16x32_bf16 v[164:167], v[112:115], v[120:123], v[164:167]
s_waitcnt lgkmcnt(6)
ds_read_b64_tr_b16 v[28:29], v7 offset:10240
ds_read_b64_tr_b16 v[30:31], v7 offset:10496
v_mfma_f32_16x16x32_bf16 v[80:83], v[16:19], a[128:131], v[80:83]
ds_read_b64_tr_b16 v[32:33], v7 offset:11264
buffer_load_dwordx4 v148, s[20:23], s78 offen offset:0 lds
v_mfma_f32_16x16x32_bf16 v[84:87], v[16:19], a[132:135], v[84:87]
ds_read_b64_tr_b16 v[34:35], v7 offset:11520
v_mfma_f32_16x16x32_bf16 v[88:91], v[16:19], a[136:139], v[88:91]
v_mfma_f32_16x16x32_bf16 v[92:95], v[16:19], a[140:143], v[92:95]
buffer_load_dwordx4 v149, s[20:23], s78 offen offset:1024 lds
v_mfma_f32_16x16x32_bf16 v[80:83], v[20:23], a[144:147], v[80:83]
ds_read_b64_tr_b16 v[176:177], v1 offset:12800
v_mfma_f32_16x16x32_bf16 v[84:87], v[20:23], a[148:151], v[84:87]
ds_read_b64_tr_b16 v[178:179], v1 offset:13120
v_mfma_f32_16x16x32_bf16 v[88:91], v[20:23], a[152:155], v[88:91]
ds_read_b64_tr_b16 v[180:181], v2 offset:6400
v_mfma_f32_16x16x32_bf16 v[92:95], v[20:23], a[156:159], v[92:95]
s_waitcnt lgkmcnt(5)
ds_read_b64_tr_b16 v[182:183], v2 offset:6560
buffer_load_dwordx4 v150, s[20:23], s78 offen offset:2048 lds
v_mfma_f32_16x16x32_bf16 v[160:163], v[208:211], v[212:215], v[160:163]
ds_read_b64_tr_b16 v[184:185], v2 offset:6432
ds_read_b64_tr_b16 v[186:187], v2 offset:6592
v_mfma_f32_16x16x32_bf16 v[164:167], v[208:211], v[216:219], v[164:167]
ds_read_b64_tr_b16 v[16:17], v7 offset:12288
ds_read_b64_tr_b16 v[18:19], v7 offset:12544
v_mfma_f32_16x16x32_bf16 v[80:83], v[28:31], a[160:163], v[80:83]
ds_read_b64_tr_b16 v[20:21], v7 offset:13312
v_mfma_f32_16x16x32_bf16 v[84:87], v[28:31], a[164:167], v[84:87]
ds_read_b64_tr_b16 v[22:23], v7 offset:13568
buffer_load_dwordx4 v151, s[20:23], s78 offen offset:3072 lds
v_mfma_f32_16x16x32_bf16 v[88:91], v[28:31], a[168:171], v[88:91]
s_add_u32 m0, s62, 45056
v_mfma_f32_16x16x32_bf16 v[92:95], v[28:31], a[172:175], v[92:95]
s_waitcnt lgkmcnt(4)
v_mfma_f32_16x16x32_bf16 v[80:83], v[32:35], a[176:179], v[80:83]
ds_read_b64_tr_b16 v[112:113], v1 offset:15360
v_mfma_f32_16x16x32_bf16 v[84:87], v[32:35], a[180:183], v[84:87]
ds_read_b64_tr_b16 v[114:115], v1 offset:15680
buffer_load_dwordx4 v152, s[20:23], s78 offen offset:0 lds
v_mfma_f32_16x16x32_bf16 v[88:91], v[32:35], a[184:187], v[88:91]
ds_read_b64_tr_b16 v[116:117], v2 offset:7680
v_mfma_f32_16x16x32_bf16 v[92:95], v[32:35], a[188:191], v[92:95]
ds_read_b64_tr_b16 v[118:119], v2 offset:7840
v_mfma_f32_16x16x32_bf16 v[160:163], v[176:179], v[180:183], v[160:163]
ds_read_b64_tr_b16 v[120:121], v2 offset:7712
ds_read_b64_tr_b16 v[122:123], v2 offset:7872
v_mfma_f32_16x16x32_bf16 v[164:167], v[176:179], v[184:187], v[164:167]
s_waitcnt lgkmcnt(6)
ds_read_b64_tr_b16 v[28:29], v7 offset:14336
ds_read_b64_tr_b16 v[30:31], v7 offset:14592
v_mfma_f32_16x16x32_bf16 v[80:83], v[16:19], a[192:195], v[80:83]
ds_read_b64_tr_b16 v[32:33], v7 offset:15360
v_mfma_f32_16x16x32_bf16 v[84:87], v[16:19], a[196:199], v[84:87]
ds_read_b64_tr_b16 v[34:35], v7 offset:15616
v_mfma_f32_16x16x32_bf16 v[88:91], v[16:19], a[200:203], v[88:91]
v_mfma_f32_16x16x32_bf16 v[92:95], v[16:19], a[204:207], v[92:95]
v_mfma_f32_16x16x32_bf16 v[80:83], v[20:23], a[208:211], v[80:83]
ds_read_b64_tr_b16 v[208:209], v1 offset:17920
v_mfma_f32_16x16x32_bf16 v[84:87], v[20:23], a[212:215], v[84:87]
ds_read_b64_tr_b16 v[210:211], v1 offset:18240
v_mfma_f32_16x16x32_bf16 v[88:91], v[20:23], a[216:219], v[88:91]
ds_read_b64_tr_b16 v[212:213], v2 offset:8960
v_mfma_f32_16x16x32_bf16 v[92:95], v[20:23], a[220:223], v[92:95]
s_waitcnt lgkmcnt(5)
ds_read_b64_tr_b16 v[214:215], v2 offset:9120
v_mfma_f32_16x16x32_bf16 v[160:163], v[112:115], v[116:119], v[160:163]
ds_read_b64_tr_b16 v[216:217], v2 offset:8992
ds_read_b64_tr_b16 v[218:219], v2 offset:9152
v_mfma_f32_16x16x32_bf16 v[164:167], v[112:115], v[120:123], v[164:167]
ds_read_b64_tr_b16 v[16:17], v7 offset:16384
ds_read_b64_tr_b16 v[18:19], v7 offset:16640
v_mfma_f32_16x16x32_bf16 v[80:83], v[28:31], a[224:227], v[80:83]
ds_read_b64_tr_b16 v[20:21], v7 offset:17408
s_waitcnt vmcnt(9)
v_cmp_ne_u32 vcc, s57, v158
s_nop 1
s_cbranch_vccnz L_slow2
L_back2:
v_mfma_f32_16x16x32_bf16 v[84:87], v[28:31], a[228:231], v[84:87]
ds_read_b64_tr_b16 v[22:23], v7 offset:17664
v_mfma_f32_16x16x32_bf16 v[88:91], v[28:31], a[232:235], v[88:91]
v_mfma_f32_16x16x32_bf16 v[92:95], v[28:31], a[236:239], v[92:95]
s_waitcnt lgkmcnt(4)
v_mfma_f32_16x16x32_bf16 v[80:83], v[32:35], a[240:243], v[80:83]
ds_read_b64_tr_b16 v[24:25], v7 offset:18432
v_mfma_f32_16x16x32_bf16 v[84:87], v[32:35], a[244:247], v[84:87]
ds_read_b64_tr_b16 v[26:27], v7 offset:18688
v_mfma_f32_16x16x32_bf16 v[88:91], v[32:35], a[248:251], v[88:91]
v_mfma_f32_16x16x32_bf16 v[92:95], v[32:35], a[252:255], v[92:95]
v_mfma_f32_16x16x32_bf16 v[160:163], v[208:211], v[212:215], v[160:163]
ds_read_b64_tr_b16 v[28:29], v7 offset:19456
v_mfma_f32_16x16x32_bf16 v[164:167], v[208:211], v[216:219], v[164:167]
s_waitcnt lgkmcnt(3)
ds_read_b64_tr_b16 v[30:31], v7 offset:19712
v_mfma_f32_16x16x32_bf16 v[80:83], v[16:19], v[224:227], v[80:83]
ds_read_b64_tr_b16 v[32:33], v7 offset:20480
v_mfma_f32_16x16x32_bf16 v[84:87], v[16:19], v[228:231], v[84:87]
ds_read_b64_tr_b16 v[34:35], v7 offset:20736
v_mfma_f32_16x16x32_bf16 v[88:91], v[16:19], v[232:235], v[88:91]
v_mfma_f32_16x16x32_bf16 v[92:95], v[16:19], v[236:239], v[92:95]
buffer_store_dwordx4 v[160:163], v3, s[28:31], s87 offen sc1
buffer_store_dwordx4 v[164:167], v3, s[28:31], s87 offen offset:1024 sc1
v_mfma_f32_16x16x32_bf16 v[80:83], v[20:23], v[240:243], v[80:83]
ds_read_b64_tr_b16 v[36:37], v7 offset:21504
v_mfma_f32_16x16x32_bf16 v[84:87], v[20:23], v[244:247], v[84:87]
ds_read_b64_tr_b16 v[38:39], v7 offset:21760
v_mfma_f32_16x16x32_bf16 v[88:91], v[20:23], v[248:251], v[88:91]
v_mfma_f32_16x16x32_bf16 v[92:95], v[20:23], v[252:255], v[92:95]
s_waitcnt lgkmcnt(4)
v_mfma_f32_16x16x32_bf16 v[96:99], v[24:27], a[0:3], 0
ds_read_b64_tr_b16 v[16:17], v7 offset:22528
v_mfma_f32_16x16x32_bf16 v[100:103], v[24:27], a[4:7], 0
ds_read_b64_tr_b16 v[18:19], v7 offset:22784
v_mfma_f32_16x16x32_bf16 v[104:107], v[24:27], a[8:11], 0
v_mul_f32 v40, s59, v80
v_mul_f32 v41, s59, v81
v_mfma_f32_16x16x32_bf16 v[108:111], v[24:27], a[12:15], 0
v_exp_f32 v40, v40
v_mfma_f32_16x16x32_bf16 v[96:99], v[28:31], a[16:19], v[96:99]
ds_read_b64_tr_b16 v[20:21], v7 offset:23552
v_add_f32 v40, 1.0, v40
v_mfma_f32_16x16x32_bf16 v[100:103], v[28:31], a[20:23], v[100:103]
ds_read_b64_tr_b16 v[22:23], v7 offset:23808
v_mul_f32 v42, s59, v82
v_mfma_f32_16x16x32_bf16 v[104:107], v[28:31], a[24:27], v[104:107]
v_exp_f32 v41, v41
v_mfma_f32_16x16x32_bf16 v[108:111], v[28:31], a[28:31], v[108:111]
s_waitcnt lgkmcnt(4)
v_rcp_f32 v40, v40
v_mfma_f32_16x16x32_bf16 v[96:99], v[32:35], a[32:35], v[96:99]
s_add_u32 s63, s44, 0
ds_read_b64_tr_b16 v[24:25], v7 offset:24576
buffer_load_dwordx4 a[0:3], v12, s[28:31], s63 offen offset:0 sc1
v_mfma_f32_16x16x32_bf16 v[100:103], v[32:35], a[36:39], v[100:103]
ds_read_b64_tr_b16 v[26:27], v7 offset:24832
buffer_load_dwordx4 a[4:7], v12, s[28:31], s63 offen offset:1024 sc1
v_mfma_f32_16x16x32_bf16 v[104:107], v[32:35], a[40:43], v[104:107]
s_add_u32 s63, s44, 16384
buffer_load_dwordx4 a[8:11], v12, s[28:31], s63 offen offset:0 sc1
buffer_load_dwordx4 a[12:15], v12, s[28:31], s63 offen offset:1024 sc1
v_mfma_f32_16x16x32_bf16 v[108:111], v[32:35], a[44:47], v[108:111]
v_exp_f32 v42, v42
v_mfma_f32_16x16x32_bf16 v[96:99], v[36:39], a[48:51], v[96:99]
s_add_u32 s63, s44, 65536
ds_read_b64_tr_b16 v[28:29], v7 offset:25600
buffer_load_dwordx4 a[16:19], v12, s[28:31], s63 offen offset:0 sc1
v_mfma_f32_16x16x32_bf16 v[100:103], v[36:39], a[52:55], v[100:103]
ds_read_b64_tr_b16 v[30:31], v7 offset:25856
buffer_load_dwordx4 a[20:23], v12, s[28:31], s63 offen offset:1024 sc1
v_mfma_f32_16x16x32_bf16 v[104:107], v[36:39], a[56:59], v[104:107]
s_add_u32 s63, s44, 81920
buffer_load_dwordx4 a[24:27], v12, s[28:31], s63 offen offset:0 sc1
buffer_load_dwordx4 a[28:31], v12, s[28:31], s63 offen offset:1024 sc1
v_mfma_f32_16x16x32_bf16 v[108:111], v[36:39], a[60:63], v[108:111]
s_waitcnt lgkmcnt(4)
v_add_f32 v41, 1.0, v41
v_mul_f32 v43, s59, v83
v_mfma_f32_16x16x32_bf16 v[96:99], v[16:19], a[64:67], v[96:99]
s_mov_b32 s78, s6
ds_read_b64_tr_b16 v[32:33], v7 offset:26624
v_mul_f32 v80, v80, v40
v_mfma_f32_16x16x32_bf16 v[100:103], v[16:19], a[68:71], v[100:103]
s_add_u32 m0, s62, 73728
ds_read_b64_tr_b16 v[34:35], v7 offset:26880
buffer_load_dwordx4 v144, s[20:23], s78 offen offset:0 lds
v_mfma_f32_16x16x32_bf16 v[104:107], v[16:19], a[72:75], v[104:107]
buffer_load_dwordx4 v145, s[20:23], s78 offen offset:1024 lds
buffer_load_dwordx4 v146, s[20:23], s78 offen offset:2048 lds
v_mfma_f32_16x16x32_bf16 v[108:111], v[16:19], a[76:79], v[108:111]
buffer_load_dwordx4 v147, s[20:23], s78 offen offset:3072 lds
v_add_f32 v42, 1.0, v42
v_mfma_f32_16x16x32_bf16 v[96:99], v[20:23], a[80:83], v[96:99]
s_add_u32 m0, s62, 77824
ds_read_b64_tr_b16 v[36:37], v7 offset:27648
buffer_load_dwordx4 v148, s[20:23], s78 offen offset:0 lds
v_mfma_f32_16x16x32_bf16 v[100:103], v[20:23], a[84:87], v[100:103]
ds_read_b64_tr_b16 v[38:39], v7 offset:27904
v_mul_f32 v44, s59, v84
v_mfma_f32_16x16x32_bf16 v[104:107], v[20:23], a[88:91], v[104:107]
buffer_load_dwordx4 v149, s[20:23], s78 offen offset:1024 lds
v_mul_f32 v45, s59, v85
v_mfma_f32_16x16x32_bf16 v[108:111], v[20:23], a[92:95], v[108:111]
s_waitcnt lgkmcnt(4)
v_rcp_f32 v41, v41
v_mfma_f32_16x16x32_bf16 v[96:99], v[24:27], a[96:99], v[96:99]
ds_read_b64_tr_b16 v[16:17], v7 offset:28672
buffer_load_dwordx4 v150, s[20:23], s78 offen offset:2048 lds
v_mfma_f32_16x16x32_bf16 v[100:103], v[24:27], a[100:103], v[100:103]
ds_read_b64_tr_b16 v[18:19], v7 offset:28928
v_mul_f32 v81, v81, v41
v_mfma_f32_16x16x32_bf16 v[104:107], v[24:27], a[104:107], v[104:107]
buffer_load_dwordx4 v151, s[20:23], s78 offen offset:3072 lds
v_mul_f32 v40, s59, v86
v_mfma_f32_16x16x32_bf16 v[108:111], v[24:27], a[108:111], v[108:111]
s_add_u32 m0, s62, 81920
v_exp_f32 v43, v43
v_mfma_f32_16x16x32_bf16 v[96:99], v[28:31], a[112:115], v[96:99]
ds_read_b64_tr_b16 v[20:21], v7 offset:29696
buffer_load_dwordx4 v152, s[20:23], s78 offen offset:0 lds
v_mfma_f32_16x16x32_bf16 v[100:103], v[28:31], a[116:119], v[100:103]
ds_read_b64_tr_b16 v[22:23], v7 offset:29952
v_add_f32 v43, 1.0, v43
v_mfma_f32_16x16x32_bf16 v[104:107], v[28:31], a[120:123], v[104:107]
v_rcp_f32 v42, v42
v_mfma_f32_16x16x32_bf16 v[108:111], v[28:31], a[124:127], v[108:111]
s_waitcnt lgkmcnt(4)
v_exp_f32 v44, v44
v_mfma_f32_16x16x32_bf16 v[96:99], v[32:35], a[128:131], v[96:99]
ds_read_b64_tr_b16 v[24:25], v7 offset:30720
v_mul_f32 v82, v82, v42
v_mfma_f32_16x16x32_bf16 v[100:103], v[32:35], a[132:135], v[100:103]
ds_read_b64_tr_b16 v[26:27], v7 offset:30976
v_add_f32 v44, 1.0, v44
v_mfma_f32_16x16x32_bf16 v[104:107], v[32:35], a[136:139], v[104:107]
v_rcp_f32 v43, v43
v_mfma_f32_16x16x32_bf16 v[108:111], v[32:35], a[140:143], v[108:111]
v_exp_f32 v45, v45
v_mfma_f32_16x16x32_bf16 v[96:99], v[36:39], a[144:147], v[96:99]
ds_read_b64_tr_b16 v[28:29], v7 offset:31744
v_mul_f32 v83, v83, v43
v_mfma_f32_16x16x32_bf16 v[100:103], v[36:39], a[148:151], v[100:103]
ds_read_b64_tr_b16 v[30:31], v7 offset:32000
v_add_f32 v45, 1.0, v45
v_mfma_f32_16x16x32_bf16 v[104:107], v[36:39], a[152:155], v[104:107]
v_rcp_f32 v44, v44
v_mfma_f32_16x16x32_bf16 v[108:111], v[36:39], a[156:159], v[108:111]
s_waitcnt lgkmcnt(4)
v_exp_f32 v40, v40
v_mfma_f32_16x16x32_bf16 v[96:99], v[16:19], a[160:163], v[96:99]
ds_read_b64_tr_b16 v[32:33], v7 offset:32768
v_mul_f32 v41, s59, v87
v_mfma_f32_16x16x32_bf16 v[100:103], v[16:19], a[164:167], v[100:103]
ds_read_b64_tr_b16 v[34:35], v7 offset:33024
v_mul_f32 v84, v84, v44
v_mfma_f32_16x16x32_bf16 v[104:107], v[16:19], a[168:171], v[104:107]
v_rcp_f32 v45, v45
v_mfma_f32_16x16x32_bf16 v[108:111], v[16:19], a[172:175], v[108:111]
v_exp_f32 v41, v41
v_mfma_f32_16x16x32_bf16 v[96:99], v[20:23], a[176:179], v[96:99]
s_add_u32 s63, s45, 0
ds_read_b64_tr_b16 v[36:37], v7 offset:33792
buffer_load_dwordx4 a[32:35], v12, s[28:31], s63 offen offset:0 sc1
v_mfma_f32_16x16x32_bf16 v[100:103], v[20:23], a[180:183], v[100:103]
ds_read_b64_tr_b16 v[38:39], v7 offset:34048
buffer_load_dwordx4 a[36:39], v12, s[28:31], s63 offen offset:1024 sc1
v_mfma_f32_16x16x32_bf16 v[104:107], v[20:23], a[184:187], v[104:107]
s_add_u32 s63, s45, 16384
buffer_load_dwordx4 a[40:43], v12, s[28:31], s63 offen offset:0 sc1
buffer_load_dwordx4 a[44:47], v12, s[28:31], s63 offen offset:1024 sc1
v_mfma_f32_16x16x32_bf16 v[108:111], v[20:23], a[188:191], v[108:111]
s_waitcnt lgkmcnt(4)
v_add_f32 v40, 1.0, v40
v_mul_f32 v42, s59, v88
v_mfma_f32_16x16x32_bf16 v[96:99], v[24:27], a[192:195], v[96:99]
s_add_u32 s63, s45, 65536
ds_read_b64_tr_b16 v[16:17], v7 offset:34816
buffer_load_dwordx4 a[48:51], v12, s[28:31], s63 offen offset:0 sc1
v_mfma_f32_16x16x32_bf16 v[100:103], v[24:27], a[196:199], v[100:103]
ds_read_b64_tr_b16 v[18:19], v7 offset:35072
buffer_load_dwordx4 a[52:55], v12, s[28:31], s63 offen offset:1024 sc1
v_mfma_f32_16x16x32_bf16 v[104:107], v[24:27], a[200:203], v[104:107]
s_add_u32 s63, s45, 81920
buffer_load_dwordx4 a[56:59], v12, s[28:31], s63 offen offset:0 sc1
buffer_load_dwordx4 a[60:63], v12, s[28:31], s63 offen offset:1024 sc1
v_mfma_f32_16x16x32_bf16 v[108:111], v[24:27], a[204:207], v[108:111]
v_rcp_f32 v40, v40
v_mfma_f32_16x16x32_bf16 v[96:99], v[28:31], a[208:211], v[96:99]
ds_read_b64_tr_b16 v[20:21], v7 offset:35840
v_mul_f32 v85, v85, v45
v_mfma_f32_16x16x32_bf16 v[100:103], v[28:31], a[212:215], v[100:103]
ds_read_b64_tr_b16 v[22:23], v7 offset:36096
v_add_f32 v41, 1.0, v41
v_mfma_f32_16x16x32_bf16 v[104:107], v[28:31], a[216:219], v[104:107]
v_exp_f32 v42, v42
v_mfma_f32_16x16x32_bf16 v[108:111], v[28:31], a[220:223], v[108:111]
s_waitcnt lgkmcnt(4)
v_rcp_f32 v41, v41
v_mfma_f32_16x16x32_bf16 v[96:99], v[32:35], a[224:227], v[96:99]
v_mul_f32 v43, s59, v89
v_mul_f32 v86, v86, v40
v_mfma_f32_16x16x32_bf16 v[100:103], v[32:35], a[228:231], v[100:103]
v_exp_f32 v43, v43
v_mfma_f32_16x16x32_bf16 v[104:107], v[32:35], a[232:235], v[104:107]
v_add_f32 v42, 1.0, v42
v_mul_f32 v44, s59, v90
v_mfma_f32_16x16x32_bf16 v[108:111], v[32:35], a[236:239], v[108:111]
v_rcp_f32 v42, v42
v_mfma_f32_16x16x32_bf16 v[96:99], v[36:39], a[240:243], v[96:99]
v_exp_f32 v44, v44
v_mfma_f32_16x16x32_bf16 v[100:103], v[36:39], a[244:247], v[100:103]
v_mul_f32 v87, v87, v41
v_add_f32 v43, 1.0, v43
v_mfma_f32_16x16x32_bf16 v[104:107], v[36:39], a[248:251], v[104:107]
v_rcp_f32 v43, v43
v_mfma_f32_16x16x32_bf16 v[108:111], v[36:39], a[252:255], v[108:111]
s_waitcnt lgkmcnt(0)
v_mul_f32 v45, s59, v91
v_mul_f32 v88, v88, v42
v_mfma_f32_16x16x32_bf16 v[96:99], v[16:19], v[224:227], v[96:99]
v_exp_f32 v45, v45
v_mfma_f32_16x16x32_bf16 v[100:103], v[16:19], v[228:231], v[100:103]
v_add_f32 v44, 1.0, v44
v_mul_f32 v40, s59, v92
v_mfma_f32_16x16x32_bf16 v[104:107], v[16:19], v[232:235], v[104:107]
v_rcp_f32 v44, v44
v_mfma_f32_16x16x32_bf16 v[108:111], v[16:19], v[236:239], v[108:111]
v_exp_f32 v40, v40
v_mfma_f32_16x16x32_bf16 v[96:99], v[20:23], v[240:243], v[96:99]
v_mul_f32 v89, v89, v43
v_add_f32 v45, 1.0, v45
v_mfma_f32_16x16x32_bf16 v[100:103], v[20:23], v[244:247], v[100:103]
v_rcp_f32 v45, v45
v_mfma_f32_16x16x32_bf16 v[104:107], v[20:23], v[248:251], v[104:107]
v_mul_f32 v41, s59, v93
v_mul_f32 v90, v90, v44
v_mfma_f32_16x16x32_bf16 v[108:111], v[20:23], v[252:255], v[108:111]
v_exp_f32 v41, v41
v_add_f32 v40, 1.0, v40
v_mul_f32 v42, s59, v94
v_mul_f32 v91, v91, v45
v_rcp_f32 v40, v40
v_add_f32 v41, 1.0, v41
v_exp_f32 v42, v42
v_mul_f32 v43, s59, v95
v_mul_f32 v92, v92, v40
v_rcp_f32 v41, v41
v_add_f32 v42, 1.0, v42
v_exp_f32 v43, v43
v_mul_f32 v93, v93, v41
v_rcp_f32 v42, v42
v_add_f32 v43, 1.0, v43
v_mul_f32 v94, v94, v42
v_rcp_f32 v43, v43
s_nop 0
v_mul_f32 v95, v95, v43
s_waitcnt vmcnt(25)
s_barrier
ds_read_b64_tr_b16 v[16:17], v153 offset:0
ds_read_b64_tr_b16 v[18:19], v153 offset:4608
ds_read_b64_tr_b16 v[20:21], v154 offset:0
ds_read_b64_tr_b16 v[22:23], v154 offset:4608
ds_read_b64_tr_b16 v[24:25], v155 offset:0
ds_read_b64_tr_b16 v[26:27], v155 offset:4608
ds_read_b64_tr_b16 v[28:29], v156 offset:0
ds_read_b64_tr_b16 v[30:31], v156 offset:4608
v_mov_b32 v15, s57
s_add_u32 s77, s67, 34603008
buffer_store_dword v15, v0, s[28:31], s77 offen sc1
ds_read_b64_tr_b16 v[32:33], v153 offset:32
ds_read_b64_tr_b16 v[34:35], v153 offset:4640
ds_read_b64_tr_b16 v[36:37], v154 offset:32
ds_read_b64_tr_b16 v[38:39], v154 offset:4640
s_waitcnt vmcnt(25) lgkmcnt(10)
v_mfma_f32_16x16x32_bf16 v[176:179], v[16:19], a[0:3], 0
s_lshr_b32 s69, s53, 1
ds_read_b64_tr_b16 v[40:41], v155 offset:32
s_mov_b32 s84, 4096
buffer_load_dword v6, v12, s[96:99], s84 offen
s_waitcnt vmcnt(25)
v_mfma_f32_16x16x32_bf16 v[180:183], v[16:19], a[4:7], 0
s_lshl_b32 s70, s53, 2
ds_read_b64_tr_b16 v[42:43], v155 offset:4640
s_mov_b32 s84, 5120
buffer_load_dword v5, v12, s[96:99], s84 offen
s_waitcnt lgkmcnt(10)
v_mfma_f32_16x16x32_bf16 v[188:191], v[20:23], a[4:7], 0
s_sub_u32 s69, s69, s70
ds_read_b64_tr_b16 v[44:45], v156 offset:32
s_mov_b32 s84, 6144
buffer_load_dwordx3 v[8:10], v12, s[96:99], s84 offen
v_mfma_f32_16x16x32_bf16 v[184:187], v[20:23], a[0:3], 0
s_mov_b32 s78, s7
ds_read_b64_tr_b16 v[46:47], v156 offset:4640
v_mul_f32 v96, v80, v96
s_waitcnt lgkmcnt(10)
v_mfma_f32_16x16x32_bf16 v[192:195], v[24:27], a[0:3], 0
s_add_u32 m0, s62, 110592
ds_read_b64_tr_b16 v[16:17], v157 offset:0
v_mul_f32 v97, v81, v97
v_mfma_f32_16x16x32_bf16 v[196:199], v[24:27], a[4:7], 0
s_waitcnt lgkmcnt(5)
ds_read_b64_tr_b16 v[18:19], v157 offset:4608
v_mul_f32 v98, v82, v98
v_mfma_f32_16x16x32_bf16 v[204:207], v[28:31], a[4:7], 0
s_add_u32 s69, s69, 16
ds_read_b64_tr_b16 v[20:21], v153 offset:9216
v_mul_f32 v99, v83, v99
v_mfma_f32_16x16x32_bf16 v[200:203], v[28:31], a[0:3], 0
s_mul_i32 s69, s69, 16384
ds_read_b64_tr_b16 v[22:23], v153 offset:13824
v_mul_f32 v100, v84, v100
v_mfma_f32_16x16x32_bf16 v[208:211], v[32:35], a[0:3], 0
s_add_u32 s64, s79, s69
ds_read_b64_tr_b16 v[24:25], v154 offset:9216
v_mul_f32 v101, v85, v101
v_mfma_f32_16x16x32_bf16 v[212:215], v[32:35], a[4:7], 0
s_and_b32 s69, s53, 1
ds_read_b64_tr_b16 v[26:27], v154 offset:13824
buffer_load_dwordx4 v144, s[20:23], s78 offen offset:0 lds
v_mfma_f32_16x16x32_bf16 v[220:223], v[36:39], a[4:7], 0
s_lshl_b32 s69, s69, 10
ds_read_b64_tr_b16 v[28:29], v155 offset:9216
v_mul_f32 v102, v86, v102
v_mfma_f32_16x16x32_bf16 v[216:219], v[36:39], a[0:3], 0
s_waitcnt lgkmcnt(5)
ds_read_b64_tr_b16 v[30:31], v155 offset:13824
v_mul_f32 v103, v87, v103
v_mfma_f32_16x16x32_bf16 v[224:227], v[40:43], a[0:3], 0
s_add_u32 s64, s64, s69
ds_read_b64_tr_b16 v[32:33], v156 offset:9216
buffer_load_dwordx4 v145, s[20:23], s78 offen offset:1024 lds
v_mfma_f32_16x16x32_bf16 v[228:231], v[40:43], a[4:7], 0
ds_read_b64_tr_b16 v[34:35], v156 offset:13824
v_mul_f32 v104, v88, v104
v_mfma_f32_16x16x32_bf16 v[236:239], v[44:47], a[4:7], 0
ds_read_b64_tr_b16 v[36:37], v153 offset:9248
v_mul_f32 v105, v89, v105
v_mfma_f32_16x16x32_bf16 v[232:235], v[44:47], a[0:3], 0
ds_read_b64_tr_b16 v[38:39], v153 offset:13856
v_mul_f32 v106, v90, v106
v_mfma_f32_16x16x32_bf16 v[240:243], v[16:19], a[0:3], 0
ds_read_b64_tr_b16 v[40:41], v154 offset:9248
buffer_load_dwordx4 v146, s[20:23], s78 offen offset:2048 lds
v_mfma_f32_16x16x32_bf16 v[244:247], v[16:19], a[4:7], 0
s_waitcnt vmcnt(28) lgkmcnt(5)
ds_read_b64_tr_b16 v[42:43], v154 offset:13856
v_mul_f32 v107, v91, v107
v_mfma_f32_16x16x32_bf16 v[176:179], v[20:23], a[8:11], v[176:179]
ds_read_b64_tr_b16 v[44:45], v155 offset:9248
v_mul_f32 v108, v92, v108
v_mfma_f32_16x16x32_bf16 v[180:183], v[20:23], a[12:15], v[180:183]
ds_read_b64_tr_b16 v[46:47], v155 offset:13856
buffer_load_dwordx4 v147, s[20:23], s78 offen offset:3072 lds
v_mfma_f32_16x16x32_bf16 v[188:191], v[24:27], a[12:15], v[188:191]
s_add_u32 m0, s62, 114688
ds_read_b64_tr_b16 v[16:17], v156 offset:9248
v_mul_f32 v109, v93, v109
v_mfma_f32_16x16x32_bf16 v[184:187], v[24:27], a[8:11], v[184:187]
ds_read_b64_tr_b16 v[18:19], v156 offset:13856
v_mul_f32 v110, v94, v110
v_mfma_f32_16x16x32_bf16 v[192:195], v[28:31], a[8:11], v[192:195]
ds_read_b64_tr_b16 v[20:21], v157 offset:9216
v_mul_f32 v111, v95, v111
v_mfma_f32_16x16x32_bf16 v[196:199], v[28:31], a[12:15], v[196:199]
s_waitcnt lgkmcnt(5)
ds_read_b64_tr_b16 v[22:23], v157 offset:13824
buffer_load_dwordx4 v148, s[20:23], s78 offen offset:0 lds
v_mfma_f32_16x16x32_bf16 v[204:207], v[32:35], a[12:15], v[204:207]
ds_read_b64_tr_b16 v[24:25], v153 offset:18432
v_cvt_pk_bf16_f32 v80, v96, v97
v_mfma_f32_16x16x32_bf16 v[200:203], v[32:35], a[8:11], v[200:203]
ds_read_b64_tr_b16 v[26:27], v153 offset:23040
v_cvt_pk_bf16_f32 v81, v98, v99
v_mfma_f32_16x16x32_bf16 v[208:211], v[36:39], a[8:11], v[208:211]
ds_read_b64_tr_b16 v[28:29], v154 offset:18432
buffer_load_dwordx4 v149, s[20:23], s78 offen offset:1024 lds
v_mfma_f32_16x16x32_bf16 v[212:215], v[36:39], a[12:15], v[212:215]
ds_read_b64_tr_b16 v[30:31], v154 offset:23040
v_cvt_pk_bf16_f32 v82, v100, v101
v_mfma_f32_16x16x32_bf16 v[220:223], v[40:43], a[12:15], v[220:223]
ds_read_b64_tr_b16 v[32:33], v155 offset:18432
v_cvt_pk_bf16_f32 v83, v102, v103
v_mfma_f32_16x16x32_bf16 v[216:219], v[40:43], a[8:11], v[216:219]
s_waitcnt lgkmcnt(5)
ds_read_b64_tr_b16 v[34:35], v155 offset:23040
v_cvt_pk_bf16_f32 v84, v104, v105
v_mfma_f32_16x16x32_bf16 v[224:227], v[44:47], a[8:11], v[224:227]
ds_read_b64_tr_b16 v[36:37], v156 offset:18432
buffer_load_dwordx4 v150, s[20:23], s78 offen offset:2048 lds
v_mfma_f32_16x16x32_bf16 v[228:231], v[44:47], a[12:15], v[228:231]
ds_read_b64_tr_b16 v[38:39], v156 offset:23040
v_cvt_pk_bf16_f32 v85, v106, v107
v_mfma_f32_16x16x32_bf16 v[236:239], v[16:19], a[12:15], v[236:239]
ds_read_b64_tr_b16 v[40:41], v153 offset:18464
v_cvt_pk_bf16_f32 v86, v108, v109
v_mfma_f32_16x16x32_bf16 v[232:235], v[16:19], a[8:11], v[232:235]
ds_read_b64_tr_b16 v[42:43], v153 offset:23072
buffer_load_dwordx4 v151, s[20:23], s78 offen offset:3072 lds
v_mfma_f32_16x16x32_bf16 v[240:243], v[20:23], a[8:11], v[240:243]
s_add_u32 m0, s62, 118784
ds_read_b64_tr_b16 v[44:45], v154 offset:18464
v_cvt_pk_bf16_f32 v87, v110, v111
v_mfma_f32_16x16x32_bf16 v[244:247], v[20:23], a[12:15], v[244:247]
s_waitcnt vmcnt(31) lgkmcnt(5)
ds_read_b64_tr_b16 v[46:47], v154 offset:23072
buffer_store_dwordx4 v[80:83], v12, s[28:31], s64 offen offset:0 sc1
v_mfma_f32_16x16x32_bf16 v[176:179], v[24:27], a[16:19], v[176:179]
ds_read_b64_tr_b16 v[16:17], v155 offset:18464
buffer_store_dwordx4 v[84:87], v12, s[28:31], s64 offen offset:2048 sc1
v_mfma_f32_16x16x32_bf16 v[180:183], v[24:27], a[20:23], v[180:183]
ds_read_b64_tr_b16 v[18:19], v155 offset:23072
buffer_load_dwordx4 v152, s[20:23], s78 offen offset:0 lds
v_mfma_f32_16x16x32_bf16 v[188:191], v[28:31], a[20:23], v[188:191]
s_add_u32 s63, s46, 0
ds_read_b64_tr_b16 v[20:21], v156 offset:18464
v_mov_b32 v106, 0
v_mfma_f32_16x16x32_bf16 v[184:187], v[28:31], a[16:19], v[184:187]
ds_read_b64_tr_b16 v[22:23], v156 offset:23072
v_mov_b32 v107, 0
v_mfma_f32_16x16x32_bf16 v[192:195], v[32:35], a[16:19], v[192:195]
ds_read_b64_tr_b16 v[24:25], v157 offset:18432
v_mfma_f32_16x16x32_bf16 v[196:199], v[32:35], a[20:23], v[196:199]
s_waitcnt lgkmcnt(5)
ds_read_b64_tr_b16 v[26:27], v157 offset:23040
buffer_load_dwordx4 a[64:67], v12, s[28:31], s63 offen offset:0 sc1
v_mfma_f32_16x16x32_bf16 v[204:207], v[36:39], a[20:23], v[204:207]
ds_read_b64_tr_b16 v[28:29], v153 offset:27648
v_mfma_f32_16x16x32_bf16 v[200:203], v[36:39], a[16:19], v[200:203]
ds_read_b64_tr_b16 v[30:31], v153 offset:32256
v_mfma_f32_16x16x32_bf16 v[208:211], v[40:43], a[16:19], v[208:211]
ds_read_b64_tr_b16 v[32:33], v154 offset:27648
buffer_load_dwordx4 a[68:71], v12, s[28:31], s63 offen offset:1024 sc1
v_mfma_f32_16x16x32_bf16 v[212:215], v[40:43], a[20:23], v[212:215]
s_add_u32 s63, s46, 16384
ds_read_b64_tr_b16 v[34:35], v154 offset:32256
v_mfma_f32_16x16x32_bf16 v[220:223], v[44:47], a[20:23], v[220:223]
ds_read_b64_tr_b16 v[36:37], v155 offset:27648
v_mfma_f32_16x16x32_bf16 v[216:219], v[44:47], a[16:19], v[216:219]
s_waitcnt lgkmcnt(5)
ds_read_b64_tr_b16 v[38:39], v155 offset:32256
v_mfma_f32_16x16x32_bf16 v[224:227], v[16:19], a[16:19], v[224:227]
ds_read_b64_tr_b16 v[40:41], v156 offset:27648
buffer_load_dwordx4 a[72:75], v12, s[28:31], s63 offen offset:0 sc1
v_mfma_f32_16x16x32_bf16 v[228:231], v[16:19], a[20:23], v[228:231]
ds_read_b64_tr_b16 v[42:43], v156 offset:32256
s_waitcnt vmcnt(14)
v_lshl_add_u32 v8, s48, 8, v8
v_mfma_f32_16x16x32_bf16 v[236:239], v[20:23], a[20:23], v[236:239]
s_lshr_b32 s71, s51, 1
ds_read_b64_tr_b16 v[44:45], v153 offset:27680
s_add_u32 s69, s85, 640
v_mfma_f32_16x16x32_bf16 v[232:235], v[20:23], a[16:19], v[232:235]
s_lshl_b32 s69, s69, 10
ds_read_b64_tr_b16 v[46:47], v153 offset:32288
buffer_load_dwordx4 a[76:79], v12, s[28:31], s63 offen offset:1024 sc1
v_mfma_f32_16x16x32_bf16 v[240:243], v[24:27], a[16:19], v[240:243]
s_add_u32 s63, s46, 65536
ds_read_b64_tr_b16 v[16:17], v154 offset:27680
v_bfrev_b32 v11, 1
v_mfma_f32_16x16x32_bf16 v[244:247], v[24:27], a[20:23], v[244:247]
s_waitcnt lgkmcnt(5)
ds_read_b64_tr_b16 v[18:19], v154 offset:32288
v_cmp_eq_u32 vcc, 0, v9
v_mfma_f32_16x16x32_bf16 v[176:179], v[28:31], a[24:27], v[176:179]
s_lshl_b32 s70, s51, 8
ds_read_b64_tr_b16 v[20:21], v155 offset:27680
v_mul_u32_u24 v143, 9216, v9
v_mfma_f32_16x16x32_bf16 v[180:183], v[28:31], a[28:31], v[180:183]
s_add_u32 s70, s69, s70
ds_read_b64_tr_b16 v[22:23], v155 offset:32288
buffer_load_dwordx4 a[80:83], v12, s[28:31], s63 offen offset:0 sc1
v_mfma_f32_16x16x32_bf16 v[188:191], v[32:35], a[28:31], v[188:191]
s_sub_u32 s71, 4, s71
ds_read_b64_tr_b16 v[24:25], v156 offset:27680
v_lshl_add_u32 v13, v9, 8, v12
v_mfma_f32_16x16x32_bf16 v[184:187], v[32:35], a[24:27], v[184:187]
s_mul_i32 s71, s71, 16384
ds_read_b64_tr_b16 v[26:27], v156 offset:32288
v_cndmask_b32 v11, v11, v12, vcc
v_mfma_f32_16x16x32_bf16 v[192:195], v[36:39], a[24:27], v[192:195]
s_sub_u32 s69, s69, s71
ds_read_b64_tr_b16 v[28:29], v157 offset:27648
buffer_load_dwordx4 a[84:87], v12, s[28:31], s63 offen offset:1024 sc1
v_mfma_f32_16x16x32_bf16 v[196:199], v[36:39], a[28:31], v[196:199]
s_waitcnt lgkmcnt(5)
ds_read_b64_tr_b16 v[30:31], v157 offset:32256
s_add_u32 s63, s46, 81920
v_mfma_f32_16x16x32_bf16 v[204:207], v[40:43], a[28:31], v[204:207]
s_and_b32 s76, s51, 1
s_lshl_b32 s71, s76, 10
s_add_u32 s69, s69, s71
v_mfma_f32_16x16x32_bf16 v[200:203], v[40:43], a[24:27], v[200:203]
s_lshl_b32 s76, s76, 2
s_add_u32 s76, s76, s48
v_lshl_add_u32 v10, s76, 7, v10
v_mfma_f32_16x16x32_bf16 v[208:211], v[44:47], a[24:27], v[208:211]
s_waitcnt lgkmcnt(0)
buffer_load_dwordx4 a[88:91], v12, s[28:31], s63 offen offset:0 sc1
s_barrier
v_mfma_f32_16x16x32_bf16 v[212:215], v[44:47], a[28:31], v[212:215]
v_add_u32 v153, 36864, v153
v_mfma_f32_16x16x32_bf16 v[220:223], v[16:19], a[28:31], v[220:223]
ds_read_b64_tr_b16 v[32:33], v153 offset:0
ds_read_b64_tr_b16 v[34:35], v153 offset:4608
v_mfma_f32_16x16x32_bf16 v[216:219], v[16:19], a[24:27], v[216:219]
buffer_load_dwordx4 a[92:95], v12, s[28:31], s63 offen offset:1024 sc1
v_add_u32 v154, 36864, v154
v_mfma_f32_16x16x32_bf16 v[224:227], v[20:23], a[24:27], v[224:227]
s_mov_b32 s78, s16
ds_read_b64_tr_b16 v[36:37], v154 offset:0
ds_read_b64_tr_b16 v[38:39], v154 offset:4608
v_mfma_f32_16x16x32_bf16 v[228:231], v[20:23], a[28:31], v[228:231]
s_add_u32 m0, s62, 0
v_add_u32 v155, 36864, v155
v_mfma_f32_16x16x32_bf16 v[236:239], v[24:27], a[28:31], v[236:239]
ds_read_b64_tr_b16 v[40:41], v155 offset:0
ds_read_b64_tr_b16 v[42:43], v155 offset:4608
v_mfma_f32_16x16x32_bf16 v[232:235], v[24:27], a[24:27], v[232:235]
v_add_u32 v156, 36864, v156
v_mfma_f32_16x16x32_bf16 v[240:243], v[28:31], a[24:27], v[240:243]
ds_read_b64_tr_b16 v[44:45], v156 offset:0
ds_read_b64_tr_b16 v[46:47], v156 offset:4608
v_mfma_f32_16x16x32_bf16 v[244:247], v[28:31], a[28:31], v[244:247]
s_waitcnt lgkmcnt(2)
v_add_u32 v157, 36864, v157
v_mfma_f32_16x16x32_bf16 v[176:179], v[32:35], a[32:35], v[176:179]
ds_read_b64_tr_b16 v[16:17], v153 offset:32
ds_read_b64_tr_b16 v[18:19], v153 offset:4640
v_mfma_f32_16x16x32_bf16 v[180:183], v[32:35], a[36:39], v[180:183]
ds_read_b64_tr_b16 v[20:21], v154 offset:32
ds_read_b64_tr_b16 v[22:23], v154 offset:4640
v_mfma_f32_16x16x32_bf16 v[188:191], v[36:39], a[36:39], v[188:191]
ds_read_b64_tr_b16 v[24:25], v155 offset:32
ds_read_b64_tr_b16 v[26:27], v155 offset:4640
v_mfma_f32_16x16x32_bf16 v[184:187], v[36:39], a[32:35], v[184:187]
ds_read_b64_tr_b16 v[28:29], v156 offset:32
ds_read_b64_tr_b16 v[30:31], v156 offset:4640
v_mfma_f32_16x16x32_bf16 v[192:195], v[40:43], a[32:35], v[192:195]
ds_read_b64_tr_b16 v[32:33], v157 offset:0
buffer_load_dwordx4 v144, s[20:23], s78 offen offset:0 lds
v_mfma_f32_16x16x32_bf16 v[196:199], v[40:43], a[36:39], v[196:199]
s_waitcnt lgkmcnt(5)
ds_read_b64_tr_b16 v[34:35], v157 offset:4608
buffer_load_dwordx4 v145, s[20:23], s78 offen offset:1024 lds
v_mfma_f32_16x16x32_bf16 v[204:207], v[44:47], a[36:39], v[204:207]
ds_read_b64_tr_b16 v[36:37], v153 offset:9216
v_mfma_f32_16x16x32_bf16 v[200:203], v[44:47], a[32:35], v[200:203]
ds_read_b64_tr_b16 v[38:39], v153 offset:13824
buffer_load_dwordx4 v146, s[20:23], s78 offen offset:2048 lds
v_mfma_f32_16x16x32_bf16 v[208:211], v[16:19], a[32:35], v[208:211]
ds_read_b64_tr_b16 v[40:41], v154 offset:9216
v_mfma_f32_16x16x32_bf16 v[212:215], v[16:19], a[36:39], v[212:215]
ds_read_b64_tr_b16 v[42:43], v154 offset:13824
v_mfma_f32_16x16x32_bf16 v[220:223], v[20:23], a[36:39], v[220:223]
ds_read_b64_tr_b16 v[44:45], v155 offset:9216
buffer_load_dwordx4 v147, s[20:23], s78 offen offset:3072 lds
v_mfma_f32_16x16x32_bf16 v[216:219], v[20:23], a[32:35], v[216:219]
s_waitcnt lgkmcnt(5)
ds_read_b64_tr_b16 v[46:47], v155 offset:13824
s_add_u32 m0, s62, 4096
v_mfma_f32_16x16x32_bf16 v[224:227], v[24:27], a[32:35], v[224:227]
ds_read_b64_tr_b16 v[16:17], v156 offset:9216
v_mfma_f32_16x16x32_bf16 v[228:231], v[24:27], a[36:39], v[228:231]
ds_read_b64_tr_b16 v[18:19], v156 offset:13824
v_mfma_f32_16x16x32_bf16 v[236:239], v[28:31], a[36:39], v[236:239]
ds_read_b64_tr_b16 v[20:21], v153 offset:9248
buffer_load_dwordx4 v148, s[20:23], s78 offen offset:0 lds
v_mfma_f32_16x16x32_bf16 v[232:235], v[28:31], a[32:35], v[232:235]
ds_read_b64_tr_b16 v[22:23], v153 offset:13856
v_mfma_f32_16x16x32_bf16 v[240:243], v[32:35], a[32:35], v[240:243]
ds_read_b64_tr_b16 v[24:25], v154 offset:9248
v_mfma_f32_16x16x32_bf16 v[244:247], v[32:35], a[36:39], v[244:247]
s_waitcnt lgkmcnt(5)
ds_read_b64_tr_b16 v[26:27], v154 offset:13856
buffer_load_dwordx4 v149, s[20:23], s78 offen offset:1024 lds
v_mfma_f32_16x16x32_bf16 v[176:179], v[36:39], a[40:43], v[176:179]
ds_read_b64_tr_b16 v[28:29], v155 offset:9248
v_mfma_f32_16x16x32_bf16 v[180:183], v[36:39], a[44:47], v[180:183]
ds_read_b64_tr_b16 v[30:31], v155 offset:13856
v_mfma_f32_16x16x32_bf16 v[188:191], v[40:43], a[44:47], v[188:191]
ds_read_b64_tr_b16 v[32:33], v156 offset:9248
v_mfma_f32_16x16x32_bf16 v[184:187], v[40:43], a[40:43], v[184:187]
ds_read_b64_tr_b16 v[34:35], v156 offset:13856
buffer_load_dwordx4 v150, s[20:23], s78 offen offset:2048 lds
v_mfma_f32_16x16x32_bf16 v[192:195], v[44:47], a[40:43], v[192:195]
ds_read_b64_tr_b16 v[36:37], v157 offset:9216
v_mfma_f32_16x16x32_bf16 v[196:199], v[44:47], a[44:47], v[196:199]
s_waitcnt lgkmcnt(5)
ds_read_b64_tr_b16 v[38:39], v157 offset:13824
v_mfma_f32_16x16x32_bf16 v[204:207], v[16:19], a[44:47], v[204:207]
ds_read_b64_tr_b16 v[40:41], v153 offset:18432
buffer_load_dwordx4 v151, s[20:23], s78 offen offset:3072 lds
v_mfma_f32_16x16x32_bf16 v[200:203], v[16:19], a[40:43], v[200:203]
s_add_u32 m0, s62, 8192
ds_read_b64_tr_b16 v[42:43], v153 offset:23040
v_mfma_f32_16x16x32_bf16 v[208:211], v[20:23], a[40:43], v[208:211]
ds_read_b64_tr_b16 v[44:45], v154 offset:18432
v_mfma_f32_16x16x32_bf16 v[212:215], v[20:23], a[44:47], v[212:215]
ds_read_b64_tr_b16 v[46:47], v154 offset:23040
v_mfma_f32_16x16x32_bf16 v[220:223], v[24:27], a[44:47], v[220:223]
ds_read_b64_tr_b16 v[16:17], v155 offset:18432
buffer_load_dwordx4 v152, s[20:23], s78 offen offset:0 lds
v_mfma_f32_16x16x32_bf16 v[216:219], v[24:27], a[40:43], v[216:219]
s_waitcnt lgkmcnt(5)
ds_read_b64_tr_b16 v[18:19], v155 offset:23040
s_add_u32 s63, s47, 0
v_mfma_f32_16x16x32_bf16 v[224:227], v[28:31], a[40:43], v[224:227]
ds_read_b64_tr_b16 v[20:21], v156 offset:18432
v_mfma_f32_16x16x32_bf16 v[228:231], v[28:31], a[44:47], v[228:231]
ds_read_b64_tr_b16 v[22:23], v156 offset:23040
v_mfma_f32_16x16x32_bf16 v[236:239], v[32:35], a[44:47], v[236:239]
ds_read_b64_tr_b16 v[24:25], v153 offset:18464
buffer_load_dwordx4 a[96:99], v12, s[28:31], s63 offen offset:0 sc1
v_mfma_f32_16x16x32_bf16 v[232:235], v[32:35], a[40:43], v[232:235]
ds_read_b64_tr_b16 v[26:27], v153 offset:23072
v_mfma_f32_16x16x32_bf16 v[240:243], v[36:39], a[40:43], v[240:243]
ds_read_b64_tr_b16 v[28:29], v154 offset:18464
v_mfma_f32_16x16x32_bf16 v[244:247], v[36:39], a[44:47], v[244:247]
s_waitcnt lgkmcnt(5)
ds_read_b64_tr_b16 v[30:31], v154 offset:23072
buffer_load_dwordx4 a[100:103], v12, s[28:31], s63 offen offset:1024 sc1
v_mfma_f32_16x16x32_bf16 v[176:179], v[40:43], a[48:51], v[176:179]
s_add_u32 s63, s47, 16384
ds_read_b64_tr_b16 v[32:33], v155 offset:18464
v_mfma_f32_16x16x32_bf16 v[180:183], v[40:43], a[52:55], v[180:183]
ds_read_b64_tr_b16 v[34:35], v155 offset:23072
v_mfma_f32_16x16x32_bf16 v[188:191], v[44:47], a[52:55], v[188:191]
ds_read_b64_tr_b16 v[36:37], v156 offset:18464
v_mfma_f32_16x16x32_bf16 v[184:187], v[44:47], a[48:51], v[184:187]
ds_read_b64_tr_b16 v[38:39], v156 offset:23072
buffer_load_dwordx4 a[104:107], v12, s[28:31], s63 offen offset:0 sc1
v_mfma_f32_16x16x32_bf16 v[192:195], v[16:19], a[48:51], v[192:195]
ds_read_b64_tr_b16 v[40:41], v157 offset:18432
v_mfma_f32_16x16x32_bf16 v[196:199], v[16:19], a[52:55], v[196:199]
s_waitcnt lgkmcnt(5)
ds_read_b64_tr_b16 v[42:43], v157 offset:23040
v_mfma_f32_16x16x32_bf16 v[204:207], v[20:23], a[52:55], v[204:207]
ds_read_b64_tr_b16 v[44:45], v153 offset:27648
buffer_load_dwordx4 a[108:111], v12, s[28:31], s63 offen offset:1024 sc1
v_mfma_f32_16x16x32_bf16 v[200:203], v[20:23], a[48:51], v[200:203]
s_add_u32 s63, s47, 65536
ds_read_b64_tr_b16 v[46:47], v153 offset:32256
v_mfma_f32_16x16x32_bf16 v[208:211], v[24:27], a[48:51], v[208:211]
ds_read_b64_tr_b16 v[16:17], v154 offset:27648
v_mfma_f32_16x16x32_bf16 v[212:215], v[24:27], a[52:55], v[212:215]
ds_read_b64_tr_b16 v[18:19], v154 offset:32256
v_mfma_f32_16x16x32_bf16 v[220:223], v[28:31], a[52:55], v[220:223]
ds_read_b64_tr_b16 v[20:21], v155 offset:27648
buffer_load_dwordx4 a[112:115], v12, s[28:31], s63 offen offset:0 sc1
v_mfma_f32_16x16x32_bf16 v[216:219], v[28:31], a[48:51], v[216:219]
s_waitcnt lgkmcnt(5)
ds_read_b64_tr_b16 v[22:23], v155 offset:32256
v_mfma_f32_16x16x32_bf16 v[224:227], v[32:35], a[48:51], v[224:227]
ds_read_b64_tr_b16 v[24:25], v156 offset:27648
v_mfma_f32_16x16x32_bf16 v[228:231], v[32:35], a[52:55], v[228:231]
ds_read_b64_tr_b16 v[26:27], v156 offset:32256
buffer_load_dwordx4 a[116:119], v12, s[28:31], s63 offen offset:1024 sc1
v_mfma_f32_16x16x32_bf16 v[236:239], v[36:39], a[52:55], v[236:239]
s_add_u32 s63, s47, 81920
ds_read_b64_tr_b16 v[28:29], v153 offset:27680
v_mfma_f32_16x16x32_bf16 v[232:235], v[36:39], a[48:51], v[232:235]
ds_read_b64_tr_b16 v[30:31], v153 offset:32288
v_mfma_f32_16x16x32_bf16 v[240:243], v[40:43], a[48:51], v[240:243]
ds_read_b64_tr_b16 v[32:33], v154 offset:27680
v_mfma_f32_16x16x32_bf16 v[244:247], v[40:43], a[52:55], v[244:247]
s_waitcnt lgkmcnt(5)
ds_read_b64_tr_b16 v[34:35], v154 offset:32288
buffer_load_dwordx4 a[120:123], v12, s[28:31], s63 offen offset:0 sc1
v_mfma_f32_16x16x32_bf16 v[176:179], v[44:47], a[56:59], v[176:179]
ds_read_b64_tr_b16 v[36:37], v155 offset:27680
v_mfma_f32_16x16x32_bf16 v[180:183], v[44:47], a[60:63], v[180:183]
ds_read_b64_tr_b16 v[38:39], v155 offset:32288
v_mfma_f32_16x16x32_bf16 v[188:191], v[16:19], a[60:63], v[188:191]
ds_read_b64_tr_b16 v[40:41], v156 offset:27680
buffer_load_dwordx4 a[124:127], v12, s[28:31], s63 offen offset:1024 sc1
v_mfma_f32_16x16x32_bf16 v[184:187], v[16:19], a[56:59], v[184:187]
ds_read_b64_tr_b16 v[42:43], v156 offset:32288
v_mfma_f32_16x16x32_bf16 v[192:195], v[20:23], a[56:59], v[192:195]
ds_read_b64_tr_b16 v[44:45], v157 offset:27648
v_mfma_f32_16x16x32_bf16 v[196:199], v[20:23], a[60:63], v[196:199]
s_waitcnt lgkmcnt(5)
ds_read_b64_tr_b16 v[46:47], v157 offset:32256
v_mfma_f32_16x16x32_bf16 v[204:207], v[24:27], a[60:63], v[204:207]
v_mfma_f32_16x16x32_bf16 v[200:203], v[24:27], a[56:59], v[200:203]
v_mfma_f32_16x16x32_bf16 v[208:211], v[28:31], a[56:59], v[208:211]
s_waitcnt vmcnt(26) lgkmcnt(0)
s_barrier
v_add_u32 v153, 36864, v153
v_mfma_f32_16x16x32_bf16 v[212:215], v[28:31], a[60:63], v[212:215]
ds_read_b64_tr_b16 v[16:17], v153 offset:0
ds_read_b64_tr_b16 v[18:19], v153 offset:4608
v_mfma_f32_16x16x32_bf16 v[220:223], v[32:35], a[60:63], v[220:223]
v_add_u32 v154, 36864, v154
v_mfma_f32_16x16x32_bf16 v[216:219], v[32:35], a[56:59], v[216:219]
ds_read_b64_tr_b16 v[20:21], v154 offset:0
ds_read_b64_tr_b16 v[22:23], v154 offset:4608
v_mfma_f32_16x16x32_bf16 v[224:227], v[36:39], a[56:59], v[224:227]
v_add_u32 v155, 36864, v155
v_mfma_f32_16x16x32_bf16 v[228:231], v[36:39], a[60:63], v[228:231]
ds_read_b64_tr_b16 v[24:25], v155 offset:0
ds_read_b64_tr_b16 v[26:27], v155 offset:4608
v_mfma_f32_16x16x32_bf16 v[236:239], v[40:43], a[60:63], v[236:239]
v_add_u32 v156, 36864, v156
v_mfma_f32_16x16x32_bf16 v[232:235], v[40:43], a[56:59], v[232:235]
ds_read_b64_tr_b16 v[28:29], v156 offset:0
ds_read_b64_tr_b16 v[30:31], v156 offset:4608
v_mfma_f32_16x16x32_bf16 v[240:243], v[44:47], a[56:59], v[240:243]
s_add_u32 s81, s66, 34603008
buffer_load_dword v158, v159, s[28:31], s81 offen sc1
v_add_u32 v157, 36864, v157
v_mfma_f32_16x16x32_bf16 v[244:247], v[44:47], a[60:63], v[244:247]
s_waitcnt vmcnt(24) lgkmcnt(2)
v_mov_b32 v15, s57
s_add_u32 s77, s86, 34668544
v_mfma_f32_16x16x32_bf16 v[176:179], v[16:19], a[64:67], v[176:179]
s_mov_b32 s78, s17
buffer_store_dword v15, v0, s[28:31], s77 offen sc1
ds_read_b64_tr_b16 v[32:33], v153 offset:32
ds_read_b64_tr_b16 v[34:35], v153 offset:4640
v_mfma_f32_16x16x32_bf16 v[180:183], v[16:19], a[68:71], v[180:183]
s_add_u32 m0, s62, 36864
ds_read_b64_tr_b16 v[36:37], v154 offset:32
ds_read_b64_tr_b16 v[38:39], v154 offset:4640
v_mfma_f32_16x16x32_bf16 v[188:191], v[20:23], a[68:71], v[188:191]
ds_read_b64_tr_b16 v[40:41], v155 offset:32
ds_read_b64_tr_b16 v[42:43], v155 offset:4640
v_mfma_f32_16x16x32_bf16 v[184:187], v[20:23], a[64:67], v[184:187]
ds_read_b64_tr_b16 v[44:45], v156 offset:32
ds_read_b64_tr_b16 v[46:47], v156 offset:4640
v_mfma_f32_16x16x32_bf16 v[192:195], v[24:27], a[64:67], v[192:195]
ds_read_b64_tr_b16 v[16:17], v157 offset:0
buffer_load_dwordx4 v144, s[20:23], s78 offen offset:0 lds
v_mfma_f32_16x16x32_bf16 v[196:199], v[24:27], a[68:71], v[196:199]
s_waitcnt lgkmcnt(5)
ds_read_b64_tr_b16 v[18:19], v157 offset:4608
buffer_load_dwordx4 v145, s[20:23], s78 offen offset:1024 lds
v_mfma_f32_16x16x32_bf16 v[204:207], v[28:31], a[68:71], v[204:207]
ds_read_b64_tr_b16 v[20:21], v153 offset:9216
v_mfma_f32_16x16x32_bf16 v[200:203], v[28:31], a[64:67], v[200:203]
ds_read_b64_tr_b16 v[22:23], v153 offset:13824
buffer_load_dwordx4 v146, s[20:23], s78 offen offset:2048 lds
v_mfma_f32_16x16x32_bf16 v[208:211], v[32:35], a[64:67], v[208:211]
ds_read_b64_tr_b16 v[24:25], v154 offset:9216
v_mfma_f32_16x16x32_bf16 v[212:215], v[32:35], a[68:71], v[212:215]
ds_read_b64_tr_b16 v[26:27], v154 offset:13824
v_mfma_f32_16x16x32_bf16 v[220:223], v[36:39], a[68:71], v[220:223]
ds_read_b64_tr_b16 v[28:29], v155 offset:9216
buffer_load_dwordx4 v147, s[20:23], s78 offen offset:3072 lds
v_mfma_f32_16x16x32_bf16 v[216:219], v[36:39], a[64:67], v[216:219]
s_waitcnt lgkmcnt(5)
ds_read_b64_tr_b16 v[30:31], v155 offset:13824
s_add_u32 m0, s62, 40960
v_mfma_f32_16x16x32_bf16 v[224:227], v[40:43], a[64:67], v[224:227]
ds_read_b64_tr_b16 v[32:33], v156 offset:9216
v_mfma_f32_16x16x32_bf16 v[228:231], v[40:43], a[68:71], v[228:231]
ds_read_b64_tr_b16 v[34:35], v156 offset:13824
v_mfma_f32_16x16x32_bf16 v[236:239], v[44:47], a[68:71], v[236:239]
ds_read_b64_tr_b16 v[36:37], v153 offset:9248
buffer_load_dwordx4 v148, s[20:23], s78 offen offset:0 lds
v_mfma_f32_16x16x32_bf16 v[232:235], v[44:47], a[64:67], v[232:235]
ds_read_b64_tr_b16 v[38:39], v153 offset:13856
v_mfma_f32_16x16x32_bf16 v[240:243], v[16:19], a[64:67], v[240:243]
ds_read_b64_tr_b16 v[40:41], v154 offset:9248
v_mfma_f32_16x16x32_bf16 v[244:247], v[16:19], a[68:71], v[244:247]
s_waitcnt vmcnt(28) lgkmcnt(5)
ds_read_b64_tr_b16 v[42:43], v154 offset:13856
buffer_load_dwordx4 v149, s[20:23], s78 offen offset:1024 lds
v_mfma_f32_16x16x32_bf16 v[176:179], v[20:23], a[72:75], v[176:179]
ds_read_b64_tr_b16 v[44:45], v155 offset:9248
v_mfma_f32_16x16x32_bf16 v[180:183], v[20:23], a[76:79], v[180:183]
ds_read_b64_tr_b16 v[46:47], v155 offset:13856
v_mfma_f32_16x16x32_bf16 v[188:191], v[24:27], a[76:79], v[188:191]
ds_read_b64_tr_b16 v[16:17], v156 offset:9248
v_mfma_f32_16x16x32_bf16 v[184:187], v[24:27], a[72:75], v[184:187]
ds_read_b64_tr_b16 v[18:19], v156 offset:13856
buffer_load_dwordx4 v150, s[20:23], s78 offen offset:2048 lds
v_mfma_f32_16x16x32_bf16 v[192:195], v[28:31], a[72:75], v[192:195]
ds_read_b64_tr_b16 v[20:21], v157 offset:9216
v_mfma_f32_16x16x32_bf16 v[196:199], v[28:31], a[76:79], v[196:199]
s_waitcnt lgkmcnt(5)
ds_read_b64_tr_b16 v[22:23], v157 offset:13824
v_mfma_f32_16x16x32_bf16 v[204:207], v[32:35], a[76:79], v[204:207]
ds_read_b64_tr_b16 v[24:25], v153 offset:18432
buffer_load_dwordx4 v151, s[20:23], s78 offen offset:3072 lds
v_mfma_f32_16x16x32_bf16 v[200:203], v[32:35], a[72:75], v[200:203]
s_add_u32 m0, s62, 45056
ds_read_b64_tr_b16 v[26:27], v153 offset:23040
v_mfma_f32_16x16x32_bf16 v[208:211], v[36:39], a[72:75], v[208:211]
ds_read_b64_tr_b16 v[28:29], v154 offset:18432
v_mfma_f32_16x16x32_bf16 v[212:215], v[36:39], a[76:79], v[212:215]
ds_read_b64_tr_b16 v[30:31], v154 offset:23040
v_mfma_f32_16x16x32_bf16 v[220:223], v[40:43], a[76:79], v[220:223]
ds_read_b64_tr_b16 v[32:33], v155 offset:18432
buffer_load_dwordx4 v152, s[20:23], s78 offen offset:0 lds
v_mfma_f32_16x16x32_bf16 v[216:219], v[40:43], a[72:75], v[216:219]
s_waitcnt lgkmcnt(5)
ds_read_b64_tr_b16 v[34:35], v155 offset:23040
s_add_u32 s63, s3, 0
v_mfma_f32_16x16x32_bf16 v[224:227], v[44:47], a[72:75], v[224:227]
ds_read_b64_tr_b16 v[36:37], v156 offset:18432
v_mfma_f32_16x16x32_bf16 v[228:231], v[44:47], a[76:79], v[228:231]
ds_read_b64_tr_b16 v[38:39], v156 offset:23040
v_mfma_f32_16x16x32_bf16 v[236:239], v[16:19], a[76:79], v[236:239]
ds_read_b64_tr_b16 v[40:41], v153 offset:18464
buffer_load_dwordx4 a[128:131], v12, s[28:31], s63 offen offset:0 sc1
v_mfma_f32_16x16x32_bf16 v[232:235], v[16:19], a[72:75], v[232:235]
ds_read_b64_tr_b16 v[42:43], v153 offset:23072
v_mfma_f32_16x16x32_bf16 v[240:243], v[20:23], a[72:75], v[240:243]
ds_read_b64_tr_b16 v[44:45], v154 offset:18464
v_mfma_f32_16x16x32_bf16 v[244:247], v[20:23], a[76:79], v[244:247]
s_waitcnt vmcnt(31) lgkmcnt(5)
ds_read_b64_tr_b16 v[46:47], v154 offset:23072
buffer_load_dwordx4 a[132:135], v12, s[28:31], s63 offen offset:1024 sc1
v_mfma_f32_16x16x32_bf16 v[176:179], v[24:27], a[80:83], v[176:179]
s_add_u32 s63, s3, 16384
ds_read_b64_tr_b16 v[16:17], v155 offset:18464
v_mfma_f32_16x16x32_bf16 v[180:183], v[24:27], a[84:87], v[180:183]
ds_read_b64_tr_b16 v[18:19], v155 offset:23072
v_mfma_f32_16x16x32_bf16 v[188:191], v[28:31], a[84:87], v[188:191]
ds_read_b64_tr_b16 v[20:21], v156 offset:18464
v_mfma_f32_16x16x32_bf16 v[184:187], v[28:31], a[80:83], v[184:187]
ds_read_b64_tr_b16 v[22:23], v156 offset:23072
buffer_load_dwordx4 a[136:139], v12, s[28:31], s63 offen offset:0 sc1
v_mfma_f32_16x16x32_bf16 v[192:195], v[32:35], a[80:83], v[192:195]
ds_read_b64_tr_b16 v[24:25], v157 offset:18432
v_mfma_f32_16x16x32_bf16 v[196:199], v[32:35], a[84:87], v[196:199]
s_waitcnt lgkmcnt(5)
ds_read_b64_tr_b16 v[26:27], v157 offset:23040
v_mfma_f32_16x16x32_bf16 v[204:207], v[36:39], a[84:87], v[204:207]
ds_read_b64_tr_b16 v[28:29], v153 offset:27648
buffer_load_dwordx4 a[140:143], v12, s[28:31], s63 offen offset:1024 sc1
v_mfma_f32_16x16x32_bf16 v[200:203], v[36:39], a[80:83], v[200:203]
s_add_u32 s63, s3, 65536
ds_read_b64_tr_b16 v[30:31], v153 offset:32256
v_mfma_f32_16x16x32_bf16 v[208:211], v[40:43], a[80:83], v[208:211]
ds_read_b64_tr_b16 v[32:33], v154 offset:27648
v_mfma_f32_16x16x32_bf16 v[212:215], v[40:43], a[84:87], v[212:215]
ds_read_b64_tr_b16 v[34:35], v154 offset:32256
v_mfma_f32_16x16x32_bf16 v[220:223], v[44:47], a[84:87], v[220:223]
ds_read_b64_tr_b16 v[36:37], v155 offset:27648
buffer_load_dwordx4 a[144:147], v12, s[28:31], s63 offen offset:0 sc1
v_mfma_f32_16x16x32_bf16 v[216:219], v[44:47], a[80:83], v[216:219]
s_waitcnt lgkmcnt(5)
ds_read_b64_tr_b16 v[38:39], v155 offset:32256
v_mfma_f32_16x16x32_bf16 v[224:227], v[16:19], a[80:83], v[224:227]
ds_read_b64_tr_b16 v[40:41], v156 offset:27648
v_mfma_f32_16x16x32_bf16 v[228:231], v[16:19], a[84:87], v[228:231]
ds_read_b64_tr_b16 v[42:43], v156 offset:32256
buffer_load_dwordx4 a[148:151], v12, s[28:31], s63 offen offset:1024 sc1
v_mfma_f32_16x16x32_bf16 v[236:239], v[20:23], a[84:87], v[236:239]
s_add_u32 s63, s3, 81920
ds_read_b64_tr_b16 v[44:45], v153 offset:27680
v_mfma_f32_16x16x32_bf16 v[232:235], v[20:23], a[80:83], v[232:235]
ds_read_b64_tr_b16 v[46:47], v153 offset:32288
v_mfma_f32_16x16x32_bf16 v[240:243], v[24:27], a[80:83], v[240:243]
ds_read_b64_tr_b16 v[16:17], v154 offset:27680
v_mfma_f32_16x16x32_bf16 v[244:247], v[24:27], a[84:87], v[244:247]
s_waitcnt vmcnt(34) lgkmcnt(5)
ds_read_b64_tr_b16 v[18:19], v154 offset:32288
buffer_load_dwordx4 a[152:155], v12, s[28:31], s63 offen offset:0 sc1
v_mfma_f32_16x16x32_bf16 v[176:179], v[28:31], a[88:91], v[176:179]
ds_read_b64_tr_b16 v[20:21], v155 offset:27680
v_mfma_f32_16x16x32_bf16 v[180:183], v[28:31], a[92:95], v[180:183]
ds_read_b64_tr_b16 v[22:23], v155 offset:32288
v_mfma_f32_16x16x32_bf16 v[188:191], v[32:35], a[92:95], v[188:191]
ds_read_b64_tr_b16 v[24:25], v156 offset:27680
buffer_load_dwordx4 a[156:159], v12, s[28:31], s63 offen offset:1024 sc1
v_mfma_f32_16x16x32_bf16 v[184:187], v[32:35], a[88:91], v[184:187]
ds_read_b64_tr_b16 v[26:27], v156 offset:32288
s_waitcnt vmcnt(18)
v_cmp_ne_u32 vcc, s57, v158
s_nop 1
s_cbranch_vccnz L_slow3
L_back3:
v_mfma_f32_16x16x32_bf16 v[192:195], v[36:39], a[88:91], v[192:195]
ds_read_b64_tr_b16 v[28:29], v157 offset:27648
v_lshl_add_u32 v140, s48, 6, v14
v_mfma_f32_16x16x32_bf16 v[196:199], v[36:39], a[92:95], v[196:199]
s_waitcnt lgkmcnt(5)
ds_read_b64_tr_b16 v[30:31], v157 offset:32256
v_min_u32 v140, 199, v140
v_mfma_f32_16x16x32_bf16 v[204:207], v[40:43], a[92:95], v[204:207]
v_mul_u32_u24 v141, 6554, v140
v_lshrrev_b32 v141, 16, v141
v_mfma_f32_16x16x32_bf16 v[200:203], v[40:43], a[88:91], v[200:203]
v_mul_u32_u24 v142, 10, v141
v_sub_u32 v142, v140, v142
v_mfma_f32_16x16x32_bf16 v[208:211], v[44:47], a[88:91], v[208:211]
s_waitcnt lgkmcnt(0)
v_and_b32 v7, 15, v141
v_lshrrev_b32 v141, 4, v141
v_mfma_f32_16x16x32_bf16 v[212:215], v[44:47], a[92:95], v[212:215]
s_barrier
v_add_u32 v153, 36864, v153
v_lshl_add_u32 v7, v141, 6, v7
v_mfma_f32_16x16x32_bf16 v[220:223], v[16:19], a[92:95], v[220:223]
ds_read_b64_tr_b16 v[32:33], v153 offset:0
ds_read_b64_tr_b16 v[34:35], v153 offset:4608
v_mfma_f32_16x16x32_bf16 v[216:219], v[16:19], a[88:91], v[216:219]
v_add_u32 v154, 36864, v154
v_and_b32 v141, 3, v142
v_mfma_f32_16x16x32_bf16 v[224:227], v[20:23], a[88:91], v[224:227]
ds_read_b64_tr_b16 v[36:37], v154 offset:0
ds_read_b64_tr_b16 v[38:39], v154 offset:4608
v_mfma_f32_16x16x32_bf16 v[228:231], v[20:23], a[92:95], v[228:231]
v_add_u32 v155, 36864, v155
v_lshl_add_u32 v7, v141, 4, v7
v_mfma_f32_16x16x32_bf16 v[236:239], v[24:27], a[92:95], v[236:239]
ds_read_b64_tr_b16 v[40:41], v155 offset:0
ds_read_b64_tr_b16 v[42:43], v155 offset:4608
v_mfma_f32_16x16x32_bf16 v[232:235], v[24:27], a[88:91], v[232:235]
v_add_u32 v156, 36864, v156
v_lshrrev_b32 v142, 2, v142
v_mfma_f32_16x16x32_bf16 v[240:243], v[28:31], a[88:91], v[240:243]
ds_read_b64_tr_b16 v[44:45], v156 offset:0
ds_read_b64_tr_b16 v[46:47], v156 offset:4608
v_mfma_f32_16x16x32_bf16 v[244:247], v[28:31], a[92:95], v[244:247]
s_waitcnt lgkmcnt(2)
v_add_u32 v157, 36864, v157
v_lshl_add_u32 v7, v142, 7, v7
v_mfma_f32_16x16x32_bf16 v[176:179], v[32:35], a[96:99], v[176:179]
ds_read_b64_tr_b16 v[16:17], v153 offset:32
ds_read_b64_tr_b16 v[18:19], v153 offset:4640
v_mfma_f32_16x16x32_bf16 v[180:183], v[32:35], a[100:103], v[180:183]
ds_read_b64_tr_b16 v[20:21], v154 offset:32
ds_read_b64_tr_b16 v[22:23], v154 offset:4640
v_mfma_f32_16x16x32_bf16 v[188:191], v[36:39], a[100:103], v[188:191]
ds_read_b64_tr_b16 v[24:25], v155 offset:32
ds_read_b64_tr_b16 v[26:27], v155 offset:4640
v_mfma_f32_16x16x32_bf16 v[184:187], v[36:39], a[96:99], v[184:187]
ds_read_b64_tr_b16 v[28:29], v156 offset:32
ds_read_b64_tr_b16 v[30:31], v156 offset:4640
v_mfma_f32_16x16x32_bf16 v[192:195], v[40:43], a[96:99], v[192:195]
ds_read_b64_tr_b16 v[32:33], v157 offset:0
v_lshlrev_b32 v7, 4, v7
v_mfma_f32_16x16x32_bf16 v[196:199], v[40:43], a[100:103], v[196:199]
s_waitcnt lgkmcnt(5)
ds_read_b64_tr_b16 v[34:35], v157 offset:4608
s_lshl_b32 s89, s52, 16
v_mfma_f32_16x16x32_bf16 v[204:207], v[44:47], a[100:103], v[204:207]
s_add_u32 s89, s89, 41943040
ds_read_b64_tr_b16 v[36:37], v153 offset:9216
buffer_load_dwordx4 v[112:115], v7, s[28:31], s89 offen sc1
v_mfma_f32_16x16x32_bf16 v[200:203], v[44:47], a[96:99], v[200:203]
s_add_u32 s89, s89, 8192
ds_read_b64_tr_b16 v[38:39], v153 offset:13824
buffer_load_dwordx4 v[116:119], v7, s[28:31], s89 offen sc1
v_mfma_f32_16x16x32_bf16 v[208:211], v[16:19], a[96:99], v[208:211]
s_add_u32 s89, s89, 8192
ds_read_b64_tr_b16 v[40:41], v154 offset:9216
buffer_load_dwordx4 v[120:123], v7, s[28:31], s89 offen sc1
v_mfma_f32_16x16x32_bf16 v[212:215], v[16:19], a[100:103], v[212:215]
s_add_u32 s89, s89, 8192
ds_read_b64_tr_b16 v[42:43], v154 offset:13824
buffer_load_dwordx4 v[124:127], v7, s[28:31], s89 offen sc1
v_mfma_f32_16x16x32_bf16 v[220:223], v[20:23], a[100:103], v[220:223]
s_add_u32 s89, s89, 8192
ds_read_b64_tr_b16 v[44:45], v155 offset:9216
buffer_load_dwordx4 v[160:163], v7, s[28:31], s89 offen sc1
v_mfma_f32_16x16x32_bf16 v[216:219], v[20:23], a[96:99], v[216:219]
s_waitcnt lgkmcnt(5)
ds_read_b64_tr_b16 v[46:47], v155 offset:13824
s_add_u32 s89, s89, 8192
v_mfma_f32_16x16x32_bf16 v[224:227], v[24:27], a[96:99], v[224:227]
ds_read_b64_tr_b16 v[16:17], v156 offset:9216
buffer_load_dwordx4 v[164:167], v7, s[28:31], s89 offen sc1
v_mfma_f32_16x16x32_bf16 v[228:231], v[24:27], a[100:103], v[228:231]
s_add_u32 s89, s89, 8192
ds_read_b64_tr_b16 v[18:19], v156 offset:13824
buffer_load_dwordx4 v[168:171], v7, s[28:31], s89 offen sc1
v_mfma_f32_16x16x32_bf16 v[236:239], v[28:31], a[100:103], v[236:239]
s_add_u32 s89, s89, 8192
ds_read_b64_tr_b16 v[20:21], v153 offset:9248
buffer_load_dwordx4 v[172:175], v7, s[28:31], s89 offen sc1
v_mfma_f32_16x16x32_bf16 v[232:235], v[28:31], a[96:99], v[232:235]
s_add_u32 s89, s89, 8192
ds_read_b64_tr_b16 v[22:23], v153 offset:13856
s_mov_b32 s78, s18
v_mfma_f32_16x16x32_bf16 v[240:243], v[32:35], a[96:99], v[240:243]
s_add_u32 m0, s62, 73728
ds_read_b64_tr_b16 v[24:25], v154 offset:9248
buffer_load_dwordx4 v144, s[20:23], s78 offen offset:0 lds
v_mfma_f32_16x16x32_bf16 v[244:247], v[32:35], a[100:103], v[244:247]
s_waitcnt lgkmcnt(5)
ds_read_b64_tr_b16 v[26:27], v154 offset:13856
buffer_load_dwordx4 v145, s[20:23], s78 offen offset:1024 lds
v_mfma_f32_16x16x32_bf16 v[176:179], v[36:39], a[104:107], v[176:179]
ds_read_b64_tr_b16 v[28:29], v155 offset:9248
buffer_load_dwordx4 v146, s[20:23], s78 offen offset:2048 lds
v_mfma_f32_16x16x32_bf16 v[180:183], v[36:39], a[108:111], v[180:183]
ds_read_b64_tr_b16 v[30:31], v155 offset:13856
buffer_load_dwordx4 v147, s[20:23], s78 offen offset:3072 lds
v_mfma_f32_16x16x32_bf16 v[188:191], v[40:43], a[108:111], v[188:191]
s_add_u32 m0, s62, 77824
ds_read_b64_tr_b16 v[32:33], v156 offset:9248
buffer_load_dwordx4 v148, s[20:23], s78 offen offset:0 lds
v_mfma_f32_16x16x32_bf16 v[184:187], v[40:43], a[104:107], v[184:187]
ds_read_b64_tr_b16 v[34:35], v156 offset:13856
buffer_load_dwordx4 v149, s[20:23], s78 offen offset:1024 lds
v_mfma_f32_16x16x32_bf16 v[192:195], v[44:47], a[104:107], v[192:195]
ds_read_b64_tr_b16 v[36:37], v157 offset:9216
buffer_load_dwordx4 v150, s[20:23], s78 offen offset:2048 lds
v_mfma_f32_16x16x32_bf16 v[196:199], v[44:47], a[108:111], v[196:199]
s_waitcnt lgkmcnt(5)
ds_read_b64_tr_b16 v[38:39], v157 offset:13824
v_mfma_f32_16x16x32_bf16 v[204:207], v[16:19], a[108:111], v[204:207]
ds_read_b64_tr_b16 v[40:41], v153 offset:18432
v_mfma_f32_16x16x32_bf16 v[200:203], v[16:19], a[104:107], v[200:203]
ds_read_b64_tr_b16 v[42:43], v153 offset:23040
buffer_load_dwordx4 v151, s[20:23], s78 offen offset:3072 lds
v_mfma_f32_16x16x32_bf16 v[208:211], v[20:23], a[104:107], v[208:211]
s_add_u32 m0, s62, 81920
ds_read_b64_tr_b16 v[44:45], v154 offset:18432
v_mfma_f32_16x16x32_bf16 v[212:215], v[20:23], a[108:111], v[212:215]
ds_read_b64_tr_b16 v[46:47], v154 offset:23040
v_mfma_f32_16x16x32_bf16 v[220:223], v[24:27], a[108:111], v[220:223]
ds_read_b64_tr_b16 v[16:17], v155 offset:18432
v_mfma_f32_16x16x32_bf16 v[216:219], v[24:27], a[104:107], v[216:219]
s_waitcnt lgkmcnt(5)
ds_read_b64_tr_b16 v[18:19], v155 offset:23040
buffer_load_dwordx4 v152, s[20:23], s78 offen offset:0 lds
v_mfma_f32_16x16x32_bf16 v[224:227], v[28:31], a[104:107], v[224:227]
s_add_u32 s63, s94, 0
ds_read_b64_tr_b16 v[20:21], v156 offset:18432
v_mfma_f32_16x16x32_bf16 v[228:231], v[28:31], a[108:111], v[228:231]
ds_read_b64_tr_b16 v[22:23], v156 offset:23040
v_mfma_f32_16x16x32_bf16 v[236:239], v[32:35], a[108:111], v[236:239]
ds_read_b64_tr_b16 v[24:25], v153 offset:18464
v_mfma_f32_16x16x32_bf16 v[232:235], v[32:35], a[104:107], v[232:235]
ds_read_b64_tr_b16 v[26:27], v153 offset:23072
buffer_load_dwordx4 a[160:163], v12, s[28:31], s63 offen offset:0 sc1
v_mfma_f32_16x16x32_bf16 v[240:243], v[36:39], a[104:107], v[240:243]
ds_read_b64_tr_b16 v[28:29], v154 offset:18464
v_mfma_f32_16x16x32_bf16 v[244:247], v[36:39], a[108:111], v[244:247]
s_waitcnt lgkmcnt(5)
ds_read_b64_tr_b16 v[30:31], v154 offset:23072
s_waitcnt vmcnt(16)
v_add_f32 v112, v112, v116
v_mfma_f32_16x16x32_bf16 v[176:179], v[40:43], a[112:115], v[176:179]
ds_read_b64_tr_b16 v[32:33], v155 offset:18464
buffer_load_dwordx4 a[164:167], v12, s[28:31], s63 offen offset:1024 sc1
v_mfma_f32_16x16x32_bf16 v[180:183], v[40:43], a[116:119], v[180:183]
s_add_u32 s63, s94, 16384
ds_read_b64_tr_b16 v[34:35], v155 offset:23072
v_add_f32 v113, v113, v117
v_mfma_f32_16x16x32_bf16 v[188:191], v[44:47], a[116:119], v[188:191]
ds_read_b64_tr_b16 v[36:37], v156 offset:18464
v_add_f32 v114, v114, v118
v_mfma_f32_16x16x32_bf16 v[184:187], v[44:47], a[112:115], v[184:187]
ds_read_b64_tr_b16 v[38:39], v156 offset:23072
v_add_f32 v115, v115, v119
v_mfma_f32_16x16x32_bf16 v[192:195], v[16:19], a[112:115], v[192:195]
ds_read_b64_tr_b16 v[40:41], v157 offset:18432
buffer_load_dwordx4 a[168:171], v12, s[28:31], s63 offen offset:0 sc1
v_mfma_f32_16x16x32_bf16 v[196:199], v[16:19], a[116:119], v[196:199]
s_waitcnt lgkmcnt(5)
ds_read_b64_tr_b16 v[42:43], v157 offset:23040
s_waitcnt vmcnt(17)
v_add_f32 v112, v112, v120
v_mfma_f32_16x16x32_bf16 v[204:207], v[20:23], a[116:119], v[204:207]
ds_read_b64_tr_b16 v[44:45], v153 offset:27648
v_add_f32 v113, v113, v121
v_mfma_f32_16x16x32_bf16 v[200:203], v[20:23], a[112:115], v[200:203]
ds_read_b64_tr_b16 v[46:47], v153 offset:32256
buffer_load_dwordx4 a[172:175], v12, s[28:31], s63 offen offset:1024 sc1
v_mfma_f32_16x16x32_bf16 v[208:211], v[24:27], a[112:115], v[208:211]
s_add_u32 s63, s94, 65536
ds_read_b64_tr_b16 v[16:17], v154 offset:27648
v_add_f32 v114, v114, v122
v_mfma_f32_16x16x32_bf16 v[212:215], v[24:27], a[116:119], v[212:215]
ds_read_b64_tr_b16 v[18:19], v154 offset:32256
v_add_f32 v115, v115, v123
v_mfma_f32_16x16x32_bf16 v[220:223], v[28:31], a[116:119], v[220:223]
ds_read_b64_tr_b16 v[20:21], v155 offset:27648
s_waitcnt vmcnt(17)
v_add_f32 v112, v112, v124
v_mfma_f32_16x16x32_bf16 v[216:219], v[28:31], a[112:115], v[216:219]
s_waitcnt lgkmcnt(5)
ds_read_b64_tr_b16 v[22:23], v155 offset:32256
buffer_load_dwordx4 a[176:179], v12, s[28:31], s63 offen offset:0 sc1
v_mfma_f32_16x16x32_bf16 v[224:227], v[32:35], a[112:115], v[224:227]
ds_read_b64_tr_b16 v[24:25], v156 offset:27648
v_add_f32 v113, v113, v125
v_mfma_f32_16x16x32_bf16 v[228:231], v[32:35], a[116:119], v[228:231]
ds_read_b64_tr_b16 v[26:27], v156 offset:32256
v_add_f32 v114, v114, v126
v_mfma_f32_16x16x32_bf16 v[236:239], v[36:39], a[116:119], v[236:239]
ds_read_b64_tr_b16 v[28:29], v153 offset:27680
buffer_load_dwordx4 a[180:183], v12, s[28:31], s63 offen offset:1024 sc1
v_mfma_f32_16x16x32_bf16 v[232:235], v[36:39], a[112:115], v[232:235]
s_add_u32 s63, s94, 81920
ds_read_b64_tr_b16 v[30:31], v153 offset:32288
v_add_f32 v115, v115, v127
v_mfma_f32_16x16x32_bf16 v[240:243], v[40:43], a[112:115], v[240:243]
ds_read_b64_tr_b16 v[32:33], v154 offset:27680
s_waitcnt vmcnt(18)
v_add_f32 v112, v112, v160
v_mfma_f32_16x16x32_bf16 v[244:247], v[40:43], a[116:119], v[244:247]
s_waitcnt lgkmcnt(5)
ds_read_b64_tr_b16 v[34:35], v154 offset:32288
v_add_f32 v113, v113, v161
v_mfma_f32_16x16x32_bf16 v[176:179], v[44:47], a[120:123], v[176:179]
ds_read_b64_tr_b16 v[36:37], v155 offset:27680
buffer_load_dwordx4 a[184:187], v12, s[28:31], s63 offen offset:0 sc1
v_mfma_f32_16x16x32_bf16 v[180:183], v[44:47], a[124:127], v[180:183]
ds_read_b64_tr_b16 v[38:39], v155 offset:32288
v_add_f32 v114, v114, v162
v_mfma_f32_16x16x32_bf16 v[188:191], v[16:19], a[124:127], v[188:191]
ds_read_b64_tr_b16 v[40:41], v156 offset:27680
v_add_f32 v115, v115, v163
v_mfma_f32_16x16x32_bf16 v[184:187], v[16:19], a[120:123], v[184:187]
ds_read_b64_tr_b16 v[42:43], v156 offset:32288
buffer_load_dwordx4 a[188:191], v12, s[28:31], s63 offen offset:1024 sc1
v_mfma_f32_16x16x32_bf16 v[192:195], v[20:23], a[120:123], v[192:195]
ds_read_b64_tr_b16 v[44:45], v157 offset:27648
s_waitcnt vmcnt(19)
v_add_f32 v112, v112, v164
v_mfma_f32_16x16x32_bf16 v[196:199], v[20:23], a[124:127], v[196:199]
s_waitcnt lgkmcnt(5)
ds_read_b64_tr_b16 v[46:47], v157 offset:32256
v_add_f32 v113, v113, v165
v_mfma_f32_16x16x32_bf16 v[204:207], v[24:27], a[124:127], v[204:207]
v_add_f32 v114, v114, v166
v_add_f32 v115, v115, v167
v_mfma_f32_16x16x32_bf16 v[200:203], v[24:27], a[120:123], v[200:203]
s_waitcnt vmcnt(18)
v_add_f32 v112, v112, v168
v_add_f32 v113, v113, v169
v_mfma_f32_16x16x32_bf16 v[208:211], v[28:31], a[120:123], v[208:211]
v_add_f32 v114, v114, v170
v_add_f32 v115, v115, v171
s_waitcnt vmcnt(17)
v_add_f32 v112, v112, v172
v_add_f32 v113, v113, v173
v_add_f32 v114, v114, v174
v_add_f32 v115, v115, v175
v_cvt_pk_bf16_f32 v112, v112, v113
v_cvt_pk_bf16_f32 v113, v114, v115
v_lshlrev_b32 v140, 3, v140
v_add_u32 v140, 147456, v140
ds_write_b64 v140, v[112:113]
s_waitcnt lgkmcnt(0)
s_barrier
v_add_u32 v153, 4294856704, v153
v_mfma_f32_16x16x32_bf16 v[212:215], v[28:31], a[124:127], v[212:215]
ds_read_b64_tr_b16 v[16:17], v153 offset:0
ds_read_b64_tr_b16 v[18:19], v153 offset:4608
v_mfma_f32_16x16x32_bf16 v[220:223], v[32:35], a[124:127], v[220:223]
s_mov_b32 s78, s19
v_add_u32 v154, 4294856704, v154
v_mov_b32 v118, 0
v_mfma_f32_16x16x32_bf16 v[216:219], v[32:35], a[120:123], v[216:219]
s_add_u32 m0, s62, 110592
ds_read_b64_tr_b16 v[20:21], v154 offset:0
ds_read_b64_tr_b16 v[22:23], v154 offset:4608
v_mfma_f32_16x16x32_bf16 v[224:227], v[36:39], a[120:123], v[224:227]
v_add_u32 v155, 4294856704, v155
v_mov_b32 v119, 0
v_mfma_f32_16x16x32_bf16 v[228:231], v[36:39], a[124:127], v[228:231]
ds_read_b64_tr_b16 v[24:25], v155 offset:0
ds_read_b64_tr_b16 v[26:27], v155 offset:4608
v_mfma_f32_16x16x32_bf16 v[236:239], v[40:43], a[124:127], v[236:239]
ds_read_b64 v[96:97], v5 offset:0
ds_read_b64 v[98:99], v5 offset:8
v_mfma_f32_16x16x32_bf16 v[232:235], v[40:43], a[120:123], v[232:235]
v_add_u32 v156, 4294856704, v156
v_mfma_f32_16x16x32_bf16 v[240:243], v[44:47], a[120:123], v[240:243]
ds_read_b64_tr_b16 v[28:29], v156 offset:0
ds_read_b64_tr_b16 v[30:31], v156 offset:4608
v_mfma_f32_16x16x32_bf16 v[244:247], v[44:47], a[124:127], v[244:247]
s_waitcnt lgkmcnt(4)
ds_read_b64 v[100:101], v5 offset:16
ds_read_b64 v[102:103], v5 offset:24
v_mfma_f32_16x16x32_bf16 v[176:179], v[16:19], a[128:131], v[176:179]
buffer_load_dwordx4 v144, s[20:23], s78 offen offset:0 lds
v_add_u32 v157, 4294856704, v157
v_mfma_f32_16x16x32_bf16 v[180:183], v[16:19], a[132:135], v[180:183]
ds_read_b64_tr_b16 v[32:33], v153 offset:32
ds_read_b64_tr_b16 v[34:35], v153 offset:4640
v_mfma_f32_16x16x32_bf16 v[188:191], v[20:23], a[132:135], v[188:191]
ds_read_b64 v[104:105], v5 offset:32
ds_read_b64 v[108:109], v6 offset:0
v_mfma_f32_16x16x32_bf16 v[184:187], v[20:23], a[128:131], v[184:187]
ds_read_b64_tr_b16 v[36:37], v154 offset:32
ds_read_b64_tr_b16 v[38:39], v154 offset:4640
v_mfma_f32_16x16x32_bf16 v[192:195], v[24:27], a[128:131], v[192:195]
ds_read_b64 v[110:111], v6 offset:8
ds_read_b64 v[112:113], v6 offset:16
v_mfma_f32_16x16x32_bf16 v[196:199], v[24:27], a[132:135], v[196:199]
s_waitcnt lgkmcnt(2)
ds_read_b64_tr_b16 v[40:41], v155 offset:32
ds_read_b64_tr_b16 v[42:43], v155 offset:4640
v_mfma_f32_16x16x32_bf16 v[204:207], v[28:31], a[132:135], v[204:207]
ds_read_b64 v[114:115], v6 offset:24
ds_read_b64 v[116:117], v6 offset:32
v_mfma_f32_16x16x32_bf16 v[200:203], v[28:31], a[128:131], v[200:203]
ds_read_b64_tr_b16 v[44:45], v156 offset:32
ds_read_b64_tr_b16 v[46:47], v156 offset:4640
v_mfma_f32_16x16x32_bf16 v[208:211], v[32:35], a[128:131], v[208:211]
ds_read_b32 v1, v8 offset:0
ds_read_b32 v2, v8 offset:64
v_mfma_f32_16x16x32_bf16 v[212:215], v[32:35], a[132:135], v[212:215]
ds_read_b64_tr_b16 v[16:17], v157 offset:0
ds_read_b64_tr_b16 v[18:19], v157 offset:4608
v_mfma_f32_16x16x32_bf16 v[220:223], v[36:39], a[132:135], v[220:223]
ds_read_b32 v3, v8 offset:128
buffer_load_dwordx4 v145, s[20:23], s78 offen offset:1024 lds
v_mfma_f32_16x16x32_bf16 v[216:219], v[36:39], a[128:131], v[216:219]
s_waitcnt lgkmcnt(5)
ds_read_b32 v4, v8 offset:192
buffer_load_dwordx4 v146, s[20:23], s78 offen offset:2048 lds
v_mfma_f32_16x16x32_bf16 v[224:227], v[40:43], a[128:131], v[224:227]
buffer_load_dwordx4 v147, s[20:23], s78 offen offset:3072 lds
s_add_u32 m0, s62, 114688
v_mfma_f32_16x16x32_bf16 v[228:231], v[40:43], a[132:135], v[228:231]
v_mfma_f32_16x16x32_bf16 v[236:239], v[44:47], a[132:135], v[236:239]
buffer_load_dwordx4 v148, s[20:23], s78 offen offset:0 lds
v_mfma_f32_16x16x32_bf16 v[232:235], v[44:47], a[128:131], v[232:235]
s_waitcnt lgkmcnt(2)
v_mfma_f32_16x16x32_bf16 v[240:243], v[16:19], a[128:131], v[240:243]
v_mfma_f32_16x16x32_bf16 v[244:247], v[16:19], a[132:135], v[244:247]
buffer_load_dwordx4 v149, s[20:23], s78 offen offset:1024 lds
v_mfma_f32_16x16x32_bf16 v[120:123], v[96:99], v[48:51], 0
ds_read_b64_tr_b16 v[44:45], v153 offset:9216
v_mfma_f32_16x16x32_bf16 v[124:127], v[108:111], v[48:51], 0
ds_read_b64_tr_b16 v[46:47], v153 offset:13824
v_mfma_f32_16x16x32_bf16 v[248:251], v[96:99], v[58:61], 0
ds_read_b64_tr_b16 v[16:17], v154 offset:9216
v_mfma_f32_16x16x32_bf16 v[252:255], v[108:111], v[58:61], 0
ds_read_b64_tr_b16 v[18:19], v154 offset:13824
buffer_load_dwordx4 v150, s[20:23], s78 offen offset:2048 lds
v_mfma_f32_16x16x32_bf16 v[120:123], v[100:103], v[52:55], v[120:123]
ds_read_b64_tr_b16 v[20:21], v155 offset:9216
v_mfma_f32_16x16x32_bf16 v[124:127], v[112:115], v[52:55], v[124:127]
ds_read_b64_tr_b16 v[22:23], v155 offset:13824
v_mfma_f32_16x16x32_bf16 v[248:251], v[100:103], v[62:65], v[248:251]
ds_read_b64_tr_b16 v[24:25], v156 offset:9216
buffer_load_dwordx4 v151, s[20:23], s78 offen offset:3072 lds
v_mfma_f32_16x16x32_bf16 v[252:255], v[112:115], v[62:65], v[252:255]
s_add_u32 m0, s62, 118784
ds_read_b64_tr_b16 v[26:27], v156 offset:13824
v_mfma_f32_16x16x32_bf16 v[120:123], v[104:107], v[56:59], v[120:123]
ds_read_b64_tr_b16 v[28:29], v153 offset:9248
v_mfma_f32_16x16x32_bf16 v[124:127], v[116:119], v[56:59], v[124:127]
ds_read_b64_tr_b16 v[30:31], v153 offset:13856
v_mfma_f32_16x16x32_bf16 v[248:251], v[104:107], v[66:69], v[248:251]
ds_read_b64_tr_b16 v[32:33], v154 offset:9248
buffer_load_dwordx4 v152, s[20:23], s78 offen offset:0 lds
v_mfma_f32_16x16x32_bf16 v[252:255], v[116:119], v[66:69], v[252:255]
s_waitcnt lgkmcnt(5)
ds_read_b64_tr_b16 v[34:35], v154 offset:13856
s_add_u32 s63, s95, 0
v_mfma_f32_16x16x32_bf16 v[176:179], v[44:47], a[136:139], v[176:179]
ds_read_b64_tr_b16 v[36:37], v155 offset:9248
v_mfma_f32_16x16x32_bf16 v[180:183], v[44:47], a[140:143], v[180:183]
ds_read_b64_tr_b16 v[38:39], v155 offset:13856
v_mfma_f32_16x16x32_bf16 v[188:191], v[16:19], a[140:143], v[188:191]
ds_read_b64_tr_b16 v[40:41], v156 offset:9248
buffer_load_dwordx4 a[192:195], v12, s[28:31], s63 offen offset:0 sc1
v_mfma_f32_16x16x32_bf16 v[184:187], v[16:19], a[136:139], v[184:187]
ds_read_b64_tr_b16 v[42:43], v156 offset:13856
v_add_f32 v124, 0x358637bd, v124
v_mfma_f32_16x16x32_bf16 v[192:195], v[20:23], a[136:139], v[192:195]
ds_read_b64_tr_b16 v[44:45], v157 offset:9216
v_add_f32 v252, 0x358637bd, v252
v_mfma_f32_16x16x32_bf16 v[196:199], v[20:23], a[140:143], v[196:199]
s_waitcnt lgkmcnt(5)
ds_read_b64_tr_b16 v[46:47], v157 offset:13824
buffer_load_dwordx4 a[196:199], v12, s[28:31], s63 offen offset:1024 sc1
v_mfma_f32_16x16x32_bf16 v[204:207], v[24:27], a[140:143], v[204:207]
s_add_u32 s63, s95, 16384
ds_read_b64_tr_b16 v[16:17], v153 offset:18432
v_rcp_f32 v124, v124
v_mfma_f32_16x16x32_bf16 v[200:203], v[24:27], a[136:139], v[200:203]
ds_read_b64_tr_b16 v[18:19], v153 offset:23040
v_rcp_f32 v252, v252
v_mfma_f32_16x16x32_bf16 v[208:211], v[28:31], a[136:139], v[208:211]
ds_read_b64_tr_b16 v[20:21], v154 offset:18432
v_mul_f32 v124, v124, v1
v_mfma_f32_16x16x32_bf16 v[212:215], v[28:31], a[140:143], v[212:215]
ds_read_b64_tr_b16 v[22:23], v154 offset:23040
buffer_load_dwordx4 a[200:203], v12, s[28:31], s63 offen offset:0 sc1
v_mfma_f32_16x16x32_bf16 v[220:223], v[32:35], a[140:143], v[220:223]
ds_read_b64_tr_b16 v[24:25], v155 offset:18432
v_mul_f32 v252, v252, v2
v_mfma_f32_16x16x32_bf16 v[216:219], v[32:35], a[136:139], v[216:219]
s_waitcnt lgkmcnt(5)
ds_read_b64_tr_b16 v[26:27], v155 offset:23040
v_mul_f32 v120, v120, v124
v_mfma_f32_16x16x32_bf16 v[224:227], v[36:39], a[136:139], v[224:227]
ds_read_b64_tr_b16 v[28:29], v156 offset:18432
buffer_load_dwordx4 a[204:207], v12, s[28:31], s63 offen offset:1024 sc1
v_mfma_f32_16x16x32_bf16 v[228:231], v[36:39], a[140:143], v[228:231]
s_add_u32 s63, s95, 65536
ds_read_b64_tr_b16 v[30:31], v156 offset:23040
v_mul_f32 v121, v121, v124
v_mfma_f32_16x16x32_bf16 v[236:239], v[40:43], a[140:143], v[236:239]
ds_read_b64_tr_b16 v[32:33], v153 offset:18464
v_mul_f32 v122, v122, v124
v_mfma_f32_16x16x32_bf16 v[232:235], v[40:43], a[136:139], v[232:235]
ds_read_b64_tr_b16 v[34:35], v153 offset:23072
v_mul_f32 v123, v123, v124
v_mfma_f32_16x16x32_bf16 v[240:243], v[44:47], a[136:139], v[240:243]
ds_read_b64_tr_b16 v[36:37], v154 offset:18464
buffer_load_dwordx4 a[208:211], v12, s[28:31], s63 offen offset:0 sc1
v_mfma_f32_16x16x32_bf16 v[244:247], v[44:47], a[140:143], v[244:247]
s_waitcnt lgkmcnt(5)
ds_read_b64_tr_b16 v[38:39], v154 offset:23072
v_mul_f32 v125, v125, v124
v_mfma_f32_16x16x32_bf16 v[176:179], v[16:19], a[144:147], v[176:179]
ds_read_b64_tr_b16 v[40:41], v155 offset:18464
v_mul_f32 v126, v126, v124
v_mfma_f32_16x16x32_bf16 v[180:183], v[16:19], a[148:151], v[180:183]
ds_read_b64_tr_b16 v[42:43], v155 offset:23072
buffer_load_dwordx4 a[212:215], v12, s[28:31], s63 offen offset:1024 sc1
v_mfma_f32_16x16x32_bf16 v[188:191], v[20:23], a[148:151], v[188:191]
s_add_u32 s63, s95, 81920
ds_read_b64_tr_b16 v[44:45], v156 offset:18464
v_cvt_pk_bf16_f32 v160, v120, v121
v_mfma_f32_16x16x32_bf16 v[184:187], v[20:23], a[144:147], v[184:187]
ds_read_b64_tr_b16 v[46:47], v156 offset:23072
v_cvt_pk_bf16_f32 v161, v122, v123
v_mfma_f32_16x16x32_bf16 v[192:195], v[24:27], a[144:147], v[192:195]
ds_read_b64_tr_b16 v[16:17], v157 offset:18432
v_cvt_pk_bf16_f32 v164, v125, v126
v_mfma_f32_16x16x32_bf16 v[196:199], v[24:27], a[148:151], v[196:199]
s_waitcnt lgkmcnt(5)
ds_read_b64_tr_b16 v[18:19], v157 offset:23040
buffer_load_dwordx4 a[216:219], v12, s[28:31], s63 offen offset:0 sc1
v_mfma_f32_16x16x32_bf16 v[204:207], v[28:31], a[148:151], v[204:207]
v_mov_b32 v165, 0
v_mul_f32 v248, v248, v252
v_mfma_f32_16x16x32_bf16 v[200:203], v[28:31], a[144:147], v[200:203]
v_mul_f32 v249, v249, v252
v_mul_f32 v250, v250, v252
v_mfma_f32_16x16x32_bf16 v[208:211], v[32:35], a[144:147], v[208:211]
buffer_load_dwordx4 a[220:223], v12, s[28:31], s63 offen offset:1024 sc1
v_mul_f32 v251, v251, v252
v_mfma_f32_16x16x32_bf16 v[212:215], v[32:35], a[148:151], v[212:215]
v_mul_f32 v253, v253, v252
v_mul_f32 v254, v254, v252
v_mfma_f32_16x16x32_bf16 v[220:223], v[36:39], a[148:151], v[220:223]
v_cvt_pk_bf16_f32 v162, v248, v249
v_cvt_pk_bf16_f32 v163, v250, v251
v_mfma_f32_16x16x32_bf16 v[216:219], v[36:39], a[144:147], v[216:219]
s_waitcnt lgkmcnt(0)
v_cvt_pk_bf16_f32 v166, v253, v254
v_mov_b32 v167, 0
v_mfma_f32_16x16x32_bf16 v[224:227], v[40:43], a[144:147], v[224:227]
v_mfma_f32_16x16x32_bf16 v[228:231], v[40:43], a[148:151], v[228:231]
v_mfma_f32_16x16x32_bf16 v[236:239], v[44:47], a[148:151], v[236:239]
v_mfma_f32_16x16x32_bf16 v[232:235], v[44:47], a[144:147], v[232:235]
v_mfma_f32_16x16x32_bf16 v[240:243], v[16:19], a[144:147], v[240:243]
v_mfma_f32_16x16x32_bf16 v[244:247], v[16:19], a[148:151], v[244:247]
v_mfma_f32_16x16x32_bf16 v[120:123], v[96:99], v[68:71], 0
ds_read_b64_tr_b16 v[44:45], v153 offset:27648
v_mfma_f32_16x16x32_bf16 v[124:127], v[108:111], v[68:71], 0
ds_read_b64_tr_b16 v[46:47], v153 offset:32256
v_mfma_f32_16x16x32_bf16 v[248:251], v[96:99], v[128:131], 0
ds_read_b64_tr_b16 v[16:17], v154 offset:27648
v_mfma_f32_16x16x32_bf16 v[252:255], v[108:111], v[128:131], 0
ds_read_b64_tr_b16 v[18:19], v154 offset:32256
v_mfma_f32_16x16x32_bf16 v[120:123], v[100:103], v[72:75], v[120:123]
ds_read_b64_tr_b16 v[20:21], v155 offset:27648
v_mfma_f32_16x16x32_bf16 v[124:127], v[112:115], v[72:75], v[124:127]
ds_read_b64_tr_b16 v[22:23], v155 offset:32256
v_mfma_f32_16x16x32_bf16 v[248:251], v[100:103], v[132:135], v[248:251]
ds_read_b64_tr_b16 v[24:25], v156 offset:27648
v_mfma_f32_16x16x32_bf16 v[252:255], v[112:115], v[132:135], v[252:255]
ds_read_b64_tr_b16 v[26:27], v156 offset:32256
v_mfma_f32_16x16x32_bf16 v[120:123], v[104:107], v[76:79], v[120:123]
ds_read_b64_tr_b16 v[28:29], v153 offset:27680
v_mfma_f32_16x16x32_bf16 v[124:127], v[116:119], v[76:79], v[124:127]
ds_read_b64_tr_b16 v[30:31], v153 offset:32288
v_mfma_f32_16x16x32_bf16 v[248:251], v[104:107], v[136:139], v[248:251]
ds_read_b64_tr_b16 v[32:33], v154 offset:27680
v_mfma_f32_16x16x32_bf16 v[252:255], v[116:119], v[136:139], v[252:255]
s_waitcnt lgkmcnt(5)
ds_read_b64_tr_b16 v[34:35], v154 offset:32288
v_mfma_f32_16x16x32_bf16 v[176:179], v[44:47], a[152:155], v[176:179]
ds_read_b64_tr_b16 v[36:37], v155 offset:27680
v_mfma_f32_16x16x32_bf16 v[180:183], v[44:47], a[156:159], v[180:183]
ds_read_b64_tr_b16 v[38:39], v155 offset:32288
v_mfma_f32_16x16x32_bf16 v[188:191], v[16:19], a[156:159], v[188:191]
ds_read_b64_tr_b16 v[40:41], v156 offset:27680
v_mfma_f32_16x16x32_bf16 v[184:187], v[16:19], a[152:155], v[184:187]
ds_read_b64_tr_b16 v[42:43], v156 offset:32288
v_add_f32 v124, 0x358637bd, v124
v_mfma_f32_16x16x32_bf16 v[192:195], v[20:23], a[152:155], v[192:195]
ds_read_b64_tr_b16 v[44:45], v157 offset:27648
v_add_f32 v252, 0x358637bd, v252
v_mfma_f32_16x16x32_bf16 v[196:199], v[20:23], a[156:159], v[196:199]
s_waitcnt lgkmcnt(5)
ds_read_b64_tr_b16 v[46:47], v157 offset:32256
v_rcp_f32 v124, v124
v_mfma_f32_16x16x32_bf16 v[204:207], v[24:27], a[156:159], v[204:207]
v_rcp_f32 v252, v252
v_mul_f32 v124, v124, v3
v_mfma_f32_16x16x32_bf16 v[200:203], v[24:27], a[152:155], v[200:203]
v_mul_f32 v252, v252, v4
v_mul_f32 v120, v120, v124
v_mfma_f32_16x16x32_bf16 v[208:211], v[28:31], a[152:155], v[208:211]
s_waitcnt lgkmcnt(0)
v_mul_f32 v121, v121, v124
v_mul_f32 v122, v122, v124
v_mfma_f32_16x16x32_bf16 v[212:215], v[28:31], a[156:159], v[212:215]
s_barrier
v_add_u32 v153, 36864, v153
v_mul_f32 v123, v123, v124
v_mfma_f32_16x16x32_bf16 v[220:223], v[32:35], a[156:159], v[220:223]
ds_read_b64_tr_b16 v[16:17], v153 offset:0
ds_read_b64_tr_b16 v[18:19], v153 offset:4608
v_mfma_f32_16x16x32_bf16 v[216:219], v[32:35], a[152:155], v[216:219]
s_add_u32 s78, s83, 589824
v_add_u32 v154, 36864, v154
v_mul_f32 v125, v125, v124
v_mfma_f32_16x16x32_bf16 v[224:227], v[36:39], a[152:155], v[224:227]
s_add_u32 m0, s62, 0
ds_read_b64_tr_b16 v[20:21], v154 offset:0
ds_read_b64_tr_b16 v[22:23], v154 offset:4608
v_mfma_f32_16x16x32_bf16 v[228:231], v[36:39], a[156:159], v[228:231]
v_add_u32 v155, 36864, v155
v_mul_f32 v126, v126, v124
v_mfma_f32_16x16x32_bf16 v[236:239], v[40:43], a[156:159], v[236:239]
ds_read_b64_tr_b16 v[24:25], v155 offset:0
ds_read_b64_tr_b16 v[26:27], v155 offset:4608
v_mfma_f32_16x16x32_bf16 v[232:235], v[40:43], a[152:155], v[232:235]
v_add_u32 v156, 36864, v156
v_cvt_pk_bf16_f32 v168, v120, v121
v_mfma_f32_16x16x32_bf16 v[240:243], v[44:47], a[152:155], v[240:243]
ds_read_b64_tr_b16 v[28:29], v156 offset:0
ds_read_b64_tr_b16 v[30:31], v156 offset:4608
v_mfma_f32_16x16x32_bf16 v[244:247], v[44:47], a[156:159], v[244:247]
s_waitcnt vmcnt(23) lgkmcnt(2)
v_add_u32 v157, 36864, v157
v_cvt_pk_bf16_f32 v169, v122, v123
v_mfma_f32_16x16x32_bf16 v[176:179], v[16:19], a[160:163], v[176:179]
ds_read_b64_tr_b16 v[32:33], v153 offset:32
ds_read_b64_tr_b16 v[34:35], v153 offset:4640
v_mfma_f32_16x16x32_bf16 v[180:183], v[16:19], a[164:167], v[180:183]
ds_read_b64_tr_b16 v[36:37], v154 offset:32
ds_read_b64_tr_b16 v[38:39], v154 offset:4640
v_mfma_f32_16x16x32_bf16 v[188:191], v[20:23], a[164:167], v[188:191]
ds_read_b64_tr_b16 v[40:41], v155 offset:32
ds_read_b64_tr_b16 v[42:43], v155 offset:4640
v_mfma_f32_16x16x32_bf16 v[184:187], v[20:23], a[160:163], v[184:187]
ds_read_b64_tr_b16 v[44:45], v156 offset:32
ds_read_b64_tr_b16 v[46:47], v156 offset:4640
v_mfma_f32_16x16x32_bf16 v[192:195], v[24:27], a[160:163], v[192:195]
ds_read_b64_tr_b16 v[16:17], v157 offset:0
buffer_load_dwordx4 v144, s[20:23], s78 offen offset:0 lds
v_mfma_f32_16x16x32_bf16 v[196:199], v[24:27], a[164:167], v[196:199]
s_waitcnt lgkmcnt(5)
ds_read_b64_tr_b16 v[18:19], v157 offset:4608
buffer_load_dwordx4 v145, s[20:23], s78 offen offset:1024 lds
v_mfma_f32_16x16x32_bf16 v[204:207], v[28:31], a[164:167], v[204:207]
ds_read_b64_tr_b16 v[20:21], v153 offset:9216
v_cvt_pk_bf16_f32 v172, v125, v126
v_mfma_f32_16x16x32_bf16 v[200:203], v[28:31], a[160:163], v[200:203]
ds_read_b64_tr_b16 v[22:23], v153 offset:13824
v_mov_b32 v173, 0
v_mfma_f32_16x16x32_bf16 v[208:211], v[32:35], a[160:163], v[208:211]
ds_read_b64_tr_b16 v[24:25], v154 offset:9216
buffer_load_dwordx4 v146, s[20:23], s78 offen offset:2048 lds
v_mfma_f32_16x16x32_bf16 v[212:215], v[32:35], a[164:167], v[212:215]
ds_read_b64_tr_b16 v[26:27], v154 offset:13824
v_mul_f32 v248, v248, v252
v_mfma_f32_16x16x32_bf16 v[220:223], v[36:39], a[164:167], v[220:223]
ds_read_b64_tr_b16 v[28:29], v155 offset:9216
v_mul_f32 v249, v249, v252
v_mfma_f32_16x16x32_bf16 v[216:219], v[36:39], a[160:163], v[216:219]
s_waitcnt lgkmcnt(5)
ds_read_b64_tr_b16 v[30:31], v155 offset:13824
buffer_load_dwordx4 v147, s[20:23], s78 offen offset:3072 lds
v_mfma_f32_16x16x32_bf16 v[224:227], v[40:43], a[160:163], v[224:227]
s_add_u32 m0, s62, 4096
ds_read_b64_tr_b16 v[32:33], v156 offset:9216
v_mul_f32 v250, v250, v252
v_mfma_f32_16x16x32_bf16 v[228:231], v[40:43], a[164:167], v[228:231]
ds_read_b64_tr_b16 v[34:35], v156 offset:13824
v_mul_f32 v251, v251, v252
v_mfma_f32_16x16x32_bf16 v[236:239], v[44:47], a[164:167], v[236:239]
ds_read_b64_tr_b16 v[36:37], v153 offset:9248
v_mul_f32 v253, v253, v252
v_mfma_f32_16x16x32_bf16 v[232:235], v[44:47], a[160:163], v[232:235]
ds_read_b64_tr_b16 v[38:39], v153 offset:13856
buffer_load_dwordx4 v148, s[20:23], s78 offen offset:0 lds
v_mfma_f32_16x16x32_bf16 v[240:243], v[16:19], a[160:163], v[240:243]
ds_read_b64_tr_b16 v[40:41], v154 offset:9248
v_mul_f32 v254, v254, v252
v_mfma_f32_16x16x32_bf16 v[244:247], v[16:19], a[164:167], v[244:247]
s_waitcnt vmcnt(26) lgkmcnt(5)
ds_read_b64_tr_b16 v[42:43], v154 offset:13856
v_cvt_pk_bf16_f32 v170, v248, v249
v_mfma_f32_16x16x32_bf16 v[176:179], v[20:23], a[168:171], v[176:179]
ds_read_b64_tr_b16 v[44:45], v155 offset:9248
buffer_load_dwordx4 v149, s[20:23], s78 offen offset:1024 lds
v_mfma_f32_16x16x32_bf16 v[180:183], v[20:23], a[172:175], v[180:183]
ds_read_b64_tr_b16 v[46:47], v155 offset:13856
v_cvt_pk_bf16_f32 v171, v250, v251
v_mfma_f32_16x16x32_bf16 v[188:191], v[24:27], a[172:175], v[188:191]
ds_read_b64_tr_b16 v[16:17], v156 offset:9248
v_cvt_pk_bf16_f32 v174, v253, v254
v_mfma_f32_16x16x32_bf16 v[184:187], v[24:27], a[168:171], v[184:187]
ds_read_b64_tr_b16 v[18:19], v156 offset:13856
v_mov_b32 v175, 0
v_mfma_f32_16x16x32_bf16 v[192:195], v[28:31], a[168:171], v[192:195]
ds_read_b64_tr_b16 v[20:21], v157 offset:9216
buffer_load_dwordx4 v150, s[20:23], s78 offen offset:2048 lds
v_mfma_f32_16x16x32_bf16 v[196:199], v[28:31], a[172:175], v[196:199]
s_waitcnt lgkmcnt(5)
ds_read_b64_tr_b16 v[22:23], v157 offset:13824
buffer_store_dwordx4 v[160:163], v12, s[28:31], s69 offen offset:0 sc1
v_mfma_f32_16x16x32_bf16 v[204:207], v[32:35], a[172:175], v[204:207]
ds_read_b64_tr_b16 v[24:25], v153 offset:18432
buffer_store_dwordx4 v[164:167], v11, s[28:31], s70 offen offset:0 sc1
v_mfma_f32_16x16x32_bf16 v[200:203], v[32:35], a[168:171], v[200:203]
ds_read_b64_tr_b16 v[26:27], v153 offset:23040
buffer_load_dwordx4 v151, s[20:23], s78 offen offset:3072 lds
v_mfma_f32_16x16x32_bf16 v[208:211], v[36:39], a[168:171], v[208:211]
s_add_u32 m0, s62, 8192
ds_read_b64_tr_b16 v[28:29], v154 offset:18432
buffer_store_dwordx4 v[168:171], v12, s[28:31], s69 offen offset:2048 sc1
v_mfma_f32_16x16x32_bf16 v[212:215], v[36:39], a[172:175], v[212:215]
ds_read_b64_tr_b16 v[30:31], v154 offset:23040
buffer_store_dwordx4 v[172:175], v11, s[28:31], s70 offen offset:2048 sc1
v_mfma_f32_16x16x32_bf16 v[220:223], v[40:43], a[172:175], v[220:223]
ds_read_b64_tr_b16 v[32:33], v155 offset:18432
v_mfma_f32_16x16x32_bf16 v[216:219], v[40:43], a[168:171], v[216:219]
s_waitcnt lgkmcnt(5)
ds_read_b64_tr_b16 v[34:35], v155 offset:23040
buffer_load_dwordx4 v152, s[20:23], s78 offen offset:0 lds
v_mfma_f32_16x16x32_bf16 v[224:227], v[44:47], a[168:171], v[224:227]
s_add_u32 s63, s61, 0
ds_read_b64_tr_b16 v[36:37], v156 offset:18432
v_mfma_f32_16x16x32_bf16 v[228:231], v[44:47], a[172:175], v[228:231]
ds_read_b64_tr_b16 v[38:39], v156 offset:23040
v_mfma_f32_16x16x32_bf16 v[236:239], v[16:19], a[172:175], v[236:239]
ds_read_b64_tr_b16 v[40:41], v153 offset:18464
v_mfma_f32_16x16x32_bf16 v[232:235], v[16:19], a[168:171], v[232:235]
ds_read_b64_tr_b16 v[42:43], v153 offset:23072
buffer_load_dwordx4 a[224:227], v12, s[28:31], s63 offen offset:0 sc1
v_mfma_f32_16x16x32_bf16 v[240:243], v[20:23], a[168:171], v[240:243]
ds_read_b64_tr_b16 v[44:45], v154 offset:18464
v_mfma_f32_16x16x32_bf16 v[244:247], v[20:23], a[172:175], v[244:247]
s_waitcnt vmcnt(33) lgkmcnt(5)
ds_read_b64_tr_b16 v[46:47], v154 offset:23072
v_mfma_f32_16x16x32_bf16 v[176:179], v[24:27], a[176:179], v[176:179]
ds_read_b64_tr_b16 v[16:17], v155 offset:18464
buffer_load_dwordx4 a[228:231], v12, s[28:31], s63 offen offset:1024 sc1
v_mfma_f32_16x16x32_bf16 v[180:183], v[24:27], a[180:183], v[180:183]
s_add_u32 s63, s61, 16384
ds_read_b64_tr_b16 v[18:19], v155 offset:23072
v_mfma_f32_16x16x32_bf16 v[188:191], v[28:31], a[180:183], v[188:191]
ds_read_b64_tr_b16 v[20:21], v156 offset:18464
v_mfma_f32_16x16x32_bf16 v[184:187], v[28:31], a[176:179], v[184:187]
ds_read_b64_tr_b16 v[22:23], v156 offset:23072
v_mfma_f32_16x16x32_bf16 v[192:195], v[32:35], a[176:179], v[192:195]
ds_read_b64_tr_b16 v[24:25], v157 offset:18432
buffer_load_dwordx4 a[232:235], v12, s[28:31], s63 offen offset:0 sc1
v_mfma_f32_16x16x32_bf16 v[196:199], v[32:35], a[180:183], v[196:199]
s_waitcnt lgkmcnt(5)
ds_read_b64_tr_b16 v[26:27], v157 offset:23040
v_mfma_f32_16x16x32_bf16 v[204:207], v[36:39], a[180:183], v[204:207]
ds_read_b64_tr_b16 v[28:29], v153 offset:27648
v_mfma_f32_16x16x32_bf16 v[200:203], v[36:39], a[176:179], v[200:203]
ds_read_b64_tr_b16 v[30:31], v153 offset:32256
buffer_load_dwordx4 a[236:239], v12, s[28:31], s63 offen offset:1024 sc1
v_mfma_f32_16x16x32_bf16 v[208:211], v[40:43], a[176:179], v[208:211]
s_add_u32 s63, s61, 65536
ds_read_b64_tr_b16 v[32:33], v154 offset:27648
v_mfma_f32_16x16x32_bf16 v[212:215], v[40:43], a[180:183], v[212:215]
ds_read_b64_tr_b16 v[34:35], v154 offset:32256
v_mfma_f32_16x16x32_bf16 v[220:223], v[44:47], a[180:183], v[220:223]
ds_read_b64_tr_b16 v[36:37], v155 offset:27648
v_mfma_f32_16x16x32_bf16 v[216:219], v[44:47], a[176:179], v[216:219]
s_waitcnt lgkmcnt(5)
ds_read_b64_tr_b16 v[38:39], v155 offset:32256
buffer_load_dwordx4 a[240:243], v12, s[28:31], s63 offen offset:0 sc1
v_mfma_f32_16x16x32_bf16 v[224:227], v[16:19], a[176:179], v[224:227]
ds_read_b64_tr_b16 v[40:41], v156 offset:27648
v_mfma_f32_16x16x32_bf16 v[228:231], v[16:19], a[180:183], v[228:231]
ds_read_b64_tr_b16 v[42:43], v156 offset:32256
v_mfma_f32_16x16x32_bf16 v[236:239], v[20:23], a[180:183], v[236:239]
ds_read_b64_tr_b16 v[44:45], v153 offset:27680
buffer_load_dwordx4 a[244:247], v12, s[28:31], s63 offen offset:1024 sc1
v_mfma_f32_16x16x32_bf16 v[232:235], v[20:23], a[176:179], v[232:235]
s_add_u32 s63, s61, 81920
ds_read_b64_tr_b16 v[46:47], v153 offset:32288
v_mfma_f32_16x16x32_bf16 v[240:243], v[24:27], a[176:179], v[240:243]
ds_read_b64_tr_b16 v[16:17], v154 offset:27680
v_mfma_f32_16x16x32_bf16 v[244:247], v[24:27], a[180:183], v[244:247]
s_waitcnt vmcnt(36) lgkmcnt(5)
ds_read_b64_tr_b16 v[18:19], v154 offset:32288
v_mfma_f32_16x16x32_bf16 v[176:179], v[28:31], a[184:187], v[176:179]
ds_read_b64_tr_b16 v[20:21], v155 offset:27680
buffer_load_dwordx4 a[248:251], v12, s[28:31], s63 offen offset:0 sc1
v_mfma_f32_16x16x32_bf16 v[180:183], v[28:31], a[188:191], v[180:183]
ds_read_b64_tr_b16 v[22:23], v155 offset:32288
v_mfma_f32_16x16x32_bf16 v[188:191], v[32:35], a[188:191], v[188:191]
ds_read_b64_tr_b16 v[24:25], v156 offset:27680
v_mfma_f32_16x16x32_bf16 v[184:187], v[32:35], a[184:187], v[184:187]
ds_read_b64_tr_b16 v[26:27], v156 offset:32288
buffer_load_dwordx4 a[252:255], v12, s[28:31], s63 offen offset:1024 sc1
v_mfma_f32_16x16x32_bf16 v[192:195], v[36:39], a[184:187], v[192:195]
ds_read_b64_tr_b16 v[28:29], v157 offset:27648
v_mfma_f32_16x16x32_bf16 v[196:199], v[36:39], a[188:191], v[196:199]
s_waitcnt lgkmcnt(5)
ds_read_b64_tr_b16 v[30:31], v157 offset:32256
v_mfma_f32_16x16x32_bf16 v[204:207], v[40:43], a[188:191], v[204:207]
v_mfma_f32_16x16x32_bf16 v[200:203], v[40:43], a[184:187], v[200:203]
v_mfma_f32_16x16x32_bf16 v[208:211], v[44:47], a[184:187], v[208:211]
s_waitcnt vmcnt(9) lgkmcnt(0)
s_barrier
ds_read_b32 v141, v10
ds_read_b32 v142, v10 offset:64
v_add_u32 v153, 36864, v153
v_mfma_f32_16x16x32_bf16 v[212:215], v[44:47], a[188:191], v[212:215]
ds_read_b64_tr_b16 v[32:33], v153 offset:0
ds_read_b64_tr_b16 v[34:35], v153 offset:4608
v_mfma_f32_16x16x32_bf16 v[220:223], v[16:19], a[188:191], v[220:223]
v_add_u32 v154, 36864, v154
v_mfma_f32_16x16x32_bf16 v[216:219], v[16:19], a[184:187], v[216:219]
ds_read_b64_tr_b16 v[36:37], v154 offset:0
ds_read_b64_tr_b16 v[38:39], v154 offset:4608
v_mfma_f32_16x16x32_bf16 v[224:227], v[20:23], a[184:187], v[224:227]
v_add_u32 v155, 36864, v155
v_mfma_f32_16x16x32_bf16 v[228:231], v[20:23], a[188:191], v[228:231]
ds_read_b64_tr_b16 v[40:41], v155 offset:0
ds_read_b64_tr_b16 v[42:43], v155 offset:4608
v_mfma_f32_16x16x32_bf16 v[236:239], v[24:27], a[188:191], v[236:239]
v_add_u32 v156, 36864, v156
v_mfma_f32_16x16x32_bf16 v[232:235], v[24:27], a[184:187], v[232:235]
ds_read_b64_tr_b16 v[44:45], v156 offset:0
ds_read_b64_tr_b16 v[46:47], v156 offset:4608
v_mfma_f32_16x16x32_bf16 v[240:243], v[28:31], a[184:187], v[240:243]
s_add_u32 s81, s68, 34668544
buffer_load_dword v158, v159, s[28:31], s81 offen sc1
v_add_u32 v157, 36864, v157
v_mfma_f32_16x16x32_bf16 v[244:247], v[28:31], a[188:191], v[244:247]
s_waitcnt lgkmcnt(2)
v_mov_b32 v15, s57
s_add_u32 s77, s86, 34701312
v_mfma_f32_16x16x32_bf16 v[176:179], v[32:35], a[192:195], v[176:179]
s_mul_i32 s78, s49, 165888
buffer_store_dword v15, v0, s[28:31], s77 offen sc1
ds_read_b64_tr_b16 v[16:17], v153 offset:32
ds_read_b64_tr_b16 v[18:19], v153 offset:4640
v_mfma_f32_16x16x32_bf16 v[180:183], v[32:35], a[196:199], v[180:183]
s_mul_i32 s89, s48, 36864
ds_read_b64_tr_b16 v[20:21], v154 offset:32
ds_read_b64_tr_b16 v[22:23], v154 offset:4640
v_mfma_f32_16x16x32_bf16 v[188:191], v[36:39], a[196:199], v[188:191]
s_add_u32 s78, s78, s89
ds_read_b64_tr_b16 v[24:25], v155 offset:32
ds_read_b64_tr_b16 v[26:27], v155 offset:4640
v_mfma_f32_16x16x32_bf16 v[184:187], v[36:39], a[192:195], v[184:187]
s_mul_i32 s83, s55, 288
ds_read_b64_tr_b16 v[28:29], v156 offset:32
ds_read_b64_tr_b16 v[30:31], v156 offset:4640
v_mfma_f32_16x16x32_bf16 v[192:195], v[40:43], a[192:195], v[192:195]
s_add_u32 s78, s78, s83
ds_read_b64_tr_b16 v[32:33], v157 offset:0
s_add_u32 m0, s62, 36864
v_mfma_f32_16x16x32_bf16 v[196:199], v[40:43], a[196:199], v[196:199]
s_waitcnt lgkmcnt(5)
ds_read_b64_tr_b16 v[34:35], v157 offset:4608
buffer_load_dwordx4 v144, s[24:27], s78 offen offset:0 lds
v_mfma_f32_16x16x32_bf16 v[204:207], v[44:47], a[196:199], v[204:207]
ds_read_b64_tr_b16 v[36:37], v153 offset:9216
buffer_load_dwordx4 v145, s[24:27], s78 offen offset:1024 lds
v_mfma_f32_16x16x32_bf16 v[200:203], v[44:47], a[192:195], v[200:203]
ds_read_b64_tr_b16 v[38:39], v153 offset:13824
buffer_load_dwordx4 v146, s[24:27], s78 offen offset:2048 lds
v_mfma_f32_16x16x32_bf16 v[208:211], v[16:19], a[192:195], v[208:211]
ds_read_b64_tr_b16 v[40:41], v154 offset:9216
v_mfma_f32_16x16x32_bf16 v[212:215], v[16:19], a[196:199], v[212:215]
ds_read_b64_tr_b16 v[42:43], v154 offset:13824
v_mfma_f32_16x16x32_bf16 v[220:223], v[20:23], a[196:199], v[220:223]
ds_read_b64_tr_b16 v[44:45], v155 offset:9216
buffer_load_dwordx4 v147, s[24:27], s78 offen offset:3072 lds
v_mfma_f32_16x16x32_bf16 v[216:219], v[20:23], a[192:195], v[216:219]
s_waitcnt lgkmcnt(5)
ds_read_b64_tr_b16 v[46:47], v155 offset:13824
s_add_u32 m0, s62, 40960
v_mfma_f32_16x16x32_bf16 v[224:227], v[24:27], a[192:195], v[224:227]
ds_read_b64_tr_b16 v[16:17], v156 offset:9216
v_mfma_f32_16x16x32_bf16 v[228:231], v[24:27], a[196:199], v[228:231]
ds_read_b64_tr_b16 v[18:19], v156 offset:13824
v_mfma_f32_16x16x32_bf16 v[236:239], v[28:31], a[196:199], v[236:239]
ds_read_b64_tr_b16 v[20:21], v153 offset:9248
buffer_load_dwordx4 v148, s[24:27], s78 offen offset:0 lds
v_mfma_f32_16x16x32_bf16 v[232:235], v[28:31], a[192:195], v[232:235]
ds_read_b64_tr_b16 v[22:23], v153 offset:13856
v_mfma_f32_16x16x32_bf16 v[240:243], v[32:35], a[192:195], v[240:243]
ds_read_b64_tr_b16 v[24:25], v154 offset:9248
v_mfma_f32_16x16x32_bf16 v[244:247], v[32:35], a[196:199], v[244:247]
s_waitcnt lgkmcnt(5)
ds_read_b64_tr_b16 v[26:27], v154 offset:13856
buffer_load_dwordx4 v149, s[24:27], s78 offen offset:1024 lds
v_mfma_f32_16x16x32_bf16 v[176:179], v[36:39], a[200:203], v[176:179]
ds_read_b64_tr_b16 v[28:29], v155 offset:9248
v_mfma_f32_16x16x32_bf16 v[180:183], v[36:39], a[204:207], v[180:183]
ds_read_b64_tr_b16 v[30:31], v155 offset:13856
v_mfma_f32_16x16x32_bf16 v[188:191], v[40:43], a[204:207], v[188:191]
ds_read_b64_tr_b16 v[32:33], v156 offset:9248
v_mfma_f32_16x16x32_bf16 v[184:187], v[40:43], a[200:203], v[184:187]
ds_read_b64_tr_b16 v[34:35], v156 offset:13856
buffer_load_dwordx4 v150, s[24:27], s78 offen offset:2048 lds
v_mfma_f32_16x16x32_bf16 v[192:195], v[44:47], a[200:203], v[192:195]
ds_read_b64_tr_b16 v[36:37], v157 offset:9216
v_mfma_f32_16x16x32_bf16 v[196:199], v[44:47], a[204:207], v[196:199]
s_waitcnt lgkmcnt(5)
ds_read_b64_tr_b16 v[38:39], v157 offset:13824
v_mfma_f32_16x16x32_bf16 v[204:207], v[16:19], a[204:207], v[204:207]
ds_read_b64_tr_b16 v[40:41], v153 offset:18432
buffer_load_dwordx4 v151, s[24:27], s78 offen offset:3072 lds
v_mfma_f32_16x16x32_bf16 v[200:203], v[16:19], a[200:203], v[200:203]
s_add_u32 m0, s62, 45056
ds_read_b64_tr_b16 v[42:43], v153 offset:23040
v_mfma_f32_16x16x32_bf16 v[208:211], v[20:23], a[200:203], v[208:211]
ds_read_b64_tr_b16 v[44:45], v154 offset:18432
v_mfma_f32_16x16x32_bf16 v[212:215], v[20:23], a[204:207], v[212:215]
ds_read_b64_tr_b16 v[46:47], v154 offset:23040
v_mfma_f32_16x16x32_bf16 v[220:223], v[24:27], a[204:207], v[220:223]
ds_read_b64_tr_b16 v[16:17], v155 offset:18432
buffer_load_dwordx4 v152, s[24:27], s78 offen offset:0 lds
v_mfma_f32_16x16x32_bf16 v[216:219], v[24:27], a[200:203], v[216:219]
s_waitcnt lgkmcnt(5)
ds_read_b64_tr_b16 v[18:19], v155 offset:23040
v_mfma_f32_16x16x32_bf16 v[224:227], v[28:31], a[200:203], v[224:227]
ds_read_b64_tr_b16 v[20:21], v156 offset:18432
v_mfma_f32_16x16x32_bf16 v[228:231], v[28:31], a[204:207], v[228:231]
ds_read_b64_tr_b16 v[22:23], v156 offset:23040
v_mfma_f32_16x16x32_bf16 v[236:239], v[32:35], a[204:207], v[236:239]
ds_read_b64_tr_b16 v[24:25], v153 offset:18464
v_mfma_f32_16x16x32_bf16 v[232:235], v[32:35], a[200:203], v[232:235]
ds_read_b64_tr_b16 v[26:27], v153 offset:23072
v_mfma_f32_16x16x32_bf16 v[240:243], v[36:39], a[200:203], v[240:243]
ds_read_b64_tr_b16 v[28:29], v154 offset:18464
v_mfma_f32_16x16x32_bf16 v[244:247], v[36:39], a[204:207], v[244:247]
s_waitcnt lgkmcnt(5)
ds_read_b64_tr_b16 v[30:31], v154 offset:23072
v_mfma_f32_16x16x32_bf16 v[176:179], v[40:43], a[208:211], v[176:179]
ds_read_b64_tr_b16 v[32:33], v155 offset:18464
v_mfma_f32_16x16x32_bf16 v[180:183], v[40:43], a[212:215], v[180:183]
ds_read_b64_tr_b16 v[34:35], v155 offset:23072
v_mfma_f32_16x16x32_bf16 v[188:191], v[44:47], a[212:215], v[188:191]
ds_read_b64_tr_b16 v[36:37], v156 offset:18464
v_mfma_f32_16x16x32_bf16 v[184:187], v[44:47], a[208:211], v[184:187]
ds_read_b64_tr_b16 v[38:39], v156 offset:23072
v_mfma_f32_16x16x32_bf16 v[192:195], v[16:19], a[208:211], v[192:195]
ds_read_b64_tr_b16 v[40:41], v157 offset:18432
s_waitcnt vmcnt(10)
v_cmp_ne_u32 vcc, s57, v158
s_nop 1
s_cbranch_vccnz L_slow4
L_back4:
v_mfma_f32_16x16x32_bf16 v[196:199], v[16:19], a[212:215], v[196:199]
s_waitcnt lgkmcnt(5)
ds_read_b64_tr_b16 v[42:43], v157 offset:23040
s_add_u32 s63, s80, 262144
v_mfma_f32_16x16x32_bf16 v[204:207], v[20:23], a[212:215], v[204:207]
ds_read_b64_tr_b16 v[44:45], v153 offset:27648
buffer_load_dwordx4 v[48:51], v12, s[28:31], s63 offen offset:0 sc1
v_mfma_f32_16x16x32_bf16 v[200:203], v[20:23], a[208:211], v[200:203]
ds_read_b64_tr_b16 v[46:47], v153 offset:32256
v_mfma_f32_16x16x32_bf16 v[208:211], v[24:27], a[208:211], v[208:211]
ds_read_b64_tr_b16 v[16:17], v154 offset:27648
buffer_load_dwordx4 v[52:55], v12, s[28:31], s63 offen offset:1024 sc1
v_mfma_f32_16x16x32_bf16 v[212:215], v[24:27], a[212:215], v[212:215]
s_add_u32 s63, s80, 278528
ds_read_b64_tr_b16 v[18:19], v154 offset:32256
v_mfma_f32_16x16x32_bf16 v[220:223], v[28:31], a[212:215], v[220:223]
ds_read_b64_tr_b16 v[20:21], v155 offset:27648
buffer_load_dwordx4 v[56:59], v12, s[28:31], s63 offen offset:0 sc1
v_mfma_f32_16x16x32_bf16 v[216:219], v[28:31], a[208:211], v[216:219]
s_waitcnt lgkmcnt(5)
ds_read_b64_tr_b16 v[22:23], v155 offset:32256
v_mfma_f32_16x16x32_bf16 v[224:227], v[32:35], a[208:211], v[224:227]
ds_read_b64_tr_b16 v[24:25], v156 offset:27648
buffer_load_dwordx4 v[60:63], v12, s[28:31], s63 offen offset:1024 sc1
v_mfma_f32_16x16x32_bf16 v[228:231], v[32:35], a[212:215], v[228:231]
s_add_u32 s63, s80, 557056
ds_read_b64_tr_b16 v[26:27], v156 offset:32256
v_mfma_f32_16x16x32_bf16 v[236:239], v[36:39], a[212:215], v[236:239]
ds_read_b64_tr_b16 v[28:29], v153 offset:27680
buffer_load_dwordx4 v[64:67], v12, s[28:31], s63 offen offset:0 sc1
v_mfma_f32_16x16x32_bf16 v[232:235], v[36:39], a[208:211], v[232:235]
ds_read_b64_tr_b16 v[30:31], v153 offset:32288
v_mfma_f32_16x16x32_bf16 v[240:243], v[40:43], a[208:211], v[240:243]
ds_read_b64_tr_b16 v[32:33], v154 offset:27680
buffer_load_dwordx4 v[68:71], v12, s[28:31], s63 offen offset:1024 sc1
v_mfma_f32_16x16x32_bf16 v[244:247], v[40:43], a[212:215], v[244:247]
s_waitcnt lgkmcnt(5)
ds_read_b64_tr_b16 v[34:35], v154 offset:32288
s_add_u32 s63, s80, 573440
v_mfma_f32_16x16x32_bf16 v[176:179], v[44:47], a[216:219], v[176:179]
ds_read_b64_tr_b16 v[36:37], v155 offset:27680
buffer_load_dwordx4 v[72:75], v12, s[28:31], s63 offen offset:0 sc1
v_mfma_f32_16x16x32_bf16 v[180:183], v[44:47], a[220:223], v[180:183]
ds_read_b64_tr_b16 v[38:39], v155 offset:32288
v_mfma_f32_16x16x32_bf16 v[188:191], v[16:19], a[220:223], v[188:191]
ds_read_b64_tr_b16 v[40:41], v156 offset:27680
buffer_load_dwordx4 v[76:79], v12, s[28:31], s63 offen offset:1024 sc1
v_mfma_f32_16x16x32_bf16 v[184:187], v[16:19], a[216:219], v[184:187]
ds_read_b64_tr_b16 v[42:43], v156 offset:32288
v_mfma_f32_16x16x32_bf16 v[192:195], v[20:23], a[216:219], v[192:195]
ds_read_b64_tr_b16 v[44:45], v157 offset:27648
v_mfma_f32_16x16x32_bf16 v[196:199], v[20:23], a[220:223], v[196:199]
s_waitcnt lgkmcnt(5)
ds_read_b64_tr_b16 v[46:47], v157 offset:32256
v_mfma_f32_16x16x32_bf16 v[204:207], v[24:27], a[220:223], v[204:207]
v_mfma_f32_16x16x32_bf16 v[200:203], v[24:27], a[216:219], v[200:203]
v_mfma_f32_16x16x32_bf16 v[208:211], v[28:31], a[216:219], v[208:211]
s_waitcnt lgkmcnt(0)
s_barrier
v_add_u32 v154, 36864, v154
v_mfma_f32_16x16x32_bf16 v[212:215], v[28:31], a[220:223], v[212:215]
ds_read_b64_tr_b16 v[16:17], v154 offset:0
ds_read_b64_tr_b16 v[18:19], v154 offset:4608
v_mfma_f32_16x16x32_bf16 v[220:223], v[32:35], a[220:223], v[220:223]
s_mul_i32 s78, s49, 165888
v_add_u32 v155, 36864, v155
s_add_u32 s78, s78, 151552
v_mfma_f32_16x16x32_bf16 v[216:219], v[32:35], a[216:219], v[216:219]
s_add_u32 s78, s78, s83
ds_read_b64_tr_b16 v[20:21], v155 offset:0
ds_read_b64_tr_b16 v[22:23], v155 offset:4608
v_mfma_f32_16x16x32_bf16 v[224:227], v[36:39], a[216:219], v[224:227]
v_add_u32 v156, 36864, v156
v_lshl_add_u32 v5, s48, 7, v14
v_mfma_f32_16x16x32_bf16 v[228:231], v[36:39], a[220:223], v[228:231]
ds_read_b64_tr_b16 v[24:25], v156 offset:0
ds_read_b64_tr_b16 v[26:27], v156 offset:4608
v_mfma_f32_16x16x32_bf16 v[236:239], v[40:43], a[220:223], v[236:239]
v_add_u32 v157, 36864, v157
v_add_u32 v5, 0, v5
v_mfma_f32_16x16x32_bf16 v[232:235], v[40:43], a[216:219], v[232:235]
ds_read_b64_tr_b16 v[28:29], v154 offset:32
ds_read_b64_tr_b16 v[30:31], v154 offset:4640
v_mfma_f32_16x16x32_bf16 v[240:243], v[44:47], a[216:219], v[240:243]
ds_read_b64_tr_b16 v[32:33], v155 offset:32
ds_read_b64_tr_b16 v[34:35], v155 offset:4640
v_mfma_f32_16x16x32_bf16 v[244:247], v[44:47], a[220:223], v[244:247]
s_waitcnt lgkmcnt(4)
ds_read_b64_tr_b16 v[36:37], v156 offset:32
ds_read_b64_tr_b16 v[38:39], v156 offset:4640
v_mfma_f32_16x16x32_bf16 v[188:191], v[16:19], a[228:231], v[188:191]
ds_read_b64_tr_b16 v[40:41], v157 offset:0
v_mul_u32_u24 v6, 3641, v5
v_mfma_f32_16x16x32_bf16 v[184:187], v[16:19], a[224:227], v[184:187]
ds_read_b64_tr_b16 v[42:43], v157 offset:4608
v_lshrrev_b32 v6, 16, v6
v_mfma_f32_16x16x32_bf16 v[192:195], v[20:23], a[224:227], v[192:195]
ds_read_b64_tr_b16 v[44:45], v154 offset:9216
v_mul_u32_u24 v6, 864, v6
v_mfma_f32_16x16x32_bf16 v[196:199], v[20:23], a[228:231], v[196:199]
ds_read_b64_tr_b16 v[46:47], v154 offset:13824
v_lshl_add_u32 v5, v5, 4, v6
v_mfma_f32_16x16x32_bf16 v[204:207], v[24:27], a[228:231], v[204:207]
ds_read_b64_tr_b16 v[16:17], v155 offset:9216
v_add_u32 v5, s78, v5
v_mfma_f32_16x16x32_bf16 v[200:203], v[24:27], a[224:227], v[200:203]
s_waitcnt lgkmcnt(5)
ds_read_b64_tr_b16 v[18:19], v155 offset:13824
s_lshl_b32 s89, s48, 11
v_mfma_f32_16x16x32_bf16 v[220:223], v[28:31], a[228:231], v[220:223]
s_add_u32 m0, s89, 73728
ds_read_b64_tr_b16 v[20:21], v156 offset:9216
buffer_load_dwordx4 v5, s[24:27], 0 offen lds
v_mfma_f32_16x16x32_bf16 v[216:219], v[28:31], a[224:227], v[216:219]
ds_read_b64_tr_b16 v[22:23], v156 offset:13824
v_lshl_add_u32 v5, s48, 7, v14
v_mfma_f32_16x16x32_bf16 v[224:227], v[32:35], a[224:227], v[224:227]
ds_read_b64_tr_b16 v[24:25], v154 offset:9248
v_add_u32 v5, 64, v5
v_mfma_f32_16x16x32_bf16 v[228:231], v[32:35], a[228:231], v[228:231]
ds_read_b64_tr_b16 v[26:27], v154 offset:13856
v_mul_u32_u24 v6, 3641, v5
v_mfma_f32_16x16x32_bf16 v[236:239], v[36:39], a[228:231], v[236:239]
ds_read_b64_tr_b16 v[28:29], v155 offset:9248
v_lshrrev_b32 v6, 16, v6
v_mfma_f32_16x16x32_bf16 v[232:235], v[36:39], a[224:227], v[232:235]
s_waitcnt lgkmcnt(5)
ds_read_b64_tr_b16 v[30:31], v155 offset:13856
v_mul_u32_u24 v6, 864, v6
v_mfma_f32_16x16x32_bf16 v[240:243], v[40:43], a[224:227], v[240:243]
ds_read_b64_tr_b16 v[32:33], v156 offset:9248
v_lshl_add_u32 v5, v5, 4, v6
v_mfma_f32_16x16x32_bf16 v[244:247], v[40:43], a[228:231], v[244:247]
ds_read_b64_tr_b16 v[34:35], v156 offset:13856
v_add_u32 v5, s78, v5
v_mfma_f32_16x16x32_bf16 v[188:191], v[44:47], a[236:239], v[188:191]
s_lshl_b32 s89, s48, 11
ds_read_b64_tr_b16 v[36:37], v157 offset:9216
s_add_u32 m0, s89, 74752
v_mfma_f32_16x16x32_bf16 v[184:187], v[44:47], a[232:235], v[184:187]
ds_read_b64_tr_b16 v[38:39], v157 offset:13824
v_mfma_f32_16x16x32_bf16 v[192:195], v[16:19], a[232:235], v[192:195]
ds_read_b64_tr_b16 v[40:41], v154 offset:18432
buffer_load_dwordx4 v5, s[24:27], 0 offen lds
v_mfma_f32_16x16x32_bf16 v[196:199], v[16:19], a[236:239], v[196:199]
s_waitcnt lgkmcnt(5)
ds_read_b64_tr_b16 v[42:43], v154 offset:23040
v_mfma_f32_16x16x32_bf16 v[204:207], v[20:23], a[236:239], v[204:207]
ds_read_b64_tr_b16 v[44:45], v155 offset:18432
v_mfma_f32_16x16x32_bf16 v[200:203], v[20:23], a[232:235], v[200:203]
ds_read_b64_tr_b16 v[46:47], v155 offset:23040
v_mfma_f32_16x16x32_bf16 v[220:223], v[24:27], a[236:239], v[220:223]
s_add_u32 s81, s68, 34701312
ds_read_b64_tr_b16 v[16:17], v156 offset:18432
buffer_load_dword v158, v159, s[28:31], s81 offen sc1
v_mfma_f32_16x16x32_bf16 v[216:219], v[24:27], a[232:235], v[216:219]
ds_read_b64_tr_b16 v[18:19], v156 offset:23040
v_mfma_f32_16x16x32_bf16 v[224:227], v[28:31], a[232:235], v[224:227]
ds_read_b64_tr_b16 v[20:21], v154 offset:18464
v_mfma_f32_16x16x32_bf16 v[228:231], v[28:31], a[236:239], v[228:231]
s_waitcnt lgkmcnt(5)
ds_read_b64_tr_b16 v[22:23], v154 offset:23072
v_mfma_f32_16x16x32_bf16 v[236:239], v[32:35], a[236:239], v[236:239]
ds_read_b64_tr_b16 v[24:25], v155 offset:18464
v_mfma_f32_16x16x32_bf16 v[232:235], v[32:35], a[232:235], v[232:235]
ds_read_b64_tr_b16 v[26:27], v155 offset:23072
v_mfma_f32_16x16x32_bf16 v[240:243], v[36:39], a[232:235], v[240:243]
ds_read_b64_tr_b16 v[28:29], v156 offset:18464
v_mfma_f32_16x16x32_bf16 v[244:247], v[36:39], a[236:239], v[244:247]
ds_read_b64_tr_b16 v[30:31], v156 offset:23072
v_mfma_f32_16x16x32_bf16 v[188:191], v[40:43], a[244:247], v[188:191]
ds_read_b64_tr_b16 v[32:33], v157 offset:18432
v_mfma_f32_16x16x32_bf16 v[184:187], v[40:43], a[240:243], v[184:187]
s_waitcnt lgkmcnt(5)
ds_read_b64_tr_b16 v[34:35], v157 offset:23040
v_mfma_f32_16x16x32_bf16 v[192:195], v[44:47], a[240:243], v[192:195]
ds_read_b64_tr_b16 v[36:37], v154 offset:27648
v_mfma_f32_16x16x32_bf16 v[196:199], v[44:47], a[244:247], v[196:199]
ds_read_b64_tr_b16 v[38:39], v154 offset:32256
v_mfma_f32_16x16x32_bf16 v[204:207], v[16:19], a[244:247], v[204:207]
ds_read_b64_tr_b16 v[40:41], v155 offset:27648
v_mfma_f32_16x16x32_bf16 v[200:203], v[16:19], a[240:243], v[200:203]
ds_read_b64_tr_b16 v[42:43], v155 offset:32256
v_mfma_f32_16x16x32_bf16 v[220:223], v[20:23], a[244:247], v[220:223]
ds_read_b64_tr_b16 v[44:45], v156 offset:27648
v_mfma_f32_16x16x32_bf16 v[216:219], v[20:23], a[240:243], v[216:219]
s_waitcnt lgkmcnt(5)
ds_read_b64_tr_b16 v[46:47], v156 offset:32256
v_mfma_f32_16x16x32_bf16 v[224:227], v[24:27], a[240:243], v[224:227]
ds_read_b64_tr_b16 v[16:17], v154 offset:27680
s_waitcnt vmcnt(9)
v_swap_b32 v50, v52
v_mfma_f32_16x16x32_bf16 v[228:231], v[24:27], a[244:247], v[228:231]
ds_read_b64_tr_b16 v[18:19], v154 offset:32288
v_swap_b32 v51, v53
v_mfma_f32_16x16x32_bf16 v[236:239], v[28:31], a[244:247], v[236:239]
ds_read_b64_tr_b16 v[20:21], v155 offset:27680
s_waitcnt vmcnt(7)
v_swap_b32 v58, v60
v_mfma_f32_16x16x32_bf16 v[232:235], v[28:31], a[240:243], v[232:235]
ds_read_b64_tr_b16 v[22:23], v155 offset:32288
v_swap_b32 v59, v61
v_mfma_f32_16x16x32_bf16 v[240:243], v[32:35], a[240:243], v[240:243]
ds_read_b64_tr_b16 v[24:25], v156 offset:27680
s_waitcnt vmcnt(5)
v_swap_b32 v66, v68
v_mfma_f32_16x16x32_bf16 v[244:247], v[32:35], a[244:247], v[244:247]
s_waitcnt lgkmcnt(5)
ds_read_b64_tr_b16 v[26:27], v156 offset:32288
v_swap_b32 v67, v69
v_mfma_f32_16x16x32_bf16 v[188:191], v[36:39], a[252:255], v[188:191]
ds_read_b64_tr_b16 v[28:29], v157 offset:27648
s_waitcnt vmcnt(3)
v_swap_b32 v74, v76
v_mfma_f32_16x16x32_bf16 v[184:187], v[36:39], a[248:251], v[184:187]
ds_read_b64_tr_b16 v[30:31], v157 offset:32256
v_swap_b32 v75, v77
v_mfma_f32_16x16x32_bf16 v[192:195], v[40:43], a[248:251], v[192:195]
v_sub_f32 v141, 1.0, v141
v_sub_f32 v142, 1.0, v142
v_mfma_f32_16x16x32_bf16 v[196:199], v[40:43], a[252:255], v[196:199]
v_mfma_f32_16x16x32_bf16 v[204:207], v[44:47], a[252:255], v[204:207]
s_waitcnt lgkmcnt(0)
s_barrier
v_add_u32 v154, 4294856704, v154
v_mfma_f32_16x16x32_bf16 v[200:203], v[44:47], a[248:251], v[200:203]
ds_read_b64_tr_b16 v[32:33], v154 offset:0
ds_read_b64_tr_b16 v[34:35], v154 offset:4608
v_mfma_f32_16x16x32_bf16 v[220:223], v[16:19], a[252:255], v[220:223]
v_add_u32 v155, 4294856704, v155
v_mfma_f32_16x16x32_bf16 v[216:219], v[16:19], a[248:251], v[216:219]
ds_read_b64_tr_b16 v[36:37], v155 offset:0
ds_read_b64_tr_b16 v[38:39], v155 offset:4608
v_mfma_f32_16x16x32_bf16 v[224:227], v[20:23], a[248:251], v[224:227]
v_add_u32 v156, 4294856704, v156
v_mfma_f32_16x16x32_bf16 v[228:231], v[20:23], a[252:255], v[228:231]
ds_read_b64_tr_b16 v[40:41], v156 offset:0
ds_read_b64_tr_b16 v[42:43], v156 offset:4608
v_mfma_f32_16x16x32_bf16 v[236:239], v[24:27], a[252:255], v[236:239]
v_add_u32 v157, 4294856704, v157
v_mfma_f32_16x16x32_bf16 v[232:235], v[24:27], a[248:251], v[232:235]
s_waitcnt lgkmcnt(2)
ds_read_b64_tr_b16 v[44:45], v154 offset:32
ds_read_b64_tr_b16 v[46:47], v154 offset:4640
v_mfma_f32_16x16x32_bf16 v[240:243], v[28:31], a[248:251], v[240:243]
ds_read_b64_tr_b16 v[16:17], v155 offset:32
ds_read_b64_tr_b16 v[18:19], v155 offset:4640
v_mfma_f32_16x16x32_bf16 v[244:247], v[28:31], a[252:255], v[244:247]
ds_read_b64_tr_b16 v[20:21], v156 offset:32
ds_read_b64_tr_b16 v[22:23], v156 offset:4640
v_mfma_f32_16x16x32_bf16 v[188:191], v[32:35], v[52:55], v[188:191]
ds_read_b64_tr_b16 v[24:25], v157 offset:0
s_waitcnt vmcnt(0)
v_cmp_ne_u32 vcc, s57, v158
s_nop 1
s_cbranch_vccnz L_slow5
L_back5:
v_mfma_f32_16x16x32_bf16 v[184:187], v[32:35], v[48:51], v[184:187]
s_add_u32 s63, s80, 589824
ds_read_b64_tr_b16 v[26:27], v157 offset:4608
buffer_load_dwordx4 v[80:83], v12, s[28:31], s63 offen offset:0 sc1
v_mfma_f32_16x16x32_bf16 v[192:195], v[36:39], v[48:51], v[192:195]
ds_read_b64_tr_b16 v[28:29], v154 offset:9216
buffer_load_dwordx4 v[84:87], v12, s[28:31], s63 offen offset:1024 sc1
v_mfma_f32_16x16x32_bf16 v[196:199], v[36:39], v[52:55], v[196:199]
s_waitcnt lgkmcnt(5)
ds_read_b64_tr_b16 v[30:31], v154 offset:13824
s_add_u32 s63, s80, 606208
v_mfma_f32_16x16x32_bf16 v[204:207], v[40:43], v[52:55], v[204:207]
ds_read_b64_tr_b16 v[32:33], v155 offset:9216
buffer_load_dwordx4 v[88:91], v12, s[28:31], s63 offen offset:0 sc1
v_mfma_f32_16x16x32_bf16 v[200:203], v[40:43], v[48:51], v[200:203]
ds_read_b64_tr_b16 v[34:35], v155 offset:13824
buffer_load_dwordx4 v[92:95], v12, s[28:31], s63 offen offset:1024 sc1
v_mfma_f32_16x16x32_bf16 v[220:223], v[44:47], v[52:55], v[220:223]
s_add_u32 s63, s80, 622592
ds_read_b64_tr_b16 v[36:37], v156 offset:9216
buffer_load_dwordx4 v[96:99], v12, s[28:31], s63 offen offset:0 sc1
v_mfma_f32_16x16x32_bf16 v[216:219], v[44:47], v[48:51], v[216:219]
ds_read_b64_tr_b16 v[38:39], v156 offset:13824
buffer_load_dwordx4 v[100:103], v12, s[28:31], s63 offen offset:1024 sc1
v_mfma_f32_16x16x32_bf16 v[224:227], v[16:19], v[48:51], v[224:227]
s_add_u32 s63, s80, 638976
ds_read_b64_tr_b16 v[40:41], v154 offset:9248
buffer_load_dwordx4 v[104:107], v12, s[28:31], s63 offen offset:0 sc1
v_mfma_f32_16x16x32_bf16 v[228:231], v[16:19], v[52:55], v[228:231]
s_waitcnt lgkmcnt(5)
ds_read_b64_tr_b16 v[42:43], v154 offset:13856
buffer_load_dwordx4 v[108:111], v12, s[28:31], s63 offen offset:1024 sc1
v_mfma_f32_16x16x32_bf16 v[236:239], v[20:23], v[52:55], v[236:239]
s_add_u32 s63, s80, 655360
ds_read_b64_tr_b16 v[44:45], v155 offset:9248
v_mfma_f32_16x16x32_bf16 v[232:235], v[20:23], v[48:51], v[232:235]
ds_read_b64_tr_b16 v[46:47], v155 offset:13856
buffer_load_dwordx4 v[112:115], v13, s[28:31], s63 offen offset:0 sc1
v_mfma_f32_16x16x32_bf16 v[240:243], v[24:27], v[48:51], v[240:243]
ds_read_b64_tr_b16 v[16:17], v156 offset:9248
buffer_load_dwordx4 v[116:119], v13, s[28:31], s63 offen offset:256 sc1
v_mfma_f32_16x16x32_bf16 v[244:247], v[24:27], v[52:55], v[244:247]
ds_read_b64_tr_b16 v[18:19], v156 offset:13856
v_mfma_f32_16x16x32_bf16 v[188:191], v[28:31], v[60:63], v[188:191]
ds_read_b64_tr_b16 v[20:21], v157 offset:9216
v_mfma_f32_16x16x32_bf16 v[184:187], v[28:31], v[56:59], v[184:187]
s_waitcnt lgkmcnt(5)
ds_read_b64_tr_b16 v[22:23], v157 offset:13824
v_mfma_f32_16x16x32_bf16 v[192:195], v[32:35], v[56:59], v[192:195]
ds_read_b64_tr_b16 v[24:25], v154 offset:18432
v_mfma_f32_16x16x32_bf16 v[196:199], v[32:35], v[60:63], v[196:199]
ds_read_b64_tr_b16 v[26:27], v154 offset:23040
v_mfma_f32_16x16x32_bf16 v[204:207], v[36:39], v[60:63], v[204:207]
ds_read_b64_tr_b16 v[28:29], v155 offset:18432
v_mfma_f32_16x16x32_bf16 v[200:203], v[36:39], v[56:59], v[200:203]
ds_read_b64_tr_b16 v[30:31], v155 offset:23040
v_mfma_f32_16x16x32_bf16 v[220:223], v[40:43], v[60:63], v[220:223]
ds_read_b64_tr_b16 v[32:33], v156 offset:18432
v_mfma_f32_16x16x32_bf16 v[216:219], v[40:43], v[56:59], v[216:219]
s_waitcnt lgkmcnt(5)
ds_read_b64_tr_b16 v[34:35], v156 offset:23040
v_mfma_f32_16x16x32_bf16 v[224:227], v[44:47], v[56:59], v[224:227]
ds_read_b64_tr_b16 v[36:37], v154 offset:18464
v_mfma_f32_16x16x32_bf16 v[228:231], v[44:47], v[60:63], v[228:231]
ds_read_b64_tr_b16 v[38:39], v154 offset:23072
v_mfma_f32_16x16x32_bf16 v[236:239], v[16:19], v[60:63], v[236:239]
ds_read_b64_tr_b16 v[40:41], v155 offset:18464
v_mfma_f32_16x16x32_bf16 v[232:235], v[16:19], v[56:59], v[232:235]
ds_read_b64_tr_b16 v[42:43], v155 offset:23072
v_mfma_f32_16x16x32_bf16 v[240:243], v[20:23], v[56:59], v[240:243]
ds_read_b64_tr_b16 v[44:45], v156 offset:18464
v_mfma_f32_16x16x32_bf16 v[244:247], v[20:23], v[60:63], v[244:247]
s_waitcnt lgkmcnt(5)
ds_read_b64_tr_b16 v[46:47], v156 offset:23072
v_mfma_f32_16x16x32_bf16 v[188:191], v[24:27], v[68:71], v[188:191]
ds_read_b64_tr_b16 v[16:17], v157 offset:18432
v_mfma_f32_16x16x32_bf16 v[184:187], v[24:27], v[64:67], v[184:187]
ds_read_b64_tr_b16 v[18:19], v157 offset:23040
v_mfma_f32_16x16x32_bf16 v[192:195], v[28:31], v[64:67], v[192:195]
ds_read_b64_tr_b16 v[20:21], v154 offset:27648
v_mfma_f32_16x16x32_bf16 v[196:199], v[28:31], v[68:71], v[196:199]
ds_read_b64_tr_b16 v[22:23], v154 offset:32256
v_mfma_f32_16x16x32_bf16 v[204:207], v[32:35], v[68:71], v[204:207]
ds_read_b64_tr_b16 v[24:25], v155 offset:27648
v_mfma_f32_16x16x32_bf16 v[200:203], v[32:35], v[64:67], v[200:203]
s_waitcnt lgkmcnt(5)
ds_read_b64_tr_b16 v[26:27], v155 offset:32256
v_mfma_f32_16x16x32_bf16 v[220:223], v[36:39], v[68:71], v[220:223]
ds_read_b64_tr_b16 v[28:29], v156 offset:27648
v_mfma_f32_16x16x32_bf16 v[216:219], v[36:39], v[64:67], v[216:219]
ds_read_b64_tr_b16 v[30:31], v156 offset:32256
v_mfma_f32_16x16x32_bf16 v[224:227], v[40:43], v[64:67], v[224:227]
ds_read_b64_tr_b16 v[32:33], v154 offset:27680
v_mfma_f32_16x16x32_bf16 v[228:231], v[40:43], v[68:71], v[228:231]
ds_read_b64_tr_b16 v[34:35], v154 offset:32288
v_mfma_f32_16x16x32_bf16 v[236:239], v[44:47], v[68:71], v[236:239]
ds_read_b64_tr_b16 v[36:37], v155 offset:27680
v_mfma_f32_16x16x32_bf16 v[232:235], v[44:47], v[64:67], v[232:235]
s_waitcnt lgkmcnt(5)
ds_read_b64_tr_b16 v[38:39], v155 offset:32288
v_mfma_f32_16x16x32_bf16 v[240:243], v[16:19], v[64:67], v[240:243]
ds_read_b64_tr_b16 v[40:41], v156 offset:27680
v_mfma_f32_16x16x32_bf16 v[244:247], v[16:19], v[68:71], v[244:247]
ds_read_b64_tr_b16 v[42:43], v156 offset:32288
v_mfma_f32_16x16x32_bf16 v[188:191], v[20:23], v[76:79], v[188:191]
ds_read_b64_tr_b16 v[44:45], v157 offset:27648
v_mfma_f32_16x16x32_bf16 v[184:187], v[20:23], v[72:75], v[184:187]
ds_read_b64_tr_b16 v[46:47], v157 offset:32256
v_mfma_f32_16x16x32_bf16 v[192:195], v[24:27], v[72:75], v[192:195]
v_mfma_f32_16x16x32_bf16 v[196:199], v[24:27], v[76:79], v[196:199]
s_waitcnt lgkmcnt(4)
v_mfma_f32_16x16x32_bf16 v[204:207], v[28:31], v[76:79], v[204:207]
s_waitcnt lgkmcnt(0)
s_barrier
v_add_u32 v154, 36864, v154
v_mfma_f32_16x16x32_bf16 v[200:203], v[28:31], v[72:75], v[200:203]
ds_read_b64_tr_b16 v[16:17], v154 offset:0
ds_read_b64_tr_b16 v[18:19], v154 offset:5184
v_mfma_f32_16x16x32_bf16 v[220:223], v[32:35], v[76:79], v[220:223]
v_add_u32 v155, 36864, v155
v_mfma_f32_16x16x32_bf16 v[216:219], v[32:35], v[72:75], v[216:219]
ds_read_b64_tr_b16 v[20:21], v155 offset:0
ds_read_b64_tr_b16 v[22:23], v155 offset:5184
v_mfma_f32_16x16x32_bf16 v[224:227], v[36:39], v[72:75], v[224:227]
v_add_u32 v156, 36864, v156
v_mfma_f32_16x16x32_bf16 v[228:231], v[36:39], v[76:79], v[228:231]
s_waitcnt vmcnt(8) lgkmcnt(2)
ds_read_b64_tr_b16 v[24:25], v156 offset:0
ds_read_b64_tr_b16 v[26:27], v156 offset:5184
v_mfma_f32_16x16x32_bf16 v[236:239], v[40:43], v[76:79], v[236:239]
v_add_u32 v157, 36864, v157
v_swap_b32 v82, v84
v_mfma_f32_16x16x32_bf16 v[232:235], v[40:43], v[72:75], v[232:235]
ds_read_b64_tr_b16 v[28:29], v154 offset:32
ds_read_b64_tr_b16 v[30:31], v154 offset:5216
v_mfma_f32_16x16x32_bf16 v[240:243], v[44:47], v[72:75], v[240:243]
ds_read_b64_tr_b16 v[32:33], v155 offset:32
ds_read_b64_tr_b16 v[34:35], v155 offset:5216
v_mfma_f32_16x16x32_bf16 v[244:247], v[44:47], v[76:79], v[244:247]
ds_read_b64_tr_b16 v[36:37], v156 offset:32
ds_read_b64_tr_b16 v[38:39], v156 offset:5216
v_swap_b32 v83, v85
s_waitcnt vmcnt(6)
v_swap_b32 v90, v92
v_swap_b32 v91, v93
s_waitcnt vmcnt(4)
v_swap_b32 v98, v100
v_swap_b32 v99, v101
s_waitcnt vmcnt(2)
v_swap_b32 v106, v108
v_swap_b32 v107, v109
s_waitcnt vmcnt(0)
v_swap_b32 v114, v116
v_swap_b32 v115, v117
v_mul_f32 v184, v184, v141
v_mul_f32 v185, v185, v141
v_mul_f32 v186, v186, v141
v_mul_f32 v187, v187, v141
v_mul_f32 v188, v188, v142
v_mul_f32 v189, v189, v142
v_mul_f32 v190, v190, v142
v_mul_f32 v191, v191, v142
s_nop 1
v_mfma_f32_16x16x32_bf16 v[188:191], v[16:19], v[84:87], v[188:191]
ds_read_b64_tr_b16 v[40:41], v157 offset:0
v_mul_f32 v192, v192, v141
v_mfma_f32_16x16x32_bf16 v[184:187], v[16:19], v[80:83], v[184:187]
s_waitcnt lgkmcnt(5)
ds_read_b64_tr_b16 v[42:43], v157 offset:5184
v_mul_f32 v193, v193, v141
v_mul_f32 v194, v194, v141
v_mul_f32 v195, v195, v141
v_mul_f32 v196, v196, v142
v_mul_f32 v197, v197, v142
v_mul_f32 v198, v198, v142
v_mul_f32 v199, v199, v142
v_mfma_f32_16x16x32_bf16 v[192:195], v[20:23], v[80:83], v[192:195]
ds_read_b64_tr_b16 v[44:45], v154 offset:10368
v_mul_f32 v200, v200, v141
v_mfma_f32_16x16x32_bf16 v[196:199], v[20:23], v[84:87], v[196:199]
ds_read_b64_tr_b16 v[46:47], v154 offset:15552
v_mul_f32 v201, v201, v141
v_mul_f32 v202, v202, v141
v_mul_f32 v203, v203, v141
v_mul_f32 v204, v204, v142
v_mul_f32 v205, v205, v142
v_mul_f32 v206, v206, v142
v_mul_f32 v207, v207, v142
s_nop 1
v_mfma_f32_16x16x32_bf16 v[204:207], v[24:27], v[84:87], v[204:207]
ds_read_b64_tr_b16 v[16:17], v155 offset:10368
v_mul_f32 v216, v216, v141
v_mfma_f32_16x16x32_bf16 v[200:203], v[24:27], v[80:83], v[200:203]
ds_read_b64_tr_b16 v[18:19], v155 offset:15552
v_mul_f32 v217, v217, v141
v_mul_f32 v218, v218, v141
v_mul_f32 v219, v219, v141
v_mul_f32 v220, v220, v142
v_mul_f32 v221, v221, v142
v_mul_f32 v222, v222, v142
v_mul_f32 v223, v223, v142
s_nop 1
v_mfma_f32_16x16x32_bf16 v[220:223], v[28:31], v[84:87], v[220:223]
ds_read_b64_tr_b16 v[20:21], v156 offset:10368
v_mul_f32 v224, v224, v141
v_mfma_f32_16x16x32_bf16 v[216:219], v[28:31], v[80:83], v[216:219]
s_waitcnt lgkmcnt(5)
ds_read_b64_tr_b16 v[22:23], v156 offset:15552
v_mul_f32 v225, v225, v141
v_mul_f32 v226, v226, v141
v_mul_f32 v227, v227, v141
v_mul_f32 v228, v228, v142
v_mul_f32 v229, v229, v142
v_mul_f32 v230, v230, v142
v_mul_f32 v231, v231, v142
v_mfma_f32_16x16x32_bf16 v[224:227], v[32:35], v[80:83], v[224:227]
ds_read_b64_tr_b16 v[24:25], v154 offset:10400
v_mul_f32 v232, v232, v141
v_mfma_f32_16x16x32_bf16 v[228:231], v[32:35], v[84:87], v[228:231]
ds_read_b64_tr_b16 v[26:27], v154 offset:15584
v_mul_f32 v233, v233, v141
v_mul_f32 v234, v234, v141
v_mul_f32 v235, v235, v141
v_mul_f32 v236, v236, v142
v_mul_f32 v237, v237, v142
v_mul_f32 v238, v238, v142
v_mul_f32 v239, v239, v142
s_nop 1
v_mfma_f32_16x16x32_bf16 v[236:239], v[36:39], v[84:87], v[236:239]
ds_read_b64_tr_b16 v[28:29], v155 offset:10400
v_mul_f32 v240, v240, v141
v_mfma_f32_16x16x32_bf16 v[232:235], v[36:39], v[80:83], v[232:235]
ds_read_b64_tr_b16 v[30:31], v155 offset:15584
v_mul_f32 v241, v241, v141
v_mul_f32 v242, v242, v141
v_mul_f32 v243, v243, v141
v_mul_f32 v244, v244, v142
v_mul_f32 v245, v245, v142
v_mul_f32 v246, v246, v142
v_mul_f32 v247, v247, v142
v_mfma_f32_16x16x32_bf16 v[240:243], v[40:43], v[80:83], v[240:243]
ds_read_b64_tr_b16 v[32:33], v156 offset:10400
v_mfma_f32_16x16x32_bf16 v[244:247], v[40:43], v[84:87], v[244:247]
s_waitcnt lgkmcnt(5)
ds_read_b64_tr_b16 v[34:35], v156 offset:15584
v_mfma_f32_16x16x32_bf16 v[188:191], v[44:47], v[92:95], v[188:191]
ds_read_b64_tr_b16 v[36:37], v157 offset:10368
v_mfma_f32_16x16x32_bf16 v[184:187], v[44:47], v[88:91], v[184:187]
ds_read_b64_tr_b16 v[38:39], v157 offset:15552
v_mfma_f32_16x16x32_bf16 v[192:195], v[16:19], v[88:91], v[192:195]
ds_read_b64_tr_b16 v[40:41], v154 offset:20736
v_mfma_f32_16x16x32_bf16 v[196:199], v[16:19], v[92:95], v[196:199]
ds_read_b64_tr_b16 v[42:43], v154 offset:25920
v_mfma_f32_16x16x32_bf16 v[204:207], v[20:23], v[92:95], v[204:207]
ds_read_b64_tr_b16 v[44:45], v155 offset:20736
v_mfma_f32_16x16x32_bf16 v[200:203], v[20:23], v[88:91], v[200:203]
s_waitcnt lgkmcnt(5)
ds_read_b64_tr_b16 v[46:47], v155 offset:25920
v_mfma_f32_16x16x32_bf16 v[220:223], v[24:27], v[92:95], v[220:223]
ds_read_b64_tr_b16 v[16:17], v156 offset:20736
v_mfma_f32_16x16x32_bf16 v[216:219], v[24:27], v[88:91], v[216:219]
ds_read_b64_tr_b16 v[18:19], v156 offset:25920
v_mfma_f32_16x16x32_bf16 v[224:227], v[28:31], v[88:91], v[224:227]
ds_read_b64_tr_b16 v[20:21], v154 offset:20768
v_mfma_f32_16x16x32_bf16 v[228:231], v[28:31], v[92:95], v[228:231]
ds_read_b64_tr_b16 v[22:23], v154 offset:25952
v_mfma_f32_16x16x32_bf16 v[236:239], v[32:35], v[92:95], v[236:239]
ds_read_b64_tr_b16 v[24:25], v155 offset:20768
v_mfma_f32_16x16x32_bf16 v[232:235], v[32:35], v[88:91], v[232:235]
s_waitcnt lgkmcnt(5)
ds_read_b64_tr_b16 v[26:27], v155 offset:25952
v_mfma_f32_16x16x32_bf16 v[240:243], v[36:39], v[88:91], v[240:243]
ds_read_b64_tr_b16 v[28:29], v156 offset:20768
v_mfma_f32_16x16x32_bf16 v[244:247], v[36:39], v[92:95], v[244:247]
ds_read_b64_tr_b16 v[30:31], v156 offset:25952
v_mfma_f32_16x16x32_bf16 v[188:191], v[40:43], v[100:103], v[188:191]
ds_read_b64_tr_b16 v[32:33], v157 offset:20736
v_mfma_f32_16x16x32_bf16 v[184:187], v[40:43], v[96:99], v[184:187]
ds_read_b64_tr_b16 v[34:35], v157 offset:25920
v_mfma_f32_16x16x32_bf16 v[192:195], v[44:47], v[96:99], v[192:195]
ds_read_b64_tr_b16 v[36:37], v154 offset:31104
v_mfma_f32_16x16x32_bf16 v[196:199], v[44:47], v[100:103], v[196:199]
s_waitcnt lgkmcnt(5)
ds_read_b64_tr_b16 v[38:39], v154 offset:36288
v_mfma_f32_16x16x32_bf16 v[204:207], v[16:19], v[100:103], v[204:207]
ds_read_b64_tr_b16 v[40:41], v155 offset:31104
v_mfma_f32_16x16x32_bf16 v[200:203], v[16:19], v[96:99], v[200:203]
ds_read_b64_tr_b16 v[42:43], v155 offset:36288
v_mfma_f32_16x16x32_bf16 v[220:223], v[20:23], v[100:103], v[220:223]
ds_read_b64_tr_b16 v[44:45], v156 offset:31104
v_mfma_f32_16x16x32_bf16 v[216:219], v[20:23], v[96:99], v[216:219]
ds_read_b64_tr_b16 v[46:47], v156 offset:36288
v_mfma_f32_16x16x32_bf16 v[224:227], v[24:27], v[96:99], v[224:227]
ds_read_b64_tr_b16 v[16:17], v154 offset:31136
v_mfma_f32_16x16x32_bf16 v[228:231], v[24:27], v[100:103], v[228:231]
s_waitcnt lgkmcnt(5)
ds_read_b64_tr_b16 v[18:19], v154 offset:36320
v_mfma_f32_16x16x32_bf16 v[236:239], v[28:31], v[100:103], v[236:239]
ds_read_b64_tr_b16 v[20:21], v155 offset:31136
v_mfma_f32_16x16x32_bf16 v[232:235], v[28:31], v[96:99], v[232:235]
ds_read_b64_tr_b16 v[22:23], v155 offset:36320
v_mfma_f32_16x16x32_bf16 v[240:243], v[32:35], v[96:99], v[240:243]
ds_read_b64_tr_b16 v[24:25], v156 offset:31136
v_mfma_f32_16x16x32_bf16 v[244:247], v[32:35], v[100:103], v[244:247]
ds_read_b64_tr_b16 v[26:27], v156 offset:36320
v_mfma_f32_16x16x32_bf16 v[188:191], v[36:39], v[108:111], v[188:191]
ds_read_b64_tr_b16 v[28:29], v157 offset:31104
v_mfma_f32_16x16x32_bf16 v[184:187], v[36:39], v[104:107], v[184:187]
s_waitcnt lgkmcnt(5)
ds_read_b64_tr_b16 v[30:31], v157 offset:36288
v_mfma_f32_16x16x32_bf16 v[192:195], v[40:43], v[104:107], v[192:195]
v_add_u32 v154, v143, v154
v_mfma_f32_16x16x32_bf16 v[196:199], v[40:43], v[108:111], v[196:199]
ds_read_b64_tr_b16 v[32:33], v154 offset:4608
ds_read_b64_tr_b16 v[34:35], v154 offset:9792
v_mfma_f32_16x16x32_bf16 v[204:207], v[44:47], v[108:111], v[204:207]
v_add_u32 v155, v143, v155
v_mfma_f32_16x16x32_bf16 v[200:203], v[44:47], v[104:107], v[200:203]
ds_read_b64_tr_b16 v[36:37], v155 offset:4608
ds_read_b64_tr_b16 v[38:39], v155 offset:9792
v_mfma_f32_16x16x32_bf16 v[220:223], v[16:19], v[108:111], v[220:223]
v_add_u32 v156, v143, v156
v_add_u32 v157, v143, v157
v_mfma_f32_16x16x32_bf16 v[216:219], v[16:19], v[104:107], v[216:219]
s_waitcnt lgkmcnt(4)
ds_read_b64_tr_b16 v[40:41], v156 offset:4608
ds_read_b64_tr_b16 v[42:43], v156 offset:9792
v_mfma_f32_16x16x32_bf16 v[224:227], v[20:23], v[104:107], v[224:227]
ds_read_b64_tr_b16 v[44:45], v154 offset:4640
v_mfma_f32_16x16x32_bf16 v[228:231], v[20:23], v[108:111], v[228:231]
ds_read_b64_tr_b16 v[46:47], v154 offset:9824
v_mfma_f32_16x16x32_bf16 v[236:239], v[24:27], v[108:111], v[236:239]
ds_read_b64_tr_b16 v[16:17], v155 offset:4640
v_mfma_f32_16x16x32_bf16 v[232:235], v[24:27], v[104:107], v[232:235]
ds_read_b64_tr_b16 v[18:19], v155 offset:9824
v_mfma_f32_16x16x32_bf16 v[240:243], v[28:31], v[104:107], v[240:243]
ds_read_b64_tr_b16 v[20:21], v156 offset:4640
v_mfma_f32_16x16x32_bf16 v[244:247], v[28:31], v[108:111], v[244:247]
s_waitcnt lgkmcnt(5)
ds_read_b64_tr_b16 v[22:23], v156 offset:9824
v_mfma_f32_16x16x32_bf16 v[188:191], v[32:35], v[116:119], v[188:191]
ds_read_b64_tr_b16 v[24:25], v157 offset:4608
v_mfma_f32_16x16x32_bf16 v[184:187], v[32:35], v[112:115], v[184:187]
ds_read_b64_tr_b16 v[26:27], v157 offset:9792
v_mfma_f32_16x16x32_bf16 v[192:195], v[36:39], v[112:115], v[192:195]
v_add_u32 v153, 36864, v153
v_mfma_f32_16x16x32_bf16 v[196:199], v[36:39], v[116:119], v[196:199]
ds_read_b64_tr_b16 v[28:29], v153 offset:0
ds_read_b64_tr_b16 v[30:31], v153 offset:4608
v_mfma_f32_16x16x32_bf16 v[204:207], v[40:43], v[116:119], v[204:207]
ds_read_b64_tr_b16 v[32:33], v153 offset:32
v_mfma_f32_16x16x32_bf16 v[200:203], v[40:43], v[112:115], v[200:203]
s_waitcnt lgkmcnt(5)
ds_read_b64_tr_b16 v[34:35], v153 offset:4640
v_mfma_f32_16x16x32_bf16 v[220:223], v[44:47], v[116:119], v[220:223]
ds_read_b64_tr_b16 v[36:37], v153 offset:9216
v_mfma_f32_16x16x32_bf16 v[216:219], v[44:47], v[112:115], v[216:219]
ds_read_b64_tr_b16 v[38:39], v153 offset:13824
v_mfma_f32_16x16x32_bf16 v[224:227], v[16:19], v[112:115], v[224:227]
ds_read_b64_tr_b16 v[40:41], v153 offset:9248
v_mfma_f32_16x16x32_bf16 v[228:231], v[16:19], v[116:119], v[228:231]
ds_read_b64_tr_b16 v[42:43], v153 offset:13856
v_mfma_f32_16x16x32_bf16 v[236:239], v[20:23], v[116:119], v[236:239]
ds_read_b64_tr_b16 v[44:45], v153 offset:18432
v_mfma_f32_16x16x32_bf16 v[232:235], v[20:23], v[112:115], v[232:235]
s_waitcnt lgkmcnt(5)
ds_read_b64_tr_b16 v[46:47], v153 offset:23040
v_mfma_f32_16x16x32_bf16 v[240:243], v[24:27], v[112:115], v[240:243]
ds_read_b64_tr_b16 v[16:17], v153 offset:18464
v_mfma_f32_16x16x32_bf16 v[244:247], v[24:27], v[116:119], v[244:247]
ds_read_b64_tr_b16 v[18:19], v153 offset:23072
v_mfma_f32_16x16x32_bf16 v[176:179], v[28:31], a[224:227], v[176:179]
ds_read_b64_tr_b16 v[20:21], v153 offset:27648
v_mfma_f32_16x16x32_bf16 v[180:183], v[28:31], a[228:231], v[180:183]
ds_read_b64_tr_b16 v[22:23], v153 offset:32256
v_mfma_f32_16x16x32_bf16 v[208:211], v[32:35], a[224:227], v[208:211]
s_lshl_b32 s63, s56, 2
ds_read_b64_tr_b16 v[24:25], v153 offset:27680
v_cvt_pk_bf16_f32 v184, v184, v185
v_mfma_f32_16x16x32_bf16 v[212:215], v[32:35], a[228:231], v[212:215]
s_waitcnt lgkmcnt(5)
ds_read_b64_tr_b16 v[26:27], v153 offset:32288
v_cvt_pk_bf16_f32 v185, v186, v187
v_mfma_f32_16x16x32_bf16 v[176:179], v[36:39], a[232:235], v[176:179]
s_add_u32 s63, s63, s55
v_add_u32 v153, 4294856704, v153
v_cvt_pk_bf16_f32 v186, v188, v189
v_mfma_f32_16x16x32_bf16 v[180:183], v[36:39], a[236:239], v[180:183]
s_lshl_b32 s63, s63, 4
ds_read_b64_tr_b16 v[28:29], v153 offset:0
ds_read_b64_tr_b16 v[30:31], v153 offset:4608
v_mfma_f32_16x16x32_bf16 v[208:211], v[40:43], a[232:235], v[208:211]
s_add_u32 s63, s63, s48
ds_read_b64_tr_b16 v[32:33], v153 offset:32
v_cvt_pk_bf16_f32 v187, v190, v191
v_mfma_f32_16x16x32_bf16 v[212:215], v[40:43], a[236:239], v[212:215]
s_add_u32 s78, s49, 1
ds_read_b64_tr_b16 v[34:35], v153 offset:4640
v_cvt_pk_bf16_f32 v216, v216, v217
v_mfma_f32_16x16x32_bf16 v[176:179], v[44:47], a[240:243], v[176:179]
s_and_b32 s78, s78, 3
ds_read_b64_tr_b16 v[36:37], v153 offset:9216
v_cvt_pk_bf16_f32 v217, v218, v219
v_mfma_f32_16x16x32_bf16 v[180:183], v[44:47], a[244:247], v[180:183]
s_waitcnt lgkmcnt(5)
ds_read_b64_tr_b16 v[38:39], v153 offset:13824
v_cvt_pk_bf16_f32 v218, v220, v221
v_mfma_f32_16x16x32_bf16 v[208:211], v[16:19], a[240:243], v[208:211]
s_lshl_b32 s78, s78, 2
ds_read_b64_tr_b16 v[40:41], v153 offset:9248
v_cvt_pk_bf16_f32 v219, v222, v223
v_mfma_f32_16x16x32_bf16 v[212:215], v[16:19], a[244:247], v[212:215]
s_add_u32 s78, s78, s63
ds_read_b64_tr_b16 v[42:43], v153 offset:13856
v_cvt_pk_bf16_f32 v192, v192, v193
v_mfma_f32_16x16x32_bf16 v[176:179], v[20:23], a[248:251], v[176:179]
s_mul_i32 s78, s78, 10240
ds_read_b64_tr_b16 v[44:45], v153 offset:18432
v_cvt_pk_bf16_f32 v193, v194, v195
v_mfma_f32_16x16x32_bf16 v[180:183], v[20:23], a[252:255], v[180:183]
s_add_u32 s76, s78, 23068672
ds_read_b64_tr_b16 v[46:47], v153 offset:23040
buffer_store_dwordx4 v[184:187], v12, s[28:31], s76 offen offset:0 sc1
v_mfma_f32_16x16x32_bf16 v[208:211], v[24:27], a[248:251], v[208:211]
ds_read_b64_tr_b16 v[16:17], v153 offset:18464
buffer_store_dwordx4 v[216:219], v12, s[28:31], s76 offen offset:1024 sc1
v_mfma_f32_16x16x32_bf16 v[212:215], v[24:27], a[252:255], v[212:215]
s_waitcnt lgkmcnt(5)
ds_read_b64_tr_b16 v[18:19], v153 offset:23072
v_cvt_pk_bf16_f32 v194, v196, v197
v_mfma_f32_16x16x32_bf16 v[176:179], v[28:31], v[48:51], v[176:179]
ds_read_b64_tr_b16 v[20:21], v153 offset:27648
v_cvt_pk_bf16_f32 v195, v198, v199
v_mfma_f32_16x16x32_bf16 v[180:183], v[28:31], v[52:55], v[180:183]
s_add_u32 s78, s49, 2
ds_read_b64_tr_b16 v[22:23], v153 offset:32256
v_cvt_pk_bf16_f32 v224, v224, v225
v_mfma_f32_16x16x32_bf16 v[208:211], v[32:35], v[48:51], v[208:211]
s_and_b32 s78, s78, 3
ds_read_b64_tr_b16 v[24:25], v153 offset:27680
v_cvt_pk_bf16_f32 v225, v226, v227
v_mfma_f32_16x16x32_bf16 v[212:215], v[32:35], v[52:55], v[212:215]
s_lshl_b32 s78, s78, 2
ds_read_b64_tr_b16 v[26:27], v153 offset:32288
v_cvt_pk_bf16_f32 v226, v228, v229
v_mfma_f32_16x16x32_bf16 v[176:179], v[36:39], v[56:59], v[176:179]
s_add_u32 s78, s78, s63
v_add_u32 v153, 36864, v153
v_cvt_pk_bf16_f32 v227, v230, v231
v_mfma_f32_16x16x32_bf16 v[180:183], v[36:39], v[60:63], v[180:183]
s_waitcnt lgkmcnt(4)
ds_read_b64_tr_b16 v[28:29], v153 offset:0
ds_read_b64_tr_b16 v[30:31], v153 offset:5184
v_mfma_f32_16x16x32_bf16 v[208:211], v[40:43], v[56:59], v[208:211]
s_mul_i32 s78, s78, 10240
ds_read_b64_tr_b16 v[32:33], v153 offset:32
v_cvt_pk_bf16_f32 v200, v200, v201
v_mfma_f32_16x16x32_bf16 v[212:215], v[40:43], v[60:63], v[212:215]
s_add_u32 s76, s78, 23071744
ds_read_b64_tr_b16 v[34:35], v153 offset:5216
buffer_store_dwordx4 v[192:195], v12, s[28:31], s76 offen offset:0 sc1
v_mfma_f32_16x16x32_bf16 v[176:179], v[44:47], v[64:67], v[176:179]
ds_read_b64_tr_b16 v[36:37], v153 offset:10368
buffer_store_dwordx4 v[224:227], v12, s[28:31], s76 offen offset:1024 sc1
v_mfma_f32_16x16x32_bf16 v[180:183], v[44:47], v[68:71], v[180:183]
ds_read_b64_tr_b16 v[38:39], v153 offset:15552
v_cvt_pk_bf16_f32 v201, v202, v203
v_mfma_f32_16x16x32_bf16 v[208:211], v[16:19], v[64:67], v[208:211]
ds_read_b64_tr_b16 v[40:41], v153 offset:10400
v_cvt_pk_bf16_f32 v202, v204, v205
v_mfma_f32_16x16x32_bf16 v[212:215], v[16:19], v[68:71], v[212:215]
s_waitcnt lgkmcnt(5)
ds_read_b64_tr_b16 v[42:43], v153 offset:15584
v_cvt_pk_bf16_f32 v203, v206, v207
v_mfma_f32_16x16x32_bf16 v[176:179], v[20:23], v[72:75], v[176:179]
s_add_u32 s78, s49, 3
ds_read_b64_tr_b16 v[44:45], v153 offset:20736
v_cvt_pk_bf16_f32 v232, v232, v233
v_mfma_f32_16x16x32_bf16 v[180:183], v[20:23], v[76:79], v[180:183]
s_and_b32 s78, s78, 3
ds_read_b64_tr_b16 v[46:47], v153 offset:25920
v_cvt_pk_bf16_f32 v233, v234, v235
v_mfma_f32_16x16x32_bf16 v[208:211], v[24:27], v[72:75], v[208:211]
s_lshl_b32 s78, s78, 2
ds_read_b64_tr_b16 v[16:17], v153 offset:20768
v_cvt_pk_bf16_f32 v234, v236, v237
v_mfma_f32_16x16x32_bf16 v[212:215], v[24:27], v[76:79], v[212:215]
s_add_u32 s78, s78, s63
ds_read_b64_tr_b16 v[18:19], v153 offset:25952
v_cvt_pk_bf16_f32 v235, v238, v239
v_mul_f32 v176, v176, v141
v_mul_f32 v177, v177, v141
v_mul_f32 v178, v178, v141
v_mul_f32 v179, v179, v141
v_mul_f32 v180, v180, v142
v_mul_f32 v181, v181, v142
v_mul_f32 v182, v182, v142
v_mul_f32 v183, v183, v142
v_mfma_f32_16x16x32_bf16 v[176:179], v[28:31], v[80:83], v[176:179]
s_mul_i32 s78, s78, 10240
ds_read_b64_tr_b16 v[20:21], v153 offset:31104
v_cvt_pk_bf16_f32 v160, v240, v241
v_mfma_f32_16x16x32_bf16 v[180:183], v[28:31], v[84:87], v[180:183]
s_waitcnt lgkmcnt(5)
ds_read_b64_tr_b16 v[22:23], v153 offset:36288
v_cvt_pk_bf16_f32 v161, v242, v243
v_mul_f32 v208, v208, v141
v_mul_f32 v209, v209, v141
v_mul_f32 v210, v210, v141
v_mul_f32 v211, v211, v141
v_mul_f32 v212, v212, v142
v_mul_f32 v213, v213, v142
v_mul_f32 v214, v214, v142
v_mul_f32 v215, v215, v142
v_mfma_f32_16x16x32_bf16 v[208:211], v[32:35], v[80:83], v[208:211]
s_add_u32 s76, s78, 23074816
ds_read_b64_tr_b16 v[24:25], v153 offset:31136
buffer_store_dwordx4 v[200:203], v12, s[28:31], s76 offen offset:0 sc1
v_mfma_f32_16x16x32_bf16 v[212:215], v[32:35], v[84:87], v[212:215]
ds_read_b64_tr_b16 v[26:27], v153 offset:36320
buffer_store_dwordx4 v[232:235], v12, s[28:31], s76 offen offset:1024 sc1
v_mfma_f32_16x16x32_bf16 v[176:179], v[36:39], v[88:91], v[176:179]
v_add_u32 v153, v143, v153
v_cvt_pk_bf16_f32 v162, v244, v245
v_mfma_f32_16x16x32_bf16 v[180:183], v[36:39], v[92:95], v[180:183]
ds_read_b64_tr_b16 v[28:29], v153 offset:4608
ds_read_b64_tr_b16 v[30:31], v153 offset:9792
v_mfma_f32_16x16x32_bf16 v[208:211], v[40:43], v[88:91], v[208:211]
ds_read_b64_tr_b16 v[32:33], v153 offset:4640
v_cvt_pk_bf16_f32 v163, v246, v247
v_mfma_f32_16x16x32_bf16 v[212:215], v[40:43], v[92:95], v[212:215]
s_waitcnt lgkmcnt(5)
ds_read_b64_tr_b16 v[34:35], v153 offset:9824
s_sub_u32 s78, s48, s49
v_mfma_f32_16x16x32_bf16 v[176:179], v[44:47], v[96:99], v[176:179]
s_and_b32 s89, s78, 3
s_lshl_b32 s78, s48, 2
s_add_u32 s78, s78, s63
v_mfma_f32_16x16x32_bf16 v[180:183], v[44:47], v[100:103], v[180:183]
s_mul_i32 s78, s78, 10240
s_mul_i32 s76, s89, 3072
s_add_u32 s76, s76, s78
v_mfma_f32_16x16x32_bf16 v[208:211], v[16:19], v[96:99], v[208:211]
s_add_u32 s76, s76, 23067648
s_min_u32 s88, s89, 1
s_lshl_b32 s88, s88, 31
v_mfma_f32_16x16x32_bf16 v[212:215], v[16:19], v[100:103], v[212:215]
s_xor_b32 s77, s88, 0x80000000
v_or_b32 v1, s77, v12
v_or_b32 v2, s88, v12
v_mfma_f32_16x16x32_bf16 v[176:179], v[20:23], v[104:107], v[176:179]
buffer_store_dwordx4 v[160:163], v1, s[28:31], s76 offen sc1
v_add_u32 v3, s49, v14
v_mfma_f32_16x16x32_bf16 v[180:183], v[20:23], v[108:111], v[180:183]
s_waitcnt lgkmcnt(0)
v_and_b32 v3, 3, v3
v_lshl_add_u32 v3, v3, 2, s63
v_mfma_f32_16x16x32_bf16 v[208:211], v[24:27], v[104:107], v[208:211]
v_lshlrev_b32 v3, 7, v3
v_lshl_add_u32 v3, v14, 2, v3
v_mfma_f32_16x16x32_bf16 v[212:215], v[24:27], v[108:111], v[212:215]
v_add_u32 v3, 34734076, v3
v_bfrev_b32 v4, 1
v_mfma_f32_16x16x32_bf16 v[176:179], v[28:31], v[112:115], v[176:179]
v_subrev_u32 v9, 1, v14
v_cmp_gt_u32 vcc, 3, v9
v_mfma_f32_16x16x32_bf16 v[180:183], v[28:31], v[116:119], v[180:183]
v_min_u32 v159, 2, v14
v_cndmask_b32 v3, v4, v3, vcc
v_mfma_f32_16x16x32_bf16 v[208:211], v[32:35], v[112:115], v[208:211]
v_lshlrev_b32 v159, 2, v159
v_lshrrev_b32 v9, 4, v14
v_mfma_f32_16x16x32_bf16 v[212:215], v[32:35], v[116:119], v[212:215]
s_lshl_b32 s78, s49, 2
v_bfe_u32 v10, v14, 2, 2
v_cmp_eq_u32 vcc, v9, v10
s_add_u32 s78, s78, s63
s_lshl_b32 s81, s78, 7
s_add_u32 s81, s81, 34734080
s_mul_i32 s78, s78, 10240
s_add_u32 s78, s78, 23068672
v_and_b32 v9, 1, v14
v_lshlrev_b32 v9, 4, v9
v_mov_b32 v10, 0x3f80
v_lshlrev_b32 v10, v9, v10
v_cndmask_b32 v10, 0, v10, vcc
v_and_b32 v9, 2, v14
v_cmp_eq_u32 vcc, 0, v9
v_mov_b32 v128, 0
v_mov_b32 v129, 0
v_cndmask_b32 v130, 0, v10, vcc
v_mov_b32 v132, 0
v_mov_b32 v133, 0
v_sub_u32 v131, v10, v130
v_mov_b32 v129, 0
v_mov_b32 v15, s57
s_waitcnt vmcnt(0)
buffer_store_dword v15, v3, s[28:31], 0 offen sc1
buffer_load_dword v158, v159, s[28:31], s81 offen sc1
v_and_b32 v46, 15, v14
v_mul_u32_u24 v46, 1152, v46
v_lshrrev_b32 v47, 4, v14
v_lshl_add_u32 v46, v47, 3, v46
v_or_b32 v4, s88, v46
v_and_b32 v46, 15, v14
v_mul_u32_u24 v46, 1152, v46
v_and_b32 v1, 1, v47
v_lshrrev_b32 v47, 1, v47
v_lshl_add_u32 v46, v1, 5, v46
v_lshl_add_u32 v46, v47, 4, v46
s_lshl_b32 s76, s56, 2
s_add_u32 s76, s76, s48
s_mul_i32 s76, s76, 36864
s_mul_i32 s77, s55, 288
s_add_u32 s76, s76, s77
s_lshl_b32 s77, s49, 6
s_add_u32 s77, s77, s75
s_add_u32 s77, s77, s76
s_xor_b32 s89, s75, 32
s_lshl3_add_u32 s76, s89, s76
s_add_u32 s89, s76, 18432
s_add_u32 s63, s77, 18432
s_waitcnt vmcnt(0)
v_cmp_ne_u32 vcc, s57, v158
s_nop 1
s_cbranch_vccnz L_slow6
L_back6:
buffer_load_dwordx4 a[0:3], v12, s[28:31], s78 offen offset:0 sc1
buffer_load_dwordx4 a[4:7], v12, s[28:31], s78 offen offset:1024 sc1
buffer_load_dwordx4 a[8:11], v2, s[28:31], s78 offen offset:2048 sc1
s_add_u32 s78, s78, 3072
buffer_load_dwordx4 a[12:15], v12, s[28:31], s78 offen offset:0 sc1
buffer_load_dwordx4 a[16:19], v12, s[28:31], s78 offen offset:1024 sc1
buffer_load_dwordx4 a[20:23], v2, s[28:31], s78 offen offset:2048 sc1
s_add_u32 s78, s78, 3072
buffer_load_dwordx4 a[24:27], v12, s[28:31], s78 offen offset:0 sc1
buffer_load_dwordx4 a[28:31], v12, s[28:31], s78 offen offset:1024 sc1
buffer_load_dwordx4 a[32:35], v2, s[28:31], s78 offen offset:2048 sc1
s_waitcnt vmcnt(8)
v_mfma_f32_16x16x32_bf16 v[176:179], v[130:133], a[0:3], v[176:179]
v_mfma_f32_16x16x32_bf16 v[180:183], v[128:131], a[0:3], v[180:183]
s_waitcnt vmcnt(7)
v_mfma_f32_16x16x32_bf16 v[208:211], v[130:133], a[4:7], v[208:211]
v_mfma_f32_16x16x32_bf16 v[212:215], v[128:131], a[4:7], v[212:215]
s_waitcnt vmcnt(6)
v_mfma_f32_16x16x32_bf16 v[240:243], v[130:133], a[8:11], v[240:243]
v_mfma_f32_16x16x32_bf16 v[244:247], v[128:131], a[8:11], v[244:247]
s_waitcnt vmcnt(5)
v_mfma_f32_16x16x32_bf16 v[176:179], v[130:133], a[12:15], v[176:179]
v_mfma_f32_16x16x32_bf16 v[180:183], v[128:131], a[12:15], v[180:183]
s_waitcnt vmcnt(4)
v_mfma_f32_16x16x32_bf16 v[208:211], v[130:133], a[16:19], v[208:211]
v_mfma_f32_16x16x32_bf16 v[212:215], v[128:131], a[16:19], v[212:215]
s_waitcnt vmcnt(3)
v_mfma_f32_16x16x32_bf16 v[240:243], v[130:133], a[20:23], v[240:243]
v_mfma_f32_16x16x32_bf16 v[244:247], v[128:131], a[20:23], v[244:247]
s_waitcnt vmcnt(2)
v_mfma_f32_16x16x32_bf16 v[176:179], v[130:133], a[24:27], v[176:179]
v_mfma_f32_16x16x32_bf16 v[180:183], v[128:131], a[24:27], v[180:183]
s_waitcnt vmcnt(1)
v_mfma_f32_16x16x32_bf16 v[208:211], v[130:133], a[28:31], v[208:211]
v_mfma_f32_16x16x32_bf16 v[212:215], v[128:131], a[28:31], v[212:215]
s_waitcnt vmcnt(0)
v_mfma_f32_16x16x32_bf16 v[240:243], v[130:133], a[32:35], v[240:243]
v_mfma_f32_16x16x32_bf16 v[244:247], v[128:131], a[32:35], v[244:247]
s_nop 0
v_cvt_pk_bf16_f32 v176, v176, v177
v_cvt_pk_bf16_f32 v177, v178, v179
s_nop 0
v_cvt_pk_bf16_f32 v178, v208, v209
v_cvt_pk_bf16_f32 v179, v210, v211
s_nop 0
v_permlane16_swap_b32 v176, v178
v_permlane16_swap_b32 v177, v179
buffer_store_dwordx4 v[176:179], v46, s[32:35], s77 offen
v_cvt_pk_bf16_f32 v180, v180, v181
v_cvt_pk_bf16_f32 v181, v182, v183
v_cvt_pk_bf16_f32 v182, v212, v213
v_cvt_pk_bf16_f32 v183, v214, v215
s_nop 0
v_permlane16_swap_b32 v180, v182
v_permlane16_swap_b32 v181, v183
buffer_store_dwordx4 v[180:183], v46, s[32:35], s63 offen
v_cvt_pk_bf16_f32 v240, v240, v241
v_cvt_pk_bf16_f32 v241, v242, v243
buffer_store_dwordx2 v[240:241], v4, s[32:35], s76 offen
v_cvt_pk_bf16_f32 v244, v244, v245
v_cvt_pk_bf16_f32 v245, v246, v247
buffer_store_dwordx2 v[244:245], v4, s[32:35], s89 offen
s_branch L_end
L_slow0:
s_mov_b32 s84, 200000
L_spin0:
s_sleep 4
buffer_load_dword v176, v181, s[36:39], 16 offen sc1
s_waitcnt vmcnt(0)
v_cmp_eq_u32 vcc, 0, v176
s_nop 1
s_cbranch_vccz L_back0
s_sub_u32 s84, s84, 1
s_cmp_lg_u32 s84, 0
s_cbranch_scc1 L_spin0
s_branch L_back0
L_slow1:
s_mov_b32 s84, 200000
L_spin1:
s_sleep 4
buffer_load_dword v2, v11, s[28:31], s81 offen sc1
s_waitcnt vmcnt(0)
v_cmp_ne_u32 vcc, s57, v2
s_nop 1
s_cbranch_vccz L_back1
s_sub_u32 s84, s84, 1
s_cmp_lg_u32 s84, 0
s_cbranch_scc1 L_spin1
s_branch L_back1
L_slow2:
s_mov_b32 s84, 200000
L_spin2:
s_sleep 4
buffer_load_dword v158, v159, s[28:31], s81 offen sc1
s_waitcnt vmcnt(0)
v_cmp_ne_u32 vcc, s57, v158
s_nop 1
s_cbranch_vccz L_back2
s_sub_u32 s84, s84, 1
s_cmp_lg_u32 s84, 0
s_cbranch_scc1 L_spin2
s_branch L_back2
L_slow3:
s_mov_b32 s84, 200000
L_spin3:
s_sleep 4
buffer_load_dword v158, v159, s[28:31], s81 offen sc1
s_waitcnt vmcnt(0)
v_cmp_ne_u32 vcc, s57, v158
s_nop 1
s_cbranch_vccz L_back3
s_sub_u32 s84, s84, 1
s_cmp_lg_u32 s84, 0
s_cbranch_scc1 L_spin3
s_branch L_back3
L_slow4:
s_mov_b32 s84, 200000
L_spin4:
s_sleep 4
buffer_load_dword v158, v159, s[28:31], s81 offen sc1
s_waitcnt vmcnt(0)
v_cmp_ne_u32 vcc, s57, v158
s_nop 1
s_cbranch_vccz L_back4
s_sub_u32 s84, s84, 1
s_cmp_lg_u32 s84, 0
s_cbranch_scc1 L_spin4
s_branch L_back4
L_slow5:
s_mov_b32 s84, 200000
L_spin5:
s_sleep 4
buffer_load_dword v158, v159, s[28:31], s81 offen sc1
s_waitcnt vmcnt(0)
v_cmp_ne_u32 vcc, s57, v158
s_nop 1
s_cbranch_vccz L_back5
s_sub_u32 s84, s84, 1
s_cmp_lg_u32 s84, 0
s_cbranch_scc1 L_spin5
s_branch L_back5
L_slow6:
s_mov_b32 s84, 200000
L_spin6:
s_sleep 1
buffer_load_dword v158, v159, s[28:31], s81 offen sc1
s_waitcnt vmcnt(0)
v_cmp_ne_u32 vcc, s57, v158
s_nop 1
s_cbranch_vccz L_back6
s_sub_u32 s84, s84, 1
s_cmp_lg_u32 s84, 0
s_cbranch_scc1 L_spin6
s_branch L_back6
L_end:
s_endpgm
.p2align 8
.type L_tab,@object
L_tab:
.long 0x0, 0x8, 0x80000000, 0x0
.long 0x10, 0x18, 0x80000000, 0x0
.long 0x20, 0x480, 0x80000000, 0x0
.long 0x488, 0x490, 0x80000000, 0x0
.long 0x498, 0x4a0, 0x80000000, 0x0
.long 0x900, 0x908, 0x80000000, 0x0
.long 0x910, 0x918, 0x80000000, 0x0
.long 0x920, 0x80000000, 0x0, 0x0
.long 0xd80, 0xd88, 0x80000000, 0x0
.long 0xd90, 0xd98, 0x80000000, 0x0
.long 0xda0, 0x1200, 0x80000000, 0x0
.long 0x1208, 0x1210, 0x80000000, 0x0
.long 0x1218, 0x1220, 0x80000000, 0x0
.long 0x1680, 0x1688, 0x80000000, 0x0
.long 0x1690, 0x1698, 0x80000000, 0x0
.long 0x16a0, 0x80000000, 0x2, 0x0
.long 0x1b00, 0x1b08, 0x80000000, 0x0
.long 0x1b10, 0x1b18, 0x80000000, 0x0
.long 0x1b20, 0x1f80, 0x80000000, 0x0
.long 0x1f88, 0x1f90, 0x80000000, 0x0
.long 0x1f98, 0x1fa0, 0x80000000, 0x0
.long 0x2400, 0x2408, 0x80000000, 0x0
.long 0x2410, 0x2418, 0x80000000, 0x0
.long 0x2420, 0x80000000, 0x4, 0x0
.long 0x2880, 0x2888, 0x80000000, 0x0
.long 0x2890, 0x2898, 0x80000000, 0x0
.long 0x28a0, 0x2d00, 0x80000000, 0x0
.long 0x2d08, 0x2d10, 0x80000000, 0x0
.long 0x2d18, 0x2d20, 0x80000000, 0x0
.long 0x3180, 0x3188, 0x80000000, 0x0
.long 0x3190, 0x3198, 0x80000000, 0x0
.long 0x31a0, 0x80000000, 0x6, 0x0
.long 0x3600, 0x3608, 0x80000000, 0x0
.long 0x3610, 0x3618, 0x80000000, 0x0
.long 0x3620, 0x3a80, 0x80000000, 0x0
.long 0x3a88, 0x3a90, 0x80000000, 0x0
.long 0x3a98, 0x3aa0, 0x80000000, 0x0
.long 0x3f00, 0x3f08, 0x80000000, 0x0
.long 0x3f10, 0x3f18, 0x80000000, 0x0
.long 0x3f20, 0x80000000, 0x8, 0x0
.long 0x4380, 0x4388, 0x80000000, 0x0
.long 0x4390, 0x4398, 0x80000000, 0x0
.long 0x43a0, 0x4800, 0x80000000, 0x0
.long 0x4808, 0x4810, 0x80000000, 0x0
.long 0x4818, 0x4820, 0x80000000, 0x0
.long 0x4c80, 0x4c88, 0x80000000, 0x0
.long 0x4c90, 0x4c98, 0x80000000, 0x0
.long 0x4ca0, 0x80000000, 0xa, 0x0
.long 0x5100, 0x5108, 0x80000000, 0x0
.long 0x5110, 0x5118, 0x80000000, 0x0
.long 0x5120, 0x5580, 0x80000000, 0x0
.long 0x5588, 0x5590, 0x80000000, 0x0
.long 0x5598, 0x55a0, 0x80000000, 0x0
.long 0x5a00, 0x5a08, 0x80000000, 0x0
.long 0x5a10, 0x5a18, 0x80000000, 0x0
.long 0x5a20, 0x80000000, 0xc, 0x0
.long 0x5e80, 0x5e88, 0x80000000, 0x0
.long 0x5e90, 0x5e98, 0x80000000, 0x0
.long 0x5ea0, 0x6300, 0x80000000, 0x0
.long 0x6308, 0x6310, 0x80000000, 0x0
.long 0x6318, 0x6320, 0x80000000, 0x0
.long 0x6780, 0x6788, 0x80000000, 0x0
.long 0x6790, 0x6798, 0x80000000, 0x0
.long 0x67a0, 0x80000000, 0xe, 0x0
.long 0x27b60, 0x27e80, 0x27e80, 0x0
.long 0x27e30, 0x27e80, 0x27e80, 0x0
.long 0x27e80, 0x27e80, 0x278e0, 0x0
.long 0x27e80, 0x27e80, 0x27bb0, 0x0
.long 0x27b88, 0x27e80, 0x27e80, 0x0
.long 0x27e58, 0x27e80, 0x27e80, 0x0
.long 0x27e80, 0x27e80, 0x27908, 0x0
.long 0x27e80, 0x27e80, 0x27bd8, 0x0
.long 0x27e80, 0x27e80, 0x27e80, 0x0
.long 0x27e80, 0x27e80, 0x27e80, 0x0
.long 0x27e80, 0x27e80, 0x27930, 0x0
.long 0x27e80, 0x27e80, 0x27c00, 0x0
.long 0x27e80, 0x27e80, 0x27e80, 0x0
.long 0x27e80, 0x27e80, 0x27e80, 0x0
.long 0x27e80, 0x27e80, 0x27958, 0x0
.long 0x27e80, 0x27e80, 0x27c28, 0x0
.long 0x27e80, 0x27e80, 0x27e80, 0x0
.long 0x27e80, 0x27e80, 0x27e80, 0x0
.long 0x27e80, 0x27b60, 0x27980, 0x0
.long 0x27e80, 0x27e30, 0x27c50, 0x0
.long 0x27e80, 0x27e80, 0x27e80, 0x0
.long 0x27e80, 0x27e80, 0x27e80, 0x0
.long 0x27e80, 0x27b88, 0x279a8, 0x0
.long 0x27e80, 0x27e58, 0x27c78, 0x0
.long 0x27e80, 0x27e80, 0x27e80, 0x0
.long 0x27e80, 0x27e80, 0x27e80, 0x0
.long 0x27e80, 0x27e80, 0x279d0, 0x0
.long 0x27e80, 0x27e80, 0x27ca0, 0x0
.long 0x27e80, 0x27e80, 0x27e80, 0x0
.long 0x27e80, 0x27e80, 0x27e80, 0x0
.long 0x27e80, 0x27e80, 0x279f8, 0x0
.long 0x27e80, 0x27e80, 0x27cc8, 0x0
.long 0x27e80, 0x27e80, 0x27e80, 0x0
.long 0x27e80, 0x27e80, 0x27e80, 0x0
.long 0x27e80, 0x27e80, 0x27a20, 0x0
.long 0x27e80, 0x27e80, 0x27cf0, 0x0
.long 0x27e80, 0x27e80, 0x27e80, 0x0
.long 0x27e80, 0x27e80, 0x27e80, 0x0
.long 0x27e80, 0x27e80, 0x27a48, 0x0
.long 0x27e80, 0x27e80, 0x27d18, 0x0
.long 0x27e80, 0x27e80, 0x27e80, 0x0
.long 0x27e80, 0x27e80, 0x27e80, 0x0
.long 0x27e80, 0x27e80, 0x27a70, 0x0
.long 0x27e80, 0x27e80, 0x27d40, 0x0
.long 0x27e80, 0x27e80, 0x27e80, 0x0
.long 0x27e80, 0x27e80, 0x27e80, 0x0
.long 0x27e80, 0x27e80, 0x27a98, 0x0
.long 0x27e80, 0x27e80, 0x27d68, 0x0
.long 0x27e80, 0x27e80, 0x27e80, 0x0
.long 0x27e80, 0x27e80, 0x27e80, 0x0
.long 0x27e80, 0x27e80, 0x27ac0, 0x0
.long 0x27e80, 0x27e80, 0x27d90, 0x0
.long 0x27e80, 0x27e80, 0x27e80, 0x0
.long 0x27e80, 0x27e80, 0x27e80, 0x0
.long 0x27e80, 0x27e80, 0x27ae8, 0x0
.long 0x27e80, 0x27e80, 0x27db8, 0x0
.long 0x27e80, 0x27e80, 0x27e80, 0x0
.long 0x27e80, 0x27e80, 0x27e80, 0x0
.long 0x27e80, 0x27e80, 0x27b10, 0x0
.long 0x27e80, 0x27e80, 0x27de0, 0x0
.long 0x27e80, 0x27e80, 0x27e80, 0x0
.long 0x27e80, 0x27e80, 0x27e80, 0x0
.long 0x27e80, 0x27e80, 0x27b38, 0x0
.long 0x27e80, 0x27e80, 0x27e08, 0x0
.long 0x278e0, 0x0, 0x0, 0x0
.long 0x27bb0, 0x0, 0x0, 0x0
.long 0x27e80, 0x0, 0x0, 0x0
.long 0x27e80, 0x0, 0x0, 0x0
.long 0x27908, 0x0, 0x0, 0x0
.long 0x27bd8, 0x0, 0x0, 0x0
.long 0x27e80, 0x0, 0x0, 0x0
.long 0x27e80, 0x0, 0x0, 0x0
.long 0x27930, 0x0, 0x0, 0x0
.long 0x27c00, 0x0, 0x0, 0x0
.long 0x27e80, 0x0, 0x0, 0x0
.long 0x27e80, 0x0, 0x0, 0x0
.long 0x27958, 0x0, 0x0, 0x0
.long 0x27c28, 0x0, 0x0, 0x0
.long 0x27e80, 0x0, 0x0, 0x0
.long 0x27e80, 0x0, 0x0, 0x0
.long 0x27980, 0x0, 0x0, 0x0
.long 0x27c50, 0x0, 0x0, 0x0
.long 0x27e80, 0x0, 0x0, 0x0
.long 0x27e80, 0x0, 0x0, 0x0
.long 0x279a8, 0x0, 0x0, 0x0
.long 0x27c78, 0x0, 0x0, 0x0
.long 0x27e80, 0x0, 0x0, 0x0
.long 0x27e80, 0x0, 0x0, 0x0
.long 0x279d0, 0x0, 0x0, 0x0
.long 0x27ca0, 0x0, 0x0, 0x0
.long 0x27e80, 0x0, 0x0, 0x0
.long 0x27e80, 0x0, 0x0, 0x0
.long 0x279f8, 0x0, 0x0, 0x0
.long 0x27cc8, 0x0, 0x0, 0x0
.long 0x27e80, 0x0, 0x0, 0x0
.long 0x27e80, 0x0, 0x0, 0x0
.long 0x27a20, 0x0, 0x0, 0x0
.long 0x27cf0, 0x0, 0x0, 0x0
.long 0x27e80, 0x0, 0x0, 0x0
.long 0x27e80, 0x0, 0x0, 0x0
.long 0x27a48, 0x0, 0x0, 0x0
.long 0x27d18, 0x0, 0x0, 0x0
.long 0x27e80, 0x0, 0x0, 0x0
.long 0x27e80, 0x0, 0x0, 0x0
.long 0x27a70, 0x0, 0x0, 0x0
.long 0x27d40, 0x0, 0x0, 0x0
.long 0x27e80, 0x0, 0x0, 0x0
.long 0x27e80, 0x0, 0x0, 0x0
.long 0x27a98, 0x0, 0x0, 0x0
.long 0x27d68, 0x0, 0x0, 0x0
.long 0x27e80, 0x0, 0x0, 0x0
.long 0x27e80, 0x0, 0x0, 0x0
.long 0x27ac0, 0x0, 0x0, 0x0
.long 0x27d90, 0x0, 0x0, 0x0
.long 0x27e80, 0x0, 0x0, 0x0
.long 0x27e80, 0x0, 0x0, 0x0
.long 0x27ae8, 0x0, 0x0, 0x0
.long 0x27db8, 0x0, 0x0, 0x0
.long 0x27e80, 0x0, 0x0, 0x0
.long 0x27e80, 0x0, 0x0, 0x0
.long 0x27b10, 0x0, 0x0, 0x0
.long 0x27de0, 0x0, 0x0, 0x0
.long 0x27e80, 0x0, 0x0, 0x0
.long 0x27e80, 0x0, 0x0, 0x0
.long 0x27b38, 0x0, 0x0, 0x0
.long 0x27e08, 0x0, 0x0, 0x0
.long 0x27e80, 0x0, 0x0, 0x0
.long 0x27e80, 0x0, 0x0, 0x0
.long 0x0, 0x0, 0x0, 0x0
.long 0x10, 0x0, 0x0, 0x0
.long 0x2400, 0x0, 0x0, 0x0
.long 0x2410, 0x0, 0x0, 0x0
.long 0x4800, 0x0, 0x0, 0x0
.long 0x4810, 0x0, 0x0, 0x0
.long 0x6c00, 0x0, 0x0, 0x0
.long 0x6c10, 0x0, 0x0, 0x0
.long 0x12000, 0x0, 0x0, 0x0
.long 0x12010, 0x0, 0x0, 0x0
.long 0x14400, 0x0, 0x0, 0x0
.long 0x14410, 0x0, 0x0, 0x0
.long 0x16800, 0x0, 0x0, 0x0
.long 0x16810, 0x0, 0x0, 0x0
.long 0x18c00, 0x0, 0x0, 0x0
.long 0x18c10, 0x0, 0x0, 0x0
.long 0x9000, 0x0, 0x0, 0x0
.long 0x9010, 0x0, 0x0, 0x0
.long 0xb400, 0x0, 0x0, 0x0
.long 0xb410, 0x0, 0x0, 0x0
.long 0xd800, 0x0, 0x0, 0x0
.long 0xd810, 0x0, 0x0, 0x0
.long 0xfc00, 0x0, 0x0, 0x0
.long 0xfc10, 0x0, 0x0, 0x0
.long 0x1b000, 0x0, 0x0, 0x0
.long 0x1b010, 0x0, 0x0, 0x0
.long 0x1d400, 0x0, 0x0, 0x0
.long 0x1d410, 0x0, 0x0, 0x0
.long 0x1f800, 0x0, 0x0, 0x0
.long 0x1f810, 0x0, 0x0, 0x0
.long 0x21c00, 0x0, 0x0, 0x0
.long 0x21c10, 0x0, 0x0, 0x0
.long 0x24000, 0x0, 0x0, 0x0
.long 0x24010, 0x0, 0x0, 0x0
.long 0x26400, 0x0, 0x0, 0x0
.long 0x26410, 0x0, 0x0, 0x0
.long 0x28800, 0x0, 0x0, 0x0
.long 0x28810, 0x0, 0x0, 0x0
.long 0x2ac00, 0x0, 0x0, 0x0
.long 0x2ac10, 0x0, 0x0, 0x0
.long 0x36000, 0x0, 0x0, 0x0
.long 0x36010, 0x0, 0x0, 0x0
.long 0x38400, 0x0, 0x0, 0x0
.long 0x38410, 0x0, 0x0, 0x0
.long 0x3a800, 0x0, 0x0, 0x0
.long 0x3a810, 0x0, 0x0, 0x0
.long 0x3cc00, 0x0, 0x0, 0x0
.long 0x3cc10, 0x0, 0x0, 0x0
.long 0x2d000, 0x0, 0x0, 0x0
.long 0x2d010, 0x0, 0x0, 0x0
.long 0x2f400, 0x0, 0x0, 0x0
.long 0x2f410, 0x0, 0x0, 0x0
.long 0x31800, 0x0, 0x0, 0x0
.long 0x31810, 0x0, 0x0, 0x0
.long 0x33c00, 0x0, 0x0, 0x0
.long 0x33c10, 0x0, 0x0, 0x0
.long 0x3f000, 0x0, 0x0, 0x0
.long 0x3f010, 0x0, 0x0, 0x0
.long 0x41400, 0x0, 0x0, 0x0
.long 0x41410, 0x0, 0x0, 0x0
.long 0x43800, 0x0, 0x0, 0x0
.long 0x43810, 0x0, 0x0, 0x0
.long 0x45c00, 0x0, 0x0, 0x0
.long 0x45c10, 0x0, 0x0, 0x0
.long 0x245a0, 0x0, 0x0, 0x0
.long 0x24500, 0x0, 0x0, 0x0
.long 0x24550, 0x0, 0x0, 0x0
.long 0x245f0, 0x0, 0x0, 0x0
.long 0x245a0, 0x0, 0x0, 0x0
.long 0x24500, 0x0, 0x0, 0x0
.long 0x24550, 0x0, 0x0, 0x0
.long 0x245f0, 0x0, 0x0, 0x0
.long 0x245a0, 0x0, 0x0, 0x0
.long 0x24500, 0x0, 0x0, 0x0
.long 0x24550, 0x0, 0x0, 0x0
.long 0x245f0, 0x0, 0x0, 0x0
.long 0x245a0, 0x0, 0x0, 0x0
.long 0x24500, 0x0, 0x0, 0x0
.long 0x24550, 0x0, 0x0, 0x0
.long 0x245f0, 0x0, 0x0, 0x0
.long 0x245c8, 0x0, 0x0, 0x0
.long 0x24528, 0x0, 0x0, 0x0
.long 0x24578, 0x0, 0x0, 0x0
.long 0x24618, 0x0, 0x0, 0x0
.long 0x245c8, 0x0, 0x0, 0x0
.long 0x24528, 0x0, 0x0, 0x0
.long 0x24578, 0x0, 0x0, 0x0
.long 0x24618, 0x0, 0x0, 0x0
.long 0x245c8, 0x0, 0x0, 0x0
.long 0x24528, 0x0, 0x0, 0x0
.long 0x24578, 0x0, 0x0, 0x0
.long 0x24618, 0x0, 0x0, 0x0
.long 0x245c8, 0x0, 0x0, 0x0
.long 0x24528, 0x0, 0x0, 0x0
.long 0x24578, 0x0, 0x0, 0x0
.long 0x24618, 0x0, 0x0, 0x0
.long 0x27e80, 0x0, 0x0, 0x0
.long 0x27e80, 0x0, 0x0, 0x0
.long 0x27e80, 0x0, 0x0, 0x0
.long 0x27e80, 0x0, 0x0, 0x0
.long 0x27e80, 0x0, 0x0, 0x0
.long 0x27e80, 0x0, 0x0, 0x0
.long 0x27e80, 0x0, 0x0, 0x0
.long 0x27e80, 0x0, 0x0, 0x0
.long 0x27e80, 0x0, 0x0, 0x0
.long 0x27e80, 0x0, 0x0, 0x0
.long 0x27e80, 0x0, 0x0, 0x0
.long 0x27e80, 0x0, 0x0, 0x0
.long 0x27e80, 0x0, 0x0, 0x0
.long 0x27e80, 0x0, 0x0, 0x0
.long 0x27e80, 0x0, 0x0, 0x0
.long 0x27e80, 0x0, 0x0, 0x0
.long 0x27e80, 0x0, 0x0, 0x0
.long 0x27e80, 0x0, 0x0, 0x0
.long 0x27e80, 0x0, 0x0, 0x0
.long 0x27e80, 0x0, 0x0, 0x0
.long 0x27e80, 0x0, 0x0, 0x0
.long 0x27e80, 0x0, 0x0, 0x0
.long 0x27e80, 0x0, 0x0, 0x0
.long 0x27e80, 0x0, 0x0, 0x0
.long 0x27e80, 0x0, 0x0, 0x0
.long 0x27e80, 0x0, 0x0, 0x0
.long 0x27e80, 0x0, 0x0, 0x0
.long 0x27e80, 0x0, 0x0, 0x0
.long 0x27e80, 0x0, 0x0, 0x0
.long 0x27e80, 0x0, 0x0, 0x0
.long 0x27e80, 0x0, 0x0, 0x0
.long 0x27e80, 0x0, 0x0, 0x0
.long 0x24000, 0x0, 0x0, 0x0
.long 0x24050, 0x0, 0x0, 0x0
.long 0x240a0, 0x0, 0x0, 0x0
.long 0x240f0, 0x0, 0x0, 0x0
.long 0x24140, 0x0, 0x0, 0x0
.long 0x24190, 0x0, 0x0, 0x0
.long 0x241e0, 0x0, 0x0, 0x0
.long 0x24230, 0x0, 0x0, 0x0
.long 0x24280, 0x0, 0x0, 0x0
.long 0x242d0, 0x0, 0x0, 0x0
.long 0x24320, 0x0, 0x0, 0x0
.long 0x24370, 0x0, 0x0, 0x0
.long 0x243c0, 0x0, 0x0, 0x0
.long 0x24410, 0x0, 0x0, 0x0
.long 0x24460, 0x0, 0x0, 0x0
.long 0x244b0, 0x0, 0x0, 0x0
.long 0x24028, 0x0, 0x0, 0x0
.long 0x24078, 0x0, 0x0, 0x0
.long 0x240c8, 0x0, 0x0, 0x0
.long 0x24118, 0x0, 0x0, 0x0
.long 0x24168, 0x0, 0x0, 0x0
.long 0x241b8, 0x0, 0x0, 0x0
.long 0x24208, 0x0, 0x0, 0x0
.long 0x24258, 0x0, 0x0, 0x0
.long 0x242a8, 0x0, 0x0, 0x0
.long 0x242f8, 0x0, 0x0, 0x0
.long 0x24348, 0x0, 0x0, 0x0
.long 0x24398, 0x0, 0x0, 0x0
.long 0x243e8, 0x0, 0x0, 0x0
.long 0x24438, 0x0, 0x0, 0x0
.long 0x24488, 0x0, 0x0, 0x0
.long 0x244d8, 0x0, 0x0, 0x0
.long 0x27e80, 0x0, 0x0, 0x0
.long 0x27e80, 0x0, 0x0, 0x0
.long 0x27e80, 0x0, 0x0, 0x0
.long 0x27e80, 0x0, 0x0, 0x0
.long 0x27e80, 0x0, 0x0, 0x0
.long 0x27e80, 0x0, 0x0, 0x0
.long 0x27e80, 0x0, 0x0, 0x0
.long 0x27e80, 0x0, 0x0, 0x0
.long 0x27e80, 0x0, 0x0, 0x0
.long 0x27e80, 0x0, 0x0, 0x0
.long 0x27e80, 0x0, 0x0, 0x0
.long 0x27e80, 0x0, 0x0, 0x0
.long 0x27e80, 0x0, 0x0, 0x0
.long 0x27e80, 0x0, 0x0, 0x0
.long 0x27e80, 0x0, 0x0, 0x0
.long 0x27e80, 0x0, 0x0, 0x0
.long 0x27e80, 0x0, 0x0, 0x0
.long 0x27e80, 0x0, 0x0, 0x0
.long 0x27e80, 0x0, 0x0, 0x0
.long 0x27e80, 0x0, 0x0, 0x0
.long 0x27e80, 0x0, 0x0, 0x0
.long 0x27e80, 0x0, 0x0, 0x0
.long 0x27e80, 0x0, 0x0, 0x0
.long 0x27e80, 0x0, 0x0, 0x0
.long 0x27e80, 0x0, 0x0, 0x0
.long 0x27e80, 0x0, 0x0, 0x0
.long 0x27e80, 0x0, 0x0, 0x0
.long 0x27e80, 0x0, 0x0, 0x0
.long 0x27e80, 0x0, 0x0, 0x0
.long 0x27e80, 0x0, 0x0, 0x0
.long 0x27e80, 0x0, 0x0, 0x0
.long 0x27e80, 0x0, 0x0, 0x0
.long 0x26700, 0x0, 0x26700, 0x0
.long 0x26704, 0x0, 0x26704, 0x0
.long 0x26708, 0x0, 0x26708, 0x0
.long 0x2670c, 0x0, 0x2670c, 0x0
.long 0x26710, 0x0, 0x26710, 0x0
.long 0x26714, 0x0, 0x26714, 0x0
.long 0x26718, 0x0, 0x26718, 0x0
.long 0x2671c, 0x0, 0x2671c, 0x0
.long 0x26720, 0x0, 0x26720, 0x0
.long 0x26724, 0x0, 0x26724, 0x0
.long 0x26728, 0x0, 0x26728, 0x0
.long 0x2672c, 0x0, 0x2672c, 0x0
.long 0x26730, 0x0, 0x26730, 0x0
.long 0x26734, 0x0, 0x26734, 0x0
.long 0x26738, 0x0, 0x26738, 0x0
.long 0x2673c, 0x0, 0x2673c, 0x0
.long 0x26700, 0x1, 0x26700, 0x0
.long 0x26704, 0x1, 0x26704, 0x0
.long 0x26708, 0x1, 0x26708, 0x0
.long 0x2670c, 0x1, 0x2670c, 0x0
.long 0x26710, 0x1, 0x26710, 0x0
.long 0x26714, 0x1, 0x26714, 0x0
.long 0x26718, 0x1, 0x26718, 0x0
.long 0x2671c, 0x1, 0x2671c, 0x0
.long 0x26720, 0x1, 0x26720, 0x0
.long 0x26724, 0x1, 0x26724, 0x0
.long 0x26728, 0x1, 0x26728, 0x0
.long 0x2672c, 0x1, 0x2672c, 0x0
.long 0x26730, 0x1, 0x26730, 0x0
.long 0x26734, 0x1, 0x26734, 0x0
.long 0x26738, 0x1, 0x26738, 0x0
.long 0x2673c, 0x1, 0x2673c, 0x0
.long 0x26700, 0x2, 0x26700, 0x0
.long 0x26704, 0x2, 0x26704, 0x0
.long 0x26708, 0x2, 0x26708, 0x0
.long 0x2670c, 0x2, 0x2670c, 0x0
.long 0x26710, 0x2, 0x26710, 0x0
.long 0x26714, 0x2, 0x26714, 0x0
.long 0x26718, 0x2, 0x26718, 0x0
.long 0x2671c, 0x2, 0x2671c, 0x0
.long 0x26720, 0x2, 0x26720, 0x0
.long 0x26724, 0x2, 0x26724, 0x0
.long 0x26728, 0x2, 0x26728, 0x0
.long 0x2672c, 0x2, 0x2672c, 0x0
.long 0x26730, 0x2, 0x26730, 0x0
.long 0x26734, 0x2, 0x26734, 0x0
.long 0x26738, 0x2, 0x26738, 0x0
.long 0x2673c, 0x2, 0x2673c, 0x0
.long 0x26700, 0x3, 0x26700, 0x0
.long 0x26704, 0x3, 0x26704, 0x0
.long 0x26708, 0x3, 0x26708, 0x0
.long 0x2670c, 0x3, 0x2670c, 0x0
.long 0x26710, 0x3, 0x26710, 0x0
.long 0x26714, 0x3, 0x26714, 0x0
.long 0x26718, 0x3, 0x26718, 0x0
.long 0x2671c, 0x3, 0x2671c, 0x0
.long 0x26720, 0x3, 0x26720, 0x0
.long 0x26724, 0x3, 0x26724, 0x0
.long 0x26728, 0x3, 0x26728, 0x0
.long 0x2672c, 0x3, 0x2672c, 0x0
.long 0x26730, 0x3, 0x26730, 0x0
.long 0x26734, 0x3, 0x26734, 0x0
.long 0x26738, 0x3, 0x26738, 0x0
.long 0x2673c, 0x3, 0x2673c, 0x0
L_tabend:
.size L_tab, L_tabend-L_tab
.section .rodata,"a"
.p2align 6
.amdhsa_kernel gated_mix__linear_kernel_hedgehog__glu_gated_swiglu__prompt_kernel
  .amdhsa_next_free_vgpr 512
  .amdhsa_next_free_sgpr 102
  .amdhsa_accum_offset 256
  .amdhsa_group_segment_fixed_size 0
  .amdhsa_kernarg_size 96
  .amdhsa_user_sgpr_count 2
  .amdhsa_user_sgpr_kernarg_segment_ptr 1
  .amdhsa_system_sgpr_workgroup_id_x 1
  .amdhsa_float_denorm_mode_32 3
.end_amdhsa_kernel
```
